```python
import torch

def _softmax(x, axis=-1):
    return torch.softmax(x, dim=axis)
def _gelu(x):
    return torch.nn.functional.gelu(x, approximate="tanh")
def _silu(x):
    return torch.nn.functional.silu(x)
def _sigmoid(x):
    return torch.sigmoid(x)
def _layernorm(x, axis=-1, eps=1e-5):
    m = x.mean(dim=axis, keepdim=True)
    v = x.var(dim=axis, keepdim=True, unbiased=False)
    return (x - m) / torch.sqrt(v + eps)
def _scatter_add(tgt, idx, src, axis=0):
    return tgt.clone().index_add_(axis, idx, src)
def _segment_sum(src, seg, n):
    out = torch.zeros((n,) + src.shape[1:], dtype=src.dtype)
    return out.index_add_(0, seg, src)
def _pad(x, pw):
    flat = tuple(v for pair in reversed(pw) for v in pair)
    return torch.nn.functional.pad(x, flat)

kernel_name = 'concat_heads__mha_block_cached__gqa_block_cached__near_ridge'

def setup_inputs():

    _w = (lambda a: (lambda t: t.to(torch.bfloat16) if t.is_floating_point() else t)(torch.as_tensor(a)))
    def _A_setup():
        B, Sq, D = 8, 192, 640
        H, Sk, Dh = 32, 1024, 128
        return {
            "x": _w((lambda *s: torch.randn(*s, dtype=torch.bfloat16) * 0.8)(B, Sq, D)),
            "k_cache": _w((lambda *s: torch.randn(*s, dtype=torch.bfloat16) * 0.8)(B, H, Sk, Dh)),
            "v_cache": _w((lambda *s: torch.randn(*s, dtype=torch.bfloat16) * 0.05)(B, H, Sk, Dh)),
            "wq": _w((lambda *s: torch.randn(*s, dtype=torch.bfloat16) * 0.8)(D, H * Dh) * (D ** -0.5)),
            "wo": _w((lambda *s: torch.randn(*s, dtype=torch.bfloat16) * 0.05)(H * Dh, D) * ((H * Dh) ** -0.5)),
        }
    _A_in = _A_setup()

    def _B_setup():
        B, Sq, D = 8, 192, 640
        Hq, Hkv, Sk, Dh = 32, 32, 1024, 128
        assert Hq % Hkv == 0, (Hq, Hkv)
        return {
            "x": _w((lambda *s: torch.randn(*s, dtype=torch.bfloat16) * 0.8)(B, Sq, D)),
            "k_cache": _w((lambda *s: torch.randn(*s, dtype=torch.bfloat16) * 0.8)(B, Hkv, Sk, Dh)),
            "v_cache": _w((lambda *s: torch.randn(*s, dtype=torch.bfloat16) * 0.05)(B, Hkv, Sk, Dh)),
            "wq": _w((lambda *s: torch.randn(*s, dtype=torch.bfloat16) * 0.8)(D, Hq * Dh) * (D ** -0.5)),
            "wo": _w((lambda *s: torch.randn(*s, dtype=torch.bfloat16) * 0.05)(Hq * Dh, D) * ((Hq * Dh) ** -0.5)),
        }
    _B_in = _B_setup()

    return {
        "A_x": _A_in["x"],
        "A_k_cache": _A_in["k_cache"],
        "A_v_cache": _A_in["v_cache"],
        "A_wq": _A_in["wq"],
        "A_wo": _A_in["wo"],
        "B_x": _B_in["x"],
        "B_k_cache": _B_in["k_cache"],
        "B_v_cache": _B_in["v_cache"],
        "B_wq": _B_in["wq"],
        "B_wo": _B_in["wo"],
    }

def reference(A_x, A_k_cache, A_v_cache, A_wq, A_wo, B_x, B_k_cache, B_v_cache, B_wq, B_wo):
    def _A_ref(x, k_cache, v_cache, wq, wo):
        B, Sq, D = x.shape
        H, Dh = 32, 128
        q = (lambda x, *d: x.permute(*d))((x @ wq).reshape(B, Sq, H, Dh), 0, 2, 1, 3)
        scores = torch.einsum("bhqd,bhkd->bhqk", q, k_cache) * (Dh ** -0.5)
        p = _softmax(scores, axis=-1)
        o = torch.einsum("bhqk,bhkd->bhqd", p, v_cache)
        return (lambda x, *d: x.permute(*d))(o, 0, 2, 1, 3).reshape(B, Sq, H * Dh) @ wo

    def _B_ref(x, k_cache, v_cache, wq, wo):
        B, Sq, D = x.shape
        Hq, Dh = 32, 128
        Hkv = k_cache.shape[1]
        rep = Hq // Hkv
        q = (lambda x, *d: x.permute(*d))((x @ wq).reshape(B, Sq, Hq, Dh), 0, 2, 1, 3)
        k = (lambda x, n, axis: torch.repeat_interleave(x, n, dim=axis))(k_cache, rep, axis=1)
        v = (lambda x, n, axis: torch.repeat_interleave(x, n, dim=axis))(v_cache, rep, axis=1)
        scores = torch.einsum("bhqd,bhkd->bhqk", q, k) * (Dh ** -0.5)
        p = _softmax(scores, axis=-1)
        o = torch.einsum("bhqk,bhkd->bhqd", p, v)
        return (lambda x, *d: x.permute(*d))(o, 0, 2, 1, 3).reshape(B, Sq, Hq * Dh) @ wo

    a = _A_ref(A_x, A_k_cache, A_v_cache, A_wq, A_wo)
    b = _B_ref(B_x, B_k_cache, B_v_cache, B_wq, B_wo)
    return torch.concatenate([a, b], axis=-1)
```

```asm
; @launch grid=(256,1,1) block=(256,1,1) lds=163840
.amdgcn_target "amdgcn-amd-amdhsa--gfx950"
.text
.globl concat_heads__mha_block_cached__gqa_block_cached__near_ridge_kernel
.p2align 8
.type concat_heads__mha_block_cached__gqa_block_cached__near_ridge_kernel,@function
concat_heads__mha_block_cached__gqa_block_cached__near_ridge_kernel:
s_cmp_ge_u32 s2, 256
s_cbranch_scc1 L_end
s_bfe_u32 s25, s2, 0x10002
s_mul_i32 s28, s25, 40
s_add_u32 s62, s0, s28
s_addc_u32 s63, s1, 0
s_load_dwordx4 s[36:39], s[62:63], 0
s_load_dwordx4 s[40:43], s[62:63], 16
s_load_dwordx2 s[44:45], s[0:1], 96
s_load_dwordx2 s[92:93], s[62:63], 32
s_getpc_b64 s[88:89]
L_pc:
s_mov_b32 s90, L_end - L_pc
s_mov_b32 s91, 0x20000
v_lshlrev_b32 v54, 7, v0
buffer_load_dword v56, v54, s[88:91], 0 offen
s_lshr_b32 s24, s2, 3
s_and_b32 s28, s2, 3
s_and_b32 s23, s24, 3
s_lshl_b32 s26, s28, 2
s_add_u32 s26, s26, s23
s_lshr_b32 s27, s24, 2
v_lshrrev_b32 v1, 6, v0
v_and_b32 v2, 63, v0
v_readfirstlane_b32 s20, v1
v_and_b32 v3, 15, v2
v_lshrrev_b32 v4, 4, v2
v_lshrrev_b32 v10, 3, v2
v_and_b32 v11, 7, v2
v_xor_b32 v13, v11, v4
v_mul_u32_u24 v14, 1280, v10
v_lshl_add_u32 v58, v13, 4, v14
v_xor_b32 v13, 4, v13
v_lshl_add_u32 v59, v13, 4, v14
v_add_u32 v59, 9216, v59
v_add_u32 v60, 18432, v58
v_add_u32 v61, 18432, v59
v_lshlrev_b32 v10, 2, v4
v_xor_b32 v10, v3, v10
v_lshlrev_b32 v11, 13, v4
v_lshl_add_u32 v6, v10, 4, v11
v_add_u32 v7, 31744, v6
v_add_u32 v8, 63488, v6
v_add_u32 v9, 95232, v6
s_lshr_b32 s21, s20, 1
s_and_b32 s22, s20, 1
s_lshl_b32 s29, s26, 1
s_add_u32 s29, s29, s21
s_lshl_b32 s46, s21, 16
s_mul_i32 s48, s20, 6144
s_lshl_b32 s54, s22, 13
s_add_u32 s54, s54, s46
s_mul_i32 s34, s27, 245760
s_mul_i32 s49, s20, 61440
s_lshl_b32 s35, s29, 8
s_lshl_b32 s53, s22, 18
s_waitcnt lgkmcnt(0)
s_add_u32 s4, s36, s34
s_addc_u32 s5, s37, 0
s_mov_b32 s6, 245760
s_mov_b32 s7, 0x20000
s_add_u32 s8, s42, s35
s_addc_u32 s9, s43, 0
s_sub_u32 s10, 5242880, s35
s_mov_b32 s11, 0x20000
s_add_u32 s34, s27, s23
s_and_b32 s34, s34, 1
s_mul_i32 s34, s34, 5
s_lshl_b32 s50, s34, 7
s_add_u32 s50, s50, s49
s_add_u32 s96, s49, 1280
s_lshl_b32 s51, s34, 19
s_add_u32 s51, s51, s53
s_add_u32 s97, s53, 5242880
s_add_u32 m0, s48, 114688
s_add_u32 s55, s50, 0
buffer_load_dwordx4 v58, s[4:7], s55 offen offset:0  lds
buffer_load_dwordx4 v59, s[4:7], s55 offen offset:1024  lds
buffer_load_dwordx4 v60, s[4:7], s55 offen offset:2048  lds
buffer_load_dwordx4 v61, s[4:7], s55 offen offset:3072  lds
s_add_u32 m0, s48, 118784
s_add_u32 s55, s50, 40960
buffer_load_dwordx4 v58, s[4:7], s55 offen offset:0  lds
buffer_load_dwordx4 v59, s[4:7], s55 offen offset:1024  lds
s_add_u32 s50, s50, 128
s_cmp_eq_u32 s50, s96
s_cselect_b32 s50, s49, s50
s_add_u32 m0, s54, 32768
s_add_u32 s55, s51, 0
buffer_load_dwordx4 v6, s[8:11], s55 offen offset:0  lds
buffer_load_dwordx4 v7, s[8:11], s55 offen offset:1024  lds
buffer_load_dwordx4 v8, s[8:11], s55 offen offset:2048  lds
buffer_load_dwordx4 v9, s[8:11], s55 offen offset:3072  lds
s_add_u32 m0, s54, 36864
s_add_u32 s55, s51, 131072
buffer_load_dwordx4 v6, s[8:11], s55 offen offset:0  lds
buffer_load_dwordx4 v7, s[8:11], s55 offen offset:1024  lds
buffer_load_dwordx4 v8, s[8:11], s55 offen offset:2048  lds
buffer_load_dwordx4 v9, s[8:11], s55 offen offset:3072  lds
s_add_u32 s51, s51, 0x80000
s_cmp_eq_u32 s51, s97
s_cselect_b32 s51, s53, s51
s_lshl_b32 s34, s27, 5
s_add_u32 s34, s34, s29
s_lshl_b32 s34, s34, 18
s_add_u32 s36, s38, s34
s_addc_u32 s37, s39, 0
s_add_u32 s38, s40, s34
s_addc_u32 s39, s41, 0
s_cmp_eq_u32 s22, 1
s_cselect_b32 s12, s38, s36
s_cselect_b32 s13, s39, s37
s_mov_b32 s14, 0x40000
s_mov_b32 s15, 0x20000
s_cselect_b64 s[32:33], -1, 0
v_xor_b32 v11, v3, v4
v_lshlrev_b32 v10, 1, v4
v_xor_b32 v10, v3, v10
v_lshlrev_b32 v12, 8, v4
v_xor_b32 v13, 0, v11
v_xor_b32 v14, 0, v10
v_cndmask_b32 v13, v13, v14, s[32:33]
v_lshl_add_u32 v16, v13, 4, v12
v_xor_b32 v13, 4, v11
v_xor_b32 v14, 8, v10
v_cndmask_b32 v13, v13, v14, s[32:33]
v_lshl_add_u32 v17, v13, 4, v12
v_xor_b32 v13, 8, v11
v_xor_b32 v14, 0, v10
v_cndmask_b32 v13, v13, v14, s[32:33]
v_lshl_add_u32 v18, v13, 4, v12
v_xor_b32 v13, 12, v11
v_xor_b32 v14, 8, v10
v_cndmask_b32 v13, v13, v14, s[32:33]
v_lshl_add_u32 v19, v13, 4, v12
v_lshlrev_b32 v12, 8, v3
v_add_u32 v12, s46, v12
v_xor_b32 v13, 0, v11
v_lshl_add_u32 v20, v13, 4, v12
v_xor_b32 v13, 4, v11
v_lshl_add_u32 v21, v13, 4, v12
v_xor_b32 v13, 8, v11
v_lshl_add_u32 v22, v13, 4, v12
v_xor_b32 v13, 12, v11
v_lshl_add_u32 v23, v13, 4, v12
v_lshrrev_b32 v10, 2, v3
v_lshl_add_u32 v11, v4, 2, v10
v_and_b32 v12, 7, v11
v_lshlrev_b32 v11, 8, v11
v_and_b32 v13, 3, v3
v_lshl_add_u32 v11, v13, 3, v11
s_add_u32 s47, s46, 8192
v_add_u32 v11, s47, v11
v_xor_b32 v14, 0, v12
v_lshl_add_u32 v24, v14, 5, v11
v_xor_b32 v14, 1, v12
v_lshl_add_u32 v25, v14, 5, v11
v_xor_b32 v14, 2, v12
v_lshl_add_u32 v26, v14, 5, v11
v_xor_b32 v14, 3, v12
v_lshl_add_u32 v27, v14, 5, v11
v_xor_b32 v14, 4, v12
v_lshl_add_u32 v28, v14, 5, v11
v_xor_b32 v14, 5, v12
v_lshl_add_u32 v29, v14, 5, v11
v_xor_b32 v14, 6, v12
v_lshl_add_u32 v30, v14, 5, v11
v_xor_b32 v14, 7, v12
v_lshl_add_u32 v31, v14, 5, v11
v_lshlrev_b32 v32, 4, v2
v_add_u32 v33, 4096, v32
s_mul_i32 s34, s22, 12288
s_add_u32 s34, s34, 114688
v_lshrrev_b32 v11, 1, v3
v_xor_b32 v11, v4, v11
v_lshlrev_b32 v12, 7, v3
v_add_u32 v12, s34, v12
v_xor_b32 v14, 0, v11
v_lshl_add_u32 v52, v14, 4, v12
v_xor_b32 v14, 4, v11
v_lshl_add_u32 v53, v14, 4, v12
v_lshl_add_u32 v11, v4, 3, v10
v_lshlrev_b32 v11, 8, v11
v_lshl_add_u32 v11, v13, 4, v11
v_add_u32 v11, s46, v11
v_xor_b32 v14, 0, v10
v_lshl_add_u32 v40, v14, 6, v11
v_xor_b32 v14, 1, v10
v_lshl_add_u32 v41, v14, 6, v11
v_xor_b32 v14, 2, v10
v_lshl_add_u32 v42, v14, 6, v11
v_xor_b32 v14, 3, v10
v_lshl_add_u32 v43, v14, 6, v11
v_and_b32 v14, 3, v2
v_cmp_eq_u32 vcc, 0, v14
v_mov_b32 v14, 0x3f803f80
s_nop 0
v_cndmask_b32 v48, 0, v14, vcc
v_cndmask_b32 v49, 0, v14, vcc
v_cndmask_b32 v50, 0, v14, vcc
v_cndmask_b32 v51, 0, v14, vcc
v_lshl_add_u32 v45, v4, 4, s46
v_mov_b32 v46, 0x3e0293ee
v_mov_b32 v47, 0x3e0293ee
s_mov_b32 s31, 0x5f800000
s_lshl_b32 s40, s25, 3
s_add_u32 s40, s40, s27
s_lshl_b32 s34, s40, 5
s_add_u32 s34, s34, s29
s_lshl_b32 s34, s34, 1
s_add_u32 s34, s34, s22
s_mul_i32 s34, s34, 24576
s_add_u32 s16, s44, s34
s_addc_u32 s17, s45, 0
s_movk_i32 s18, 0x6000
s_mov_b32 s19, 0x20000
s_mov_b32 s59, 0
s_add_u32 s30, s2, 1
s_mul_i32 s34, s30, 0x9E3779B1
s_lshr_b32 s30, s34, 27
s_mul_i32 s35, s21, 16
s_add_u32 s30, s30, s35
s_lshl_b32 s30, s30, 13
s_bfe_u32 s101, s34, 0x40017
s_lshl_b32 s101, s101, 14
s_add_u32 s101, s101, 4096
s_mov_b32 s34, 0x8000
buffer_load_dword v56, v54, s[88:91], s34 offen
s_lshl_b32 s34, s26, 3
s_add_u32 s34, s34, s27
s_mul_i32 s34, s34, 40960
s_add_u32 s88, s92, s34
s_addc_u32 s89, s93, 0
s_mov_b32 s90, 40960
s_mov_b32 s91, 0x20000
v_add_u32 v55, 0x8000, v54
s_add_u32 m0, s48, 139264
s_add_u32 s55, s50, 0
buffer_load_dwordx4 v58, s[4:7], s55 offen offset:0  lds
buffer_load_dwordx4 v59, s[4:7], s55 offen offset:1024  lds
buffer_load_dwordx4 v60, s[4:7], s55 offen offset:2048  lds
buffer_load_dwordx4 v61, s[4:7], s55 offen offset:3072  lds
s_add_u32 m0, s48, 143360
s_add_u32 s55, s50, 40960
buffer_load_dwordx4 v58, s[4:7], s55 offen offset:0  lds
buffer_load_dwordx4 v59, s[4:7], s55 offen offset:1024  lds
s_add_u32 s50, s50, 128
s_cmp_eq_u32 s50, s96
s_cselect_b32 s50, s49, s50
s_add_u32 m0, s54, 0
s_add_u32 s55, s51, 0
buffer_load_dwordx4 v6, s[8:11], s55 offen offset:0  lds
buffer_load_dwordx4 v7, s[8:11], s55 offen offset:1024  lds
buffer_load_dwordx4 v8, s[8:11], s55 offen offset:2048  lds
buffer_load_dwordx4 v9, s[8:11], s55 offen offset:3072  lds
s_add_u32 m0, s54, 4096
s_add_u32 s55, s51, 131072
buffer_load_dwordx4 v6, s[8:11], s55 offen offset:0  lds
buffer_load_dwordx4 v7, s[8:11], s55 offen offset:1024  lds
buffer_load_dwordx4 v8, s[8:11], s55 offen offset:2048  lds
buffer_load_dwordx4 v9, s[8:11], s55 offen offset:3072  lds
s_add_u32 s51, s51, 0x80000
s_cmp_eq_u32 s51, s97
s_cselect_b32 s51, s53, s51
s_waitcnt vmcnt(15)
s_barrier
ds_read_b128 a[144:147], v52 offset:0
ds_read_b128 a[148:151], v53 offset:0
ds_read_b128 a[152:155], v52 offset:2048
ds_read_b128 a[156:159], v53 offset:2048
ds_read_b128 a[160:163], v52 offset:4096
ds_read_b128 a[164:167], v53 offset:4096
ds_read_b128 a[168:171], v52 offset:6144
ds_read_b128 a[172:175], v53 offset:6144
ds_read_b128 a[176:179], v52 offset:8192
ds_read_b128 a[180:183], v53 offset:8192
ds_read_b128 a[184:187], v52 offset:10240
ds_read_b128 a[188:191], v53 offset:10240
ds_read_b64_tr_b16 a[80:81], v40 offset:32768
ds_read_b64_tr_b16 a[82:83], v40 offset:33792
ds_read_b64_tr_b16 a[84:85], v40 offset:40960
ds_read_b64_tr_b16 a[86:87], v40 offset:41984
ds_read_b64_tr_b16 a[88:89], v40 offset:32776
ds_read_b64_tr_b16 a[90:91], v40 offset:33800
ds_read_b64_tr_b16 a[92:93], v40 offset:40968
ds_read_b64_tr_b16 a[94:95], v40 offset:41992
ds_read_b64_tr_b16 a[96:97], v41 offset:32768
ds_read_b64_tr_b16 a[98:99], v41 offset:33792
ds_read_b64_tr_b16 a[100:101], v41 offset:40960
ds_read_b64_tr_b16 a[102:103], v41 offset:41984
ds_read_b64_tr_b16 a[104:105], v41 offset:32776
ds_read_b64_tr_b16 a[106:107], v41 offset:33800
ds_read_b64_tr_b16 a[108:109], v41 offset:40968
ds_read_b64_tr_b16 a[110:111], v41 offset:41992
ds_read_b64_tr_b16 a[112:113], v42 offset:32768
ds_read_b64_tr_b16 a[114:115], v42 offset:33792
ds_read_b64_tr_b16 a[116:117], v42 offset:40960
ds_read_b64_tr_b16 a[118:119], v42 offset:41984
ds_read_b64_tr_b16 a[120:121], v42 offset:32776
ds_read_b64_tr_b16 a[122:123], v42 offset:33800
ds_read_b64_tr_b16 a[124:125], v42 offset:40968
ds_read_b64_tr_b16 a[126:127], v42 offset:41992
ds_read_b64_tr_b16 a[128:129], v43 offset:32768
ds_read_b64_tr_b16 a[130:131], v43 offset:33792
ds_read_b64_tr_b16 a[132:133], v43 offset:40960
ds_read_b64_tr_b16 a[134:135], v43 offset:41984
ds_read_b64_tr_b16 a[136:137], v43 offset:32776
ds_read_b64_tr_b16 a[138:139], v43 offset:33800
ds_read_b64_tr_b16 a[140:141], v43 offset:40968
ds_read_b64_tr_b16 a[142:143], v43 offset:41992
s_waitcnt lgkmcnt(15)
v_mfma_f32_16x16x32_bf16 v[64:67], a[80:83], a[144:147], 0
s_add_u32 m0, s54, 16384
v_accvgpr_write_b32 a0, 0
v_accvgpr_write_b32 a1, 0
v_mfma_f32_16x16x32_bf16 v[64:67], a[84:87], a[148:151], v[64:67]
s_add_u32 s55, s51, 0
v_accvgpr_write_b32 a2, 0
v_accvgpr_write_b32 a3, 0
v_mfma_f32_16x16x32_bf16 v[96:99], a[80:83], a[152:155], 0
v_accvgpr_write_b32 a4, 0
v_accvgpr_write_b32 a5, 0
v_mfma_f32_16x16x32_bf16 v[96:99], a[84:87], a[156:159], v[96:99]
buffer_load_dwordx4 v6, s[8:11], s55 offen offset:0  lds
v_mfma_f32_16x16x32_bf16 v[128:131], a[80:83], a[160:163], 0
v_accvgpr_write_b32 a6, 0
v_accvgpr_write_b32 a7, 0
v_mfma_f32_16x16x32_bf16 v[128:131], a[84:87], a[164:167], v[128:131]
v_accvgpr_write_b32 a8, 0
v_accvgpr_write_b32 a9, 0
v_mfma_f32_16x16x32_bf16 v[160:163], a[80:83], a[168:171], 0
buffer_load_dwordx4 v7, s[8:11], s55 offen offset:1024  lds
v_mfma_f32_16x16x32_bf16 v[160:163], a[84:87], a[172:175], v[160:163]
v_accvgpr_write_b32 a10, 0
v_accvgpr_write_b32 a11, 0
v_mfma_f32_16x16x32_bf16 v[192:195], a[80:83], a[176:179], 0
v_accvgpr_write_b32 a12, 0
v_accvgpr_write_b32 a13, 0
v_mfma_f32_16x16x32_bf16 v[192:195], a[84:87], a[180:183], v[192:195]
buffer_load_dwordx4 v8, s[8:11], s55 offen offset:2048  lds
v_mfma_f32_16x16x32_bf16 v[224:227], a[80:83], a[184:187], 0
s_waitcnt vmcnt(3) lgkmcnt(0)
v_mfma_f32_16x16x32_bf16 v[224:227], a[84:87], a[188:191], v[224:227]
s_barrier
v_mfma_f32_16x16x32_bf16 v[68:71], a[88:91], a[144:147], 0
ds_read_b64_tr_b16 a[80:81], v40 offset:0
ds_read_b64_tr_b16 a[82:83], v40 offset:1024
v_mfma_f32_16x16x32_bf16 v[68:71], a[92:95], a[148:151], v[68:71]
ds_read_b64_tr_b16 a[84:85], v40 offset:8192
ds_read_b64_tr_b16 a[86:87], v40 offset:9216
v_mfma_f32_16x16x32_bf16 v[100:103], a[88:91], a[152:155], 0
ds_read_b128 a[192:195], v52 offset:24576
ds_read_b128 a[196:199], v53 offset:24576
v_mfma_f32_16x16x32_bf16 v[100:103], a[92:95], a[156:159], v[100:103]
ds_read_b128 a[200:203], v52 offset:26624
ds_read_b128 a[204:207], v53 offset:26624
v_mfma_f32_16x16x32_bf16 v[132:135], a[88:91], a[160:163], 0
ds_read_b128 a[208:211], v52 offset:28672
ds_read_b128 a[212:215], v53 offset:28672
v_mfma_f32_16x16x32_bf16 v[132:135], a[92:95], a[164:167], v[132:135]
ds_read_b128 a[216:219], v52 offset:30720
ds_read_b128 a[220:223], v53 offset:30720
v_mfma_f32_16x16x32_bf16 v[164:167], a[88:91], a[168:171], 0
ds_read_b128 a[224:227], v52 offset:32768
ds_read_b128 a[228:231], v53 offset:32768
v_mfma_f32_16x16x32_bf16 v[164:167], a[92:95], a[172:175], v[164:167]
ds_read_b128 a[232:235], v52 offset:34816
ds_read_b128 a[236:239], v53 offset:34816
v_mfma_f32_16x16x32_bf16 v[196:199], a[88:91], a[176:179], 0
v_accvgpr_write_b32 a14, 0
v_accvgpr_write_b32 a15, 0
v_mfma_f32_16x16x32_bf16 v[196:199], a[92:95], a[180:183], v[196:199]
buffer_load_dwordx4 v9, s[8:11], s55 offen offset:3072  lds
v_mfma_f32_16x16x32_bf16 v[228:231], a[88:91], a[184:187], 0
s_add_u32 m0, s54, 20480
v_accvgpr_write_b32 a16, 0
v_accvgpr_write_b32 a17, 0
v_mfma_f32_16x16x32_bf16 v[228:231], a[92:95], a[188:191], v[228:231]
ds_read_b64_tr_b16 a[88:89], v40 offset:8
ds_read_b64_tr_b16 a[90:91], v40 offset:1032
v_mfma_f32_16x16x32_bf16 v[72:75], a[96:99], a[144:147], 0
ds_read_b64_tr_b16 a[92:93], v40 offset:8200
ds_read_b64_tr_b16 a[94:95], v40 offset:9224
v_mfma_f32_16x16x32_bf16 v[72:75], a[100:103], a[148:151], v[72:75]
s_add_u32 s55, s51, 131072
v_accvgpr_write_b32 a18, 0
v_accvgpr_write_b32 a19, 0
v_mfma_f32_16x16x32_bf16 v[104:107], a[96:99], a[152:155], 0
v_accvgpr_write_b32 a20, 0
v_accvgpr_write_b32 a21, 0
v_mfma_f32_16x16x32_bf16 v[104:107], a[100:103], a[156:159], v[104:107]
buffer_load_dwordx4 v6, s[8:11], s55 offen offset:0  lds
v_mfma_f32_16x16x32_bf16 v[136:139], a[96:99], a[160:163], 0
v_accvgpr_write_b32 a22, 0
v_accvgpr_write_b32 a23, 0
v_mfma_f32_16x16x32_bf16 v[136:139], a[100:103], a[164:167], v[136:139]
v_accvgpr_write_b32 a24, 0
v_accvgpr_write_b32 a25, 0
v_mfma_f32_16x16x32_bf16 v[168:171], a[96:99], a[168:171], 0
buffer_load_dwordx4 v7, s[8:11], s55 offen offset:1024  lds
v_mfma_f32_16x16x32_bf16 v[168:171], a[100:103], a[172:175], v[168:171]
v_accvgpr_write_b32 a26, 0
v_accvgpr_write_b32 a27, 0
v_mfma_f32_16x16x32_bf16 v[200:203], a[96:99], a[176:179], 0
v_accvgpr_write_b32 a28, 0
v_accvgpr_write_b32 a29, 0
v_mfma_f32_16x16x32_bf16 v[200:203], a[100:103], a[180:183], v[200:203]
buffer_load_dwordx4 v8, s[8:11], s55 offen offset:2048  lds
v_mfma_f32_16x16x32_bf16 v[232:235], a[96:99], a[184:187], 0
v_accvgpr_write_b32 a30, 0
v_accvgpr_write_b32 a31, 0
v_mfma_f32_16x16x32_bf16 v[232:235], a[100:103], a[188:191], v[232:235]
ds_read_b64_tr_b16 a[96:97], v41 offset:0
ds_read_b64_tr_b16 a[98:99], v41 offset:1024
v_mfma_f32_16x16x32_bf16 v[76:79], a[104:107], a[144:147], 0
ds_read_b64_tr_b16 a[100:101], v41 offset:8192
ds_read_b64_tr_b16 a[102:103], v41 offset:9216
v_mfma_f32_16x16x32_bf16 v[76:79], a[108:111], a[148:151], v[76:79]
v_accvgpr_write_b32 a32, 0
v_accvgpr_write_b32 a33, 0
v_mfma_f32_16x16x32_bf16 v[108:111], a[104:107], a[152:155], 0
v_accvgpr_write_b32 a34, 0
v_accvgpr_write_b32 a35, 0
v_mfma_f32_16x16x32_bf16 v[108:111], a[108:111], a[156:159], v[108:111]
buffer_load_dwordx4 v9, s[8:11], s55 offen offset:3072  lds
v_mfma_f32_16x16x32_bf16 v[140:143], a[104:107], a[160:163], 0
s_add_u32 s51, s51, 0x80000
v_accvgpr_write_b32 a36, 0
v_accvgpr_write_b32 a37, 0
v_mfma_f32_16x16x32_bf16 v[140:143], a[108:111], a[164:167], v[140:143]
s_cmp_eq_u32 s51, s97
s_cselect_b32 s51, s53, s51
v_accvgpr_write_b32 a38, 0
v_accvgpr_write_b32 a39, 0
v_mfma_f32_16x16x32_bf16 v[172:175], a[104:107], a[168:171], 0
s_add_u32 m0, s48, 114688
v_accvgpr_write_b32 a40, 0
v_accvgpr_write_b32 a41, 0
v_mfma_f32_16x16x32_bf16 v[172:175], a[108:111], a[172:175], v[172:175]
s_add_u32 s55, s50, 0
v_accvgpr_write_b32 a42, 0
v_accvgpr_write_b32 a43, 0
v_mfma_f32_16x16x32_bf16 v[204:207], a[104:107], a[176:179], 0
v_accvgpr_write_b32 a44, 0
v_accvgpr_write_b32 a45, 0
v_mfma_f32_16x16x32_bf16 v[204:207], a[108:111], a[180:183], v[204:207]
buffer_load_dwordx4 v58, s[4:7], s55 offen offset:0  lds
v_mfma_f32_16x16x32_bf16 v[236:239], a[104:107], a[184:187], 0
v_accvgpr_write_b32 a46, 0
v_accvgpr_write_b32 a47, 0
v_mfma_f32_16x16x32_bf16 v[236:239], a[108:111], a[188:191], v[236:239]
ds_read_b64_tr_b16 a[104:105], v41 offset:8
ds_read_b64_tr_b16 a[106:107], v41 offset:1032
v_mfma_f32_16x16x32_bf16 v[80:83], a[112:115], a[144:147], 0
ds_read_b64_tr_b16 a[108:109], v41 offset:8200
ds_read_b64_tr_b16 a[110:111], v41 offset:9224
v_mfma_f32_16x16x32_bf16 v[80:83], a[116:119], a[148:151], v[80:83]
v_accvgpr_write_b32 a48, 0
v_accvgpr_write_b32 a49, 0
v_mfma_f32_16x16x32_bf16 v[112:115], a[112:115], a[152:155], 0
v_accvgpr_write_b32 a50, 0
v_accvgpr_write_b32 a51, 0
v_mfma_f32_16x16x32_bf16 v[112:115], a[116:119], a[156:159], v[112:115]
buffer_load_dwordx4 v59, s[4:7], s55 offen offset:1024  lds
v_mfma_f32_16x16x32_bf16 v[144:147], a[112:115], a[160:163], 0
v_accvgpr_write_b32 a52, 0
v_accvgpr_write_b32 a53, 0
v_mfma_f32_16x16x32_bf16 v[144:147], a[116:119], a[164:167], v[144:147]
v_accvgpr_write_b32 a54, 0
v_accvgpr_write_b32 a55, 0
v_mfma_f32_16x16x32_bf16 v[176:179], a[112:115], a[168:171], 0
buffer_load_dwordx4 v60, s[4:7], s55 offen offset:2048  lds
v_mfma_f32_16x16x32_bf16 v[176:179], a[116:119], a[172:175], v[176:179]
v_accvgpr_write_b32 a56, 0
v_accvgpr_write_b32 a57, 0
v_mfma_f32_16x16x32_bf16 v[208:211], a[112:115], a[176:179], 0
v_accvgpr_write_b32 a58, 0
v_accvgpr_write_b32 a59, 0
v_mfma_f32_16x16x32_bf16 v[208:211], a[116:119], a[180:183], v[208:211]
buffer_load_dwordx4 v61, s[4:7], s55 offen offset:3072  lds
v_mfma_f32_16x16x32_bf16 v[240:243], a[112:115], a[184:187], 0
s_add_u32 m0, s48, 118784
v_accvgpr_write_b32 a60, 0
v_accvgpr_write_b32 a61, 0
v_mfma_f32_16x16x32_bf16 v[240:243], a[116:119], a[188:191], v[240:243]
ds_read_b64_tr_b16 a[112:113], v42 offset:0
ds_read_b64_tr_b16 a[114:115], v42 offset:1024
v_mfma_f32_16x16x32_bf16 v[84:87], a[120:123], a[144:147], 0
ds_read_b64_tr_b16 a[116:117], v42 offset:8192
ds_read_b64_tr_b16 a[118:119], v42 offset:9216
v_mfma_f32_16x16x32_bf16 v[84:87], a[124:127], a[148:151], v[84:87]
s_add_u32 s55, s50, 40960
v_accvgpr_write_b32 a62, 0
v_accvgpr_write_b32 a63, 0
v_mfma_f32_16x16x32_bf16 v[116:119], a[120:123], a[152:155], 0
v_accvgpr_write_b32 a64, 0
v_accvgpr_write_b32 a65, 0
v_mfma_f32_16x16x32_bf16 v[116:119], a[124:127], a[156:159], v[116:119]
buffer_load_dwordx4 v58, s[4:7], s55 offen offset:0  lds
v_mfma_f32_16x16x32_bf16 v[148:151], a[120:123], a[160:163], 0
v_accvgpr_write_b32 a66, 0
v_accvgpr_write_b32 a67, 0
v_mfma_f32_16x16x32_bf16 v[148:151], a[124:127], a[164:167], v[148:151]
v_accvgpr_write_b32 a68, 0
v_accvgpr_write_b32 a69, 0
v_mfma_f32_16x16x32_bf16 v[180:183], a[120:123], a[168:171], 0
buffer_load_dwordx4 v59, s[4:7], s55 offen offset:1024  lds
v_mfma_f32_16x16x32_bf16 v[180:183], a[124:127], a[172:175], v[180:183]
s_add_u32 s50, s50, 128
v_accvgpr_write_b32 a70, 0
v_accvgpr_write_b32 a71, 0
v_mfma_f32_16x16x32_bf16 v[212:215], a[120:123], a[176:179], 0
s_cmp_eq_u32 s50, s96
s_cselect_b32 s50, s49, s50
v_accvgpr_write_b32 a72, 0
v_accvgpr_write_b32 a73, 0
v_mfma_f32_16x16x32_bf16 v[212:215], a[124:127], a[180:183], v[212:215]
s_add_u32 m0, s54, 32768
v_accvgpr_write_b32 a74, 0
v_accvgpr_write_b32 a75, 0
v_mfma_f32_16x16x32_bf16 v[244:247], a[120:123], a[184:187], 0
s_add_u32 s55, s51, 0
v_accvgpr_write_b32 a76, 0
v_accvgpr_write_b32 a77, 0
v_mfma_f32_16x16x32_bf16 v[244:247], a[124:127], a[188:191], v[244:247]
ds_read_b64_tr_b16 a[120:121], v42 offset:8
ds_read_b64_tr_b16 a[122:123], v42 offset:1032
v_mfma_f32_16x16x32_bf16 v[88:91], a[128:131], a[144:147], 0
ds_read_b64_tr_b16 a[124:125], v42 offset:8200
ds_read_b64_tr_b16 a[126:127], v42 offset:9224
v_mfma_f32_16x16x32_bf16 v[88:91], a[132:135], a[148:151], v[88:91]
v_accvgpr_write_b32 a78, 0
v_accvgpr_write_b32 a79, 0
v_mfma_f32_16x16x32_bf16 v[120:123], a[128:131], a[152:155], 0
v_mfma_f32_16x16x32_bf16 v[120:123], a[132:135], a[156:159], v[120:123]
buffer_load_dwordx4 v6, s[8:11], s55 offen offset:0  lds
v_mfma_f32_16x16x32_bf16 v[152:155], a[128:131], a[160:163], 0
v_mfma_f32_16x16x32_bf16 v[152:155], a[132:135], a[164:167], v[152:155]
v_mfma_f32_16x16x32_bf16 v[184:187], a[128:131], a[168:171], 0
buffer_load_dwordx4 v7, s[8:11], s55 offen offset:1024  lds
v_mfma_f32_16x16x32_bf16 v[184:187], a[132:135], a[172:175], v[184:187]
v_mfma_f32_16x16x32_bf16 v[216:219], a[128:131], a[176:179], 0
v_mfma_f32_16x16x32_bf16 v[216:219], a[132:135], a[180:183], v[216:219]
buffer_load_dwordx4 v8, s[8:11], s55 offen offset:2048  lds
v_mfma_f32_16x16x32_bf16 v[248:251], a[128:131], a[184:187], 0
v_mfma_f32_16x16x32_bf16 v[248:251], a[132:135], a[188:191], v[248:251]
ds_read_b64_tr_b16 a[128:129], v43 offset:0
ds_read_b64_tr_b16 a[130:131], v43 offset:1024
v_mfma_f32_16x16x32_bf16 v[92:95], a[136:139], a[144:147], 0
ds_read_b64_tr_b16 a[132:133], v43 offset:8192
ds_read_b64_tr_b16 a[134:135], v43 offset:9216
v_mfma_f32_16x16x32_bf16 v[92:95], a[140:143], a[148:151], v[92:95]
v_mfma_f32_16x16x32_bf16 v[124:127], a[136:139], a[152:155], 0
v_mfma_f32_16x16x32_bf16 v[124:127], a[140:143], a[156:159], v[124:127]
buffer_load_dwordx4 v9, s[8:11], s55 offen offset:3072  lds
v_mfma_f32_16x16x32_bf16 v[156:159], a[136:139], a[160:163], 0
s_add_u32 m0, s54, 36864
v_mfma_f32_16x16x32_bf16 v[156:159], a[140:143], a[164:167], v[156:159]
s_add_u32 s55, s51, 131072
v_mfma_f32_16x16x32_bf16 v[188:191], a[136:139], a[168:171], 0
buffer_load_dwordx4 v6, s[8:11], s55 offen offset:0  lds
v_mfma_f32_16x16x32_bf16 v[188:191], a[140:143], a[172:175], v[188:191]
v_mfma_f32_16x16x32_bf16 v[220:223], a[136:139], a[176:179], 0
v_mfma_f32_16x16x32_bf16 v[220:223], a[140:143], a[180:183], v[220:223]
buffer_load_dwordx4 v7, s[8:11], s55 offen offset:1024  lds
v_mfma_f32_16x16x32_bf16 v[252:255], a[136:139], a[184:187], 0
v_mfma_f32_16x16x32_bf16 v[252:255], a[140:143], a[188:191], v[252:255]
ds_read_b64_tr_b16 a[136:137], v43 offset:8
ds_read_b64_tr_b16 a[138:139], v43 offset:1032
ds_read_b64_tr_b16 a[140:141], v43 offset:8200
ds_read_b64_tr_b16 a[142:143], v43 offset:9224
s_waitcnt lgkmcnt(15)
v_mfma_f32_16x16x32_bf16 v[64:67], a[80:83], a[192:195], v[64:67]
buffer_load_dwordx4 v8, s[8:11], s55 offen offset:2048  lds
v_mfma_f32_16x16x32_bf16 v[64:67], a[84:87], a[196:199], v[64:67]
v_mfma_f32_16x16x32_bf16 v[96:99], a[80:83], a[200:203], v[96:99]
v_mfma_f32_16x16x32_bf16 v[96:99], a[84:87], a[204:207], v[96:99]
buffer_load_dwordx4 v9, s[8:11], s55 offen offset:3072  lds
v_mfma_f32_16x16x32_bf16 v[128:131], a[80:83], a[208:211], v[128:131]
s_add_u32 s51, s51, 0x80000
v_mfma_f32_16x16x32_bf16 v[128:131], a[84:87], a[212:215], v[128:131]
s_cmp_eq_u32 s51, s97
s_cselect_b32 s51, s53, s51
v_mfma_f32_16x16x32_bf16 v[160:163], a[80:83], a[216:219], v[160:163]
v_mfma_f32_16x16x32_bf16 v[160:163], a[84:87], a[220:223], v[160:163]
v_mfma_f32_16x16x32_bf16 v[192:195], a[80:83], a[224:227], v[192:195]
v_mfma_f32_16x16x32_bf16 v[192:195], a[84:87], a[228:231], v[192:195]
v_mfma_f32_16x16x32_bf16 v[224:227], a[80:83], a[232:235], v[224:227]
s_waitcnt vmcnt(8) lgkmcnt(0)
v_mfma_f32_16x16x32_bf16 v[224:227], a[84:87], a[236:239], v[224:227]
s_barrier
v_mfma_f32_16x16x32_bf16 v[68:71], a[88:91], a[192:195], v[68:71]
ds_read_b64_tr_b16 a[80:81], v40 offset:16384
ds_read_b64_tr_b16 a[82:83], v40 offset:17408
v_mfma_f32_16x16x32_bf16 v[68:71], a[92:95], a[196:199], v[68:71]
ds_read_b64_tr_b16 a[84:85], v40 offset:24576
ds_read_b64_tr_b16 a[86:87], v40 offset:25600
v_mfma_f32_16x16x32_bf16 v[100:103], a[88:91], a[200:203], v[100:103]
ds_read_b128 a[144:147], v52 offset:0
ds_read_b128 a[148:151], v53 offset:0
v_mfma_f32_16x16x32_bf16 v[100:103], a[92:95], a[204:207], v[100:103]
ds_read_b128 a[152:155], v52 offset:2048
ds_read_b128 a[156:159], v53 offset:2048
v_mfma_f32_16x16x32_bf16 v[132:135], a[88:91], a[208:211], v[132:135]
ds_read_b128 a[160:163], v52 offset:4096
ds_read_b128 a[164:167], v53 offset:4096
v_mfma_f32_16x16x32_bf16 v[132:135], a[92:95], a[212:215], v[132:135]
ds_read_b128 a[168:171], v52 offset:6144
ds_read_b128 a[172:175], v53 offset:6144
v_mfma_f32_16x16x32_bf16 v[164:167], a[88:91], a[216:219], v[164:167]
ds_read_b128 a[176:179], v52 offset:8192
ds_read_b128 a[180:183], v53 offset:8192
v_mfma_f32_16x16x32_bf16 v[164:167], a[92:95], a[220:223], v[164:167]
ds_read_b128 a[184:187], v52 offset:10240
ds_read_b128 a[188:191], v53 offset:10240
v_mfma_f32_16x16x32_bf16 v[196:199], a[88:91], a[224:227], v[196:199]
s_add_u32 m0, s48, 139264
v_mfma_f32_16x16x32_bf16 v[196:199], a[92:95], a[228:231], v[196:199]
s_add_u32 s55, s50, 0
v_mfma_f32_16x16x32_bf16 v[228:231], a[88:91], a[232:235], v[228:231]
v_mfma_f32_16x16x32_bf16 v[228:231], a[92:95], a[236:239], v[228:231]
ds_read_b64_tr_b16 a[88:89], v40 offset:16392
ds_read_b64_tr_b16 a[90:91], v40 offset:17416
v_mfma_f32_16x16x32_bf16 v[72:75], a[96:99], a[192:195], v[72:75]
ds_read_b64_tr_b16 a[92:93], v40 offset:24584
ds_read_b64_tr_b16 a[94:95], v40 offset:25608
v_mfma_f32_16x16x32_bf16 v[72:75], a[100:103], a[196:199], v[72:75]
v_mfma_f32_16x16x32_bf16 v[104:107], a[96:99], a[200:203], v[104:107]
v_mfma_f32_16x16x32_bf16 v[104:107], a[100:103], a[204:207], v[104:107]
buffer_load_dwordx4 v58, s[4:7], s55 offen offset:0  lds
v_mfma_f32_16x16x32_bf16 v[136:139], a[96:99], a[208:211], v[136:139]
v_mfma_f32_16x16x32_bf16 v[136:139], a[100:103], a[212:215], v[136:139]
v_mfma_f32_16x16x32_bf16 v[168:171], a[96:99], a[216:219], v[168:171]
buffer_load_dwordx4 v59, s[4:7], s55 offen offset:1024  lds
v_mfma_f32_16x16x32_bf16 v[168:171], a[100:103], a[220:223], v[168:171]
v_mfma_f32_16x16x32_bf16 v[200:203], a[96:99], a[224:227], v[200:203]
v_mfma_f32_16x16x32_bf16 v[200:203], a[100:103], a[228:231], v[200:203]
buffer_load_dwordx4 v60, s[4:7], s55 offen offset:2048  lds
v_mfma_f32_16x16x32_bf16 v[232:235], a[96:99], a[232:235], v[232:235]
v_mfma_f32_16x16x32_bf16 v[232:235], a[100:103], a[236:239], v[232:235]
ds_read_b64_tr_b16 a[96:97], v41 offset:16384
ds_read_b64_tr_b16 a[98:99], v41 offset:17408
v_mfma_f32_16x16x32_bf16 v[76:79], a[104:107], a[192:195], v[76:79]
ds_read_b64_tr_b16 a[100:101], v41 offset:24576
ds_read_b64_tr_b16 a[102:103], v41 offset:25600
v_mfma_f32_16x16x32_bf16 v[76:79], a[108:111], a[196:199], v[76:79]
v_mfma_f32_16x16x32_bf16 v[108:111], a[104:107], a[200:203], v[108:111]
v_mfma_f32_16x16x32_bf16 v[108:111], a[108:111], a[204:207], v[108:111]
buffer_load_dwordx4 v61, s[4:7], s55 offen offset:3072  lds
v_mfma_f32_16x16x32_bf16 v[140:143], a[104:107], a[208:211], v[140:143]
s_add_u32 m0, s48, 143360
v_mfma_f32_16x16x32_bf16 v[140:143], a[108:111], a[212:215], v[140:143]
s_add_u32 s55, s50, 40960
v_mfma_f32_16x16x32_bf16 v[172:175], a[104:107], a[216:219], v[172:175]
buffer_load_dwordx4 v58, s[4:7], s55 offen offset:0  lds
v_mfma_f32_16x16x32_bf16 v[172:175], a[108:111], a[220:223], v[172:175]
v_mfma_f32_16x16x32_bf16 v[204:207], a[104:107], a[224:227], v[204:207]
v_mfma_f32_16x16x32_bf16 v[204:207], a[108:111], a[228:231], v[204:207]
buffer_load_dwordx4 v59, s[4:7], s55 offen offset:1024  lds
v_mfma_f32_16x16x32_bf16 v[236:239], a[104:107], a[232:235], v[236:239]
s_add_u32 s50, s50, 128
v_mfma_f32_16x16x32_bf16 v[236:239], a[108:111], a[236:239], v[236:239]
ds_read_b64_tr_b16 a[104:105], v41 offset:16392
ds_read_b64_tr_b16 a[106:107], v41 offset:17416
v_mfma_f32_16x16x32_bf16 v[80:83], a[112:115], a[192:195], v[80:83]
ds_read_b64_tr_b16 a[108:109], v41 offset:24584
ds_read_b64_tr_b16 a[110:111], v41 offset:25608
v_mfma_f32_16x16x32_bf16 v[80:83], a[116:119], a[196:199], v[80:83]
s_cmp_eq_u32 s50, s96
s_cselect_b32 s50, s49, s50
v_mfma_f32_16x16x32_bf16 v[112:115], a[112:115], a[200:203], v[112:115]
s_add_u32 m0, s54, 0
v_mfma_f32_16x16x32_bf16 v[112:115], a[116:119], a[204:207], v[112:115]
s_add_u32 s55, s51, 0
v_mfma_f32_16x16x32_bf16 v[144:147], a[112:115], a[208:211], v[144:147]
v_mfma_f32_16x16x32_bf16 v[144:147], a[116:119], a[212:215], v[144:147]
v_mfma_f32_16x16x32_bf16 v[176:179], a[112:115], a[216:219], v[176:179]
buffer_load_dwordx4 v6, s[8:11], s55 offen offset:0  lds
v_mfma_f32_16x16x32_bf16 v[176:179], a[116:119], a[220:223], v[176:179]
v_mfma_f32_16x16x32_bf16 v[208:211], a[112:115], a[224:227], v[208:211]
v_mfma_f32_16x16x32_bf16 v[208:211], a[116:119], a[228:231], v[208:211]
buffer_load_dwordx4 v7, s[8:11], s55 offen offset:1024  lds
v_mfma_f32_16x16x32_bf16 v[240:243], a[112:115], a[232:235], v[240:243]
v_mfma_f32_16x16x32_bf16 v[240:243], a[116:119], a[236:239], v[240:243]
ds_read_b64_tr_b16 a[112:113], v42 offset:16384
ds_read_b64_tr_b16 a[114:115], v42 offset:17408
v_mfma_f32_16x16x32_bf16 v[84:87], a[120:123], a[192:195], v[84:87]
ds_read_b64_tr_b16 a[116:117], v42 offset:24576
ds_read_b64_tr_b16 a[118:119], v42 offset:25600
v_mfma_f32_16x16x32_bf16 v[84:87], a[124:127], a[196:199], v[84:87]
v_mfma_f32_16x16x32_bf16 v[116:119], a[120:123], a[200:203], v[116:119]
v_mfma_f32_16x16x32_bf16 v[116:119], a[124:127], a[204:207], v[116:119]
buffer_load_dwordx4 v8, s[8:11], s55 offen offset:2048  lds
v_mfma_f32_16x16x32_bf16 v[148:151], a[120:123], a[208:211], v[148:151]
v_mfma_f32_16x16x32_bf16 v[148:151], a[124:127], a[212:215], v[148:151]
v_mfma_f32_16x16x32_bf16 v[180:183], a[120:123], a[216:219], v[180:183]
buffer_load_dwordx4 v9, s[8:11], s55 offen offset:3072  lds
v_mfma_f32_16x16x32_bf16 v[180:183], a[124:127], a[220:223], v[180:183]
s_add_u32 m0, s54, 4096
v_mfma_f32_16x16x32_bf16 v[212:215], a[120:123], a[224:227], v[212:215]
s_add_u32 s55, s51, 131072
v_mfma_f32_16x16x32_bf16 v[212:215], a[124:127], a[228:231], v[212:215]
buffer_load_dwordx4 v6, s[8:11], s55 offen offset:0  lds
v_mfma_f32_16x16x32_bf16 v[244:247], a[120:123], a[232:235], v[244:247]
v_mfma_f32_16x16x32_bf16 v[244:247], a[124:127], a[236:239], v[244:247]
ds_read_b64_tr_b16 a[120:121], v42 offset:16392
ds_read_b64_tr_b16 a[122:123], v42 offset:17416
v_mfma_f32_16x16x32_bf16 v[88:91], a[128:131], a[192:195], v[88:91]
ds_read_b64_tr_b16 a[124:125], v42 offset:24584
ds_read_b64_tr_b16 a[126:127], v42 offset:25608
v_mfma_f32_16x16x32_bf16 v[88:91], a[132:135], a[196:199], v[88:91]
v_mfma_f32_16x16x32_bf16 v[120:123], a[128:131], a[200:203], v[120:123]
v_mfma_f32_16x16x32_bf16 v[120:123], a[132:135], a[204:207], v[120:123]
buffer_load_dwordx4 v7, s[8:11], s55 offen offset:1024  lds
v_mfma_f32_16x16x32_bf16 v[152:155], a[128:131], a[208:211], v[152:155]
v_mfma_f32_16x16x32_bf16 v[152:155], a[132:135], a[212:215], v[152:155]
v_mfma_f32_16x16x32_bf16 v[184:187], a[128:131], a[216:219], v[184:187]
buffer_load_dwordx4 v8, s[8:11], s55 offen offset:2048  lds
v_mfma_f32_16x16x32_bf16 v[184:187], a[132:135], a[220:223], v[184:187]
v_mfma_f32_16x16x32_bf16 v[216:219], a[128:131], a[224:227], v[216:219]
v_mfma_f32_16x16x32_bf16 v[216:219], a[132:135], a[228:231], v[216:219]
buffer_load_dwordx4 v9, s[8:11], s55 offen offset:3072  lds
v_mfma_f32_16x16x32_bf16 v[248:251], a[128:131], a[232:235], v[248:251]
s_add_u32 s51, s51, 0x80000
v_mfma_f32_16x16x32_bf16 v[248:251], a[132:135], a[236:239], v[248:251]
ds_read_b64_tr_b16 a[128:129], v43 offset:16384
ds_read_b64_tr_b16 a[130:131], v43 offset:17408
v_mfma_f32_16x16x32_bf16 v[92:95], a[136:139], a[192:195], v[92:95]
ds_read_b64_tr_b16 a[132:133], v43 offset:24576
ds_read_b64_tr_b16 a[134:135], v43 offset:25600
v_mfma_f32_16x16x32_bf16 v[92:95], a[140:143], a[196:199], v[92:95]
s_cmp_eq_u32 s51, s97
s_cselect_b32 s51, s53, s51
v_mfma_f32_16x16x32_bf16 v[124:127], a[136:139], a[200:203], v[124:127]
v_mfma_f32_16x16x32_bf16 v[124:127], a[140:143], a[204:207], v[124:127]
v_mfma_f32_16x16x32_bf16 v[156:159], a[136:139], a[208:211], v[156:159]
v_mfma_f32_16x16x32_bf16 v[156:159], a[140:143], a[212:215], v[156:159]
v_mfma_f32_16x16x32_bf16 v[188:191], a[136:139], a[216:219], v[188:191]
v_mfma_f32_16x16x32_bf16 v[188:191], a[140:143], a[220:223], v[188:191]
v_mfma_f32_16x16x32_bf16 v[220:223], a[136:139], a[224:227], v[220:223]
v_mfma_f32_16x16x32_bf16 v[220:223], a[140:143], a[228:231], v[220:223]
v_mfma_f32_16x16x32_bf16 v[252:255], a[136:139], a[232:235], v[252:255]
v_mfma_f32_16x16x32_bf16 v[252:255], a[140:143], a[236:239], v[252:255]
ds_read_b64_tr_b16 a[136:137], v43 offset:16392
ds_read_b64_tr_b16 a[138:139], v43 offset:17416
ds_read_b64_tr_b16 a[140:141], v43 offset:24584
ds_read_b64_tr_b16 a[142:143], v43 offset:25608
s_waitcnt lgkmcnt(15)
v_mfma_f32_16x16x32_bf16 v[64:67], a[80:83], a[144:147], v[64:67]
v_mfma_f32_16x16x32_bf16 v[64:67], a[84:87], a[148:151], v[64:67]
v_mfma_f32_16x16x32_bf16 v[96:99], a[80:83], a[152:155], v[96:99]
v_mfma_f32_16x16x32_bf16 v[96:99], a[84:87], a[156:159], v[96:99]
v_mfma_f32_16x16x32_bf16 v[128:131], a[80:83], a[160:163], v[128:131]
v_mfma_f32_16x16x32_bf16 v[128:131], a[84:87], a[164:167], v[128:131]
v_mfma_f32_16x16x32_bf16 v[160:163], a[80:83], a[168:171], v[160:163]
v_mfma_f32_16x16x32_bf16 v[160:163], a[84:87], a[172:175], v[160:163]
v_mfma_f32_16x16x32_bf16 v[192:195], a[80:83], a[176:179], v[192:195]
v_mfma_f32_16x16x32_bf16 v[192:195], a[84:87], a[180:183], v[192:195]
v_mfma_f32_16x16x32_bf16 v[224:227], a[80:83], a[184:187], v[224:227]
s_waitcnt vmcnt(8) lgkmcnt(0)
v_mfma_f32_16x16x32_bf16 v[224:227], a[84:87], a[188:191], v[224:227]
s_barrier
v_mfma_f32_16x16x32_bf16 v[68:71], a[88:91], a[144:147], v[68:71]
ds_read_b64_tr_b16 a[80:81], v40 offset:32768
ds_read_b64_tr_b16 a[82:83], v40 offset:33792
v_mfma_f32_16x16x32_bf16 v[68:71], a[92:95], a[148:151], v[68:71]
ds_read_b64_tr_b16 a[84:85], v40 offset:40960
ds_read_b64_tr_b16 a[86:87], v40 offset:41984
v_mfma_f32_16x16x32_bf16 v[100:103], a[88:91], a[152:155], v[100:103]
ds_read_b128 a[192:195], v52 offset:24576
ds_read_b128 a[196:199], v53 offset:24576
v_mfma_f32_16x16x32_bf16 v[100:103], a[92:95], a[156:159], v[100:103]
ds_read_b128 a[200:203], v52 offset:26624
ds_read_b128 a[204:207], v53 offset:26624
v_mfma_f32_16x16x32_bf16 v[132:135], a[88:91], a[160:163], v[132:135]
ds_read_b128 a[208:211], v52 offset:28672
ds_read_b128 a[212:215], v53 offset:28672
v_mfma_f32_16x16x32_bf16 v[132:135], a[92:95], a[164:167], v[132:135]
ds_read_b128 a[216:219], v52 offset:30720
ds_read_b128 a[220:223], v53 offset:30720
v_mfma_f32_16x16x32_bf16 v[164:167], a[88:91], a[168:171], v[164:167]
ds_read_b128 a[224:227], v52 offset:32768
ds_read_b128 a[228:231], v53 offset:32768
v_mfma_f32_16x16x32_bf16 v[164:167], a[92:95], a[172:175], v[164:167]
ds_read_b128 a[232:235], v52 offset:34816
ds_read_b128 a[236:239], v53 offset:34816
v_mfma_f32_16x16x32_bf16 v[196:199], a[88:91], a[176:179], v[196:199]
s_add_u32 m0, s48, 114688
v_mfma_f32_16x16x32_bf16 v[196:199], a[92:95], a[180:183], v[196:199]
s_add_u32 s55, s50, 0
v_mfma_f32_16x16x32_bf16 v[228:231], a[88:91], a[184:187], v[228:231]
v_mfma_f32_16x16x32_bf16 v[228:231], a[92:95], a[188:191], v[228:231]
ds_read_b64_tr_b16 a[88:89], v40 offset:32776
ds_read_b64_tr_b16 a[90:91], v40 offset:33800
v_mfma_f32_16x16x32_bf16 v[72:75], a[96:99], a[144:147], v[72:75]
ds_read_b64_tr_b16 a[92:93], v40 offset:40968
ds_read_b64_tr_b16 a[94:95], v40 offset:41992
v_mfma_f32_16x16x32_bf16 v[72:75], a[100:103], a[148:151], v[72:75]
v_mfma_f32_16x16x32_bf16 v[104:107], a[96:99], a[152:155], v[104:107]
v_mfma_f32_16x16x32_bf16 v[104:107], a[100:103], a[156:159], v[104:107]
buffer_load_dwordx4 v58, s[4:7], s55 offen offset:0  lds
v_mfma_f32_16x16x32_bf16 v[136:139], a[96:99], a[160:163], v[136:139]
v_mfma_f32_16x16x32_bf16 v[136:139], a[100:103], a[164:167], v[136:139]
v_mfma_f32_16x16x32_bf16 v[168:171], a[96:99], a[168:171], v[168:171]
buffer_load_dwordx4 v59, s[4:7], s55 offen offset:1024  lds
v_mfma_f32_16x16x32_bf16 v[168:171], a[100:103], a[172:175], v[168:171]
v_mfma_f32_16x16x32_bf16 v[200:203], a[96:99], a[176:179], v[200:203]
v_mfma_f32_16x16x32_bf16 v[200:203], a[100:103], a[180:183], v[200:203]
buffer_load_dwordx4 v60, s[4:7], s55 offen offset:2048  lds
v_mfma_f32_16x16x32_bf16 v[232:235], a[96:99], a[184:187], v[232:235]
v_mfma_f32_16x16x32_bf16 v[232:235], a[100:103], a[188:191], v[232:235]
ds_read_b64_tr_b16 a[96:97], v41 offset:32768
ds_read_b64_tr_b16 a[98:99], v41 offset:33792
v_mfma_f32_16x16x32_bf16 v[76:79], a[104:107], a[144:147], v[76:79]
ds_read_b64_tr_b16 a[100:101], v41 offset:40960
ds_read_b64_tr_b16 a[102:103], v41 offset:41984
v_mfma_f32_16x16x32_bf16 v[76:79], a[108:111], a[148:151], v[76:79]
v_mfma_f32_16x16x32_bf16 v[108:111], a[104:107], a[152:155], v[108:111]
v_mfma_f32_16x16x32_bf16 v[108:111], a[108:111], a[156:159], v[108:111]
buffer_load_dwordx4 v61, s[4:7], s55 offen offset:3072  lds
v_mfma_f32_16x16x32_bf16 v[140:143], a[104:107], a[160:163], v[140:143]
s_add_u32 m0, s48, 118784
v_mfma_f32_16x16x32_bf16 v[140:143], a[108:111], a[164:167], v[140:143]
s_add_u32 s55, s50, 40960
v_mfma_f32_16x16x32_bf16 v[172:175], a[104:107], a[168:171], v[172:175]
buffer_load_dwordx4 v58, s[4:7], s55 offen offset:0  lds
v_mfma_f32_16x16x32_bf16 v[172:175], a[108:111], a[172:175], v[172:175]
v_mfma_f32_16x16x32_bf16 v[204:207], a[104:107], a[176:179], v[204:207]
v_mfma_f32_16x16x32_bf16 v[204:207], a[108:111], a[180:183], v[204:207]
buffer_load_dwordx4 v59, s[4:7], s55 offen offset:1024  lds
v_mfma_f32_16x16x32_bf16 v[236:239], a[104:107], a[184:187], v[236:239]
s_add_u32 s50, s50, 128
v_mfma_f32_16x16x32_bf16 v[236:239], a[108:111], a[188:191], v[236:239]
ds_read_b64_tr_b16 a[104:105], v41 offset:32776
ds_read_b64_tr_b16 a[106:107], v41 offset:33800
v_mfma_f32_16x16x32_bf16 v[80:83], a[112:115], a[144:147], v[80:83]
ds_read_b64_tr_b16 a[108:109], v41 offset:40968
ds_read_b64_tr_b16 a[110:111], v41 offset:41992
v_mfma_f32_16x16x32_bf16 v[80:83], a[116:119], a[148:151], v[80:83]
s_cmp_eq_u32 s50, s96
s_cselect_b32 s50, s49, s50
v_mfma_f32_16x16x32_bf16 v[112:115], a[112:115], a[152:155], v[112:115]
s_add_u32 m0, s54, 16384
v_mfma_f32_16x16x32_bf16 v[112:115], a[116:119], a[156:159], v[112:115]
s_add_u32 s55, s51, 0
v_mfma_f32_16x16x32_bf16 v[144:147], a[112:115], a[160:163], v[144:147]
v_mfma_f32_16x16x32_bf16 v[144:147], a[116:119], a[164:167], v[144:147]
v_mfma_f32_16x16x32_bf16 v[176:179], a[112:115], a[168:171], v[176:179]
buffer_load_dwordx4 v6, s[8:11], s55 offen offset:0  lds
v_mfma_f32_16x16x32_bf16 v[176:179], a[116:119], a[172:175], v[176:179]
v_mfma_f32_16x16x32_bf16 v[208:211], a[112:115], a[176:179], v[208:211]
v_mfma_f32_16x16x32_bf16 v[208:211], a[116:119], a[180:183], v[208:211]
buffer_load_dwordx4 v7, s[8:11], s55 offen offset:1024  lds
v_mfma_f32_16x16x32_bf16 v[240:243], a[112:115], a[184:187], v[240:243]
v_mfma_f32_16x16x32_bf16 v[240:243], a[116:119], a[188:191], v[240:243]
ds_read_b64_tr_b16 a[112:113], v42 offset:32768
ds_read_b64_tr_b16 a[114:115], v42 offset:33792
v_mfma_f32_16x16x32_bf16 v[84:87], a[120:123], a[144:147], v[84:87]
ds_read_b64_tr_b16 a[116:117], v42 offset:40960
ds_read_b64_tr_b16 a[118:119], v42 offset:41984
v_mfma_f32_16x16x32_bf16 v[84:87], a[124:127], a[148:151], v[84:87]
v_mfma_f32_16x16x32_bf16 v[116:119], a[120:123], a[152:155], v[116:119]
v_mfma_f32_16x16x32_bf16 v[116:119], a[124:127], a[156:159], v[116:119]
buffer_load_dwordx4 v8, s[8:11], s55 offen offset:2048  lds
v_mfma_f32_16x16x32_bf16 v[148:151], a[120:123], a[160:163], v[148:151]
v_mfma_f32_16x16x32_bf16 v[148:151], a[124:127], a[164:167], v[148:151]
v_mfma_f32_16x16x32_bf16 v[180:183], a[120:123], a[168:171], v[180:183]
buffer_load_dwordx4 v9, s[8:11], s55 offen offset:3072  lds
v_mfma_f32_16x16x32_bf16 v[180:183], a[124:127], a[172:175], v[180:183]
s_add_u32 m0, s54, 20480
v_mfma_f32_16x16x32_bf16 v[212:215], a[120:123], a[176:179], v[212:215]
s_add_u32 s55, s51, 131072
v_mfma_f32_16x16x32_bf16 v[212:215], a[124:127], a[180:183], v[212:215]
buffer_load_dwordx4 v6, s[8:11], s55 offen offset:0  lds
v_mfma_f32_16x16x32_bf16 v[244:247], a[120:123], a[184:187], v[244:247]
v_mfma_f32_16x16x32_bf16 v[244:247], a[124:127], a[188:191], v[244:247]
ds_read_b64_tr_b16 a[120:121], v42 offset:32776
ds_read_b64_tr_b16 a[122:123], v42 offset:33800
v_mfma_f32_16x16x32_bf16 v[88:91], a[128:131], a[144:147], v[88:91]
ds_read_b64_tr_b16 a[124:125], v42 offset:40968
ds_read_b64_tr_b16 a[126:127], v42 offset:41992
v_mfma_f32_16x16x32_bf16 v[88:91], a[132:135], a[148:151], v[88:91]
v_mfma_f32_16x16x32_bf16 v[120:123], a[128:131], a[152:155], v[120:123]
v_mfma_f32_16x16x32_bf16 v[120:123], a[132:135], a[156:159], v[120:123]
buffer_load_dwordx4 v7, s[8:11], s55 offen offset:1024  lds
v_mfma_f32_16x16x32_bf16 v[152:155], a[128:131], a[160:163], v[152:155]
v_mfma_f32_16x16x32_bf16 v[152:155], a[132:135], a[164:167], v[152:155]
v_mfma_f32_16x16x32_bf16 v[184:187], a[128:131], a[168:171], v[184:187]
buffer_load_dwordx4 v8, s[8:11], s55 offen offset:2048  lds
v_mfma_f32_16x16x32_bf16 v[184:187], a[132:135], a[172:175], v[184:187]
v_mfma_f32_16x16x32_bf16 v[216:219], a[128:131], a[176:179], v[216:219]
v_mfma_f32_16x16x32_bf16 v[216:219], a[132:135], a[180:183], v[216:219]
buffer_load_dwordx4 v9, s[8:11], s55 offen offset:3072  lds
v_mfma_f32_16x16x32_bf16 v[248:251], a[128:131], a[184:187], v[248:251]
s_add_u32 s51, s51, 0x80000
v_mfma_f32_16x16x32_bf16 v[248:251], a[132:135], a[188:191], v[248:251]
ds_read_b64_tr_b16 a[128:129], v43 offset:32768
ds_read_b64_tr_b16 a[130:131], v43 offset:33792
v_mfma_f32_16x16x32_bf16 v[92:95], a[136:139], a[144:147], v[92:95]
ds_read_b64_tr_b16 a[132:133], v43 offset:40960
ds_read_b64_tr_b16 a[134:135], v43 offset:41984
v_mfma_f32_16x16x32_bf16 v[92:95], a[140:143], a[148:151], v[92:95]
s_cmp_eq_u32 s51, s97
s_cselect_b32 s51, s53, s51
v_mfma_f32_16x16x32_bf16 v[124:127], a[136:139], a[152:155], v[124:127]
v_mfma_f32_16x16x32_bf16 v[124:127], a[140:143], a[156:159], v[124:127]
v_mfma_f32_16x16x32_bf16 v[156:159], a[136:139], a[160:163], v[156:159]
v_mfma_f32_16x16x32_bf16 v[156:159], a[140:143], a[164:167], v[156:159]
v_mfma_f32_16x16x32_bf16 v[188:191], a[136:139], a[168:171], v[188:191]
v_mfma_f32_16x16x32_bf16 v[188:191], a[140:143], a[172:175], v[188:191]
v_mfma_f32_16x16x32_bf16 v[220:223], a[136:139], a[176:179], v[220:223]
v_mfma_f32_16x16x32_bf16 v[220:223], a[140:143], a[180:183], v[220:223]
v_mfma_f32_16x16x32_bf16 v[252:255], a[136:139], a[184:187], v[252:255]
v_mfma_f32_16x16x32_bf16 v[252:255], a[140:143], a[188:191], v[252:255]
ds_read_b64_tr_b16 a[136:137], v43 offset:32776
ds_read_b64_tr_b16 a[138:139], v43 offset:33800
ds_read_b64_tr_b16 a[140:141], v43 offset:40968
ds_read_b64_tr_b16 a[142:143], v43 offset:41992
s_waitcnt lgkmcnt(15)
v_mfma_f32_16x16x32_bf16 v[64:67], a[80:83], a[192:195], v[64:67]
v_mfma_f32_16x16x32_bf16 v[64:67], a[84:87], a[196:199], v[64:67]
v_mfma_f32_16x16x32_bf16 v[96:99], a[80:83], a[200:203], v[96:99]
v_mfma_f32_16x16x32_bf16 v[96:99], a[84:87], a[204:207], v[96:99]
v_mfma_f32_16x16x32_bf16 v[128:131], a[80:83], a[208:211], v[128:131]
v_mfma_f32_16x16x32_bf16 v[128:131], a[84:87], a[212:215], v[128:131]
v_mfma_f32_16x16x32_bf16 v[160:163], a[80:83], a[216:219], v[160:163]
v_mfma_f32_16x16x32_bf16 v[160:163], a[84:87], a[220:223], v[160:163]
v_mfma_f32_16x16x32_bf16 v[192:195], a[80:83], a[224:227], v[192:195]
v_mfma_f32_16x16x32_bf16 v[192:195], a[84:87], a[228:231], v[192:195]
v_mfma_f32_16x16x32_bf16 v[224:227], a[80:83], a[232:235], v[224:227]
s_waitcnt vmcnt(8) lgkmcnt(0)
v_mfma_f32_16x16x32_bf16 v[224:227], a[84:87], a[236:239], v[224:227]
s_barrier
v_mfma_f32_16x16x32_bf16 v[68:71], a[88:91], a[192:195], v[68:71]
ds_read_b64_tr_b16 a[80:81], v40 offset:0
ds_read_b64_tr_b16 a[82:83], v40 offset:1024
v_mfma_f32_16x16x32_bf16 v[68:71], a[92:95], a[196:199], v[68:71]
ds_read_b64_tr_b16 a[84:85], v40 offset:8192
ds_read_b64_tr_b16 a[86:87], v40 offset:9216
v_mfma_f32_16x16x32_bf16 v[100:103], a[88:91], a[200:203], v[100:103]
ds_read_b128 a[144:147], v52 offset:0
ds_read_b128 a[148:151], v53 offset:0
v_mfma_f32_16x16x32_bf16 v[100:103], a[92:95], a[204:207], v[100:103]
ds_read_b128 a[152:155], v52 offset:2048
ds_read_b128 a[156:159], v53 offset:2048
v_mfma_f32_16x16x32_bf16 v[132:135], a[88:91], a[208:211], v[132:135]
ds_read_b128 a[160:163], v52 offset:4096
ds_read_b128 a[164:167], v53 offset:4096
v_mfma_f32_16x16x32_bf16 v[132:135], a[92:95], a[212:215], v[132:135]
ds_read_b128 a[168:171], v52 offset:6144
ds_read_b128 a[172:175], v53 offset:6144
v_mfma_f32_16x16x32_bf16 v[164:167], a[88:91], a[216:219], v[164:167]
ds_read_b128 a[176:179], v52 offset:8192
ds_read_b128 a[180:183], v53 offset:8192
v_mfma_f32_16x16x32_bf16 v[164:167], a[92:95], a[220:223], v[164:167]
ds_read_b128 a[184:187], v52 offset:10240
ds_read_b128 a[188:191], v53 offset:10240
v_mfma_f32_16x16x32_bf16 v[196:199], a[88:91], a[224:227], v[196:199]
s_add_u32 m0, s48, 139264
v_mfma_f32_16x16x32_bf16 v[196:199], a[92:95], a[228:231], v[196:199]
s_add_u32 s55, s50, 0
v_mfma_f32_16x16x32_bf16 v[228:231], a[88:91], a[232:235], v[228:231]
v_mfma_f32_16x16x32_bf16 v[228:231], a[92:95], a[236:239], v[228:231]
ds_read_b64_tr_b16 a[88:89], v40 offset:8
ds_read_b64_tr_b16 a[90:91], v40 offset:1032
v_mfma_f32_16x16x32_bf16 v[72:75], a[96:99], a[192:195], v[72:75]
ds_read_b64_tr_b16 a[92:93], v40 offset:8200
ds_read_b64_tr_b16 a[94:95], v40 offset:9224
v_mfma_f32_16x16x32_bf16 v[72:75], a[100:103], a[196:199], v[72:75]
v_mfma_f32_16x16x32_bf16 v[104:107], a[96:99], a[200:203], v[104:107]
v_mfma_f32_16x16x32_bf16 v[104:107], a[100:103], a[204:207], v[104:107]
buffer_load_dwordx4 v58, s[4:7], s55 offen offset:0  lds
v_mfma_f32_16x16x32_bf16 v[136:139], a[96:99], a[208:211], v[136:139]
v_mfma_f32_16x16x32_bf16 v[136:139], a[100:103], a[212:215], v[136:139]
v_mfma_f32_16x16x32_bf16 v[168:171], a[96:99], a[216:219], v[168:171]
buffer_load_dwordx4 v59, s[4:7], s55 offen offset:1024  lds
v_mfma_f32_16x16x32_bf16 v[168:171], a[100:103], a[220:223], v[168:171]
v_mfma_f32_16x16x32_bf16 v[200:203], a[96:99], a[224:227], v[200:203]
v_mfma_f32_16x16x32_bf16 v[200:203], a[100:103], a[228:231], v[200:203]
buffer_load_dwordx4 v60, s[4:7], s55 offen offset:2048  lds
v_mfma_f32_16x16x32_bf16 v[232:235], a[96:99], a[232:235], v[232:235]
v_mfma_f32_16x16x32_bf16 v[232:235], a[100:103], a[236:239], v[232:235]
ds_read_b64_tr_b16 a[96:97], v41 offset:0
ds_read_b64_tr_b16 a[98:99], v41 offset:1024
v_mfma_f32_16x16x32_bf16 v[76:79], a[104:107], a[192:195], v[76:79]
ds_read_b64_tr_b16 a[100:101], v41 offset:8192
ds_read_b64_tr_b16 a[102:103], v41 offset:9216
v_mfma_f32_16x16x32_bf16 v[76:79], a[108:111], a[196:199], v[76:79]
v_mfma_f32_16x16x32_bf16 v[108:111], a[104:107], a[200:203], v[108:111]
v_mfma_f32_16x16x32_bf16 v[108:111], a[108:111], a[204:207], v[108:111]
buffer_load_dwordx4 v61, s[4:7], s55 offen offset:3072  lds
v_mfma_f32_16x16x32_bf16 v[140:143], a[104:107], a[208:211], v[140:143]
s_add_u32 m0, s48, 143360
v_mfma_f32_16x16x32_bf16 v[140:143], a[108:111], a[212:215], v[140:143]
s_add_u32 s55, s50, 40960
v_mfma_f32_16x16x32_bf16 v[172:175], a[104:107], a[216:219], v[172:175]
buffer_load_dwordx4 v58, s[4:7], s55 offen offset:0  lds
v_mfma_f32_16x16x32_bf16 v[172:175], a[108:111], a[220:223], v[172:175]
v_mfma_f32_16x16x32_bf16 v[204:207], a[104:107], a[224:227], v[204:207]
v_mfma_f32_16x16x32_bf16 v[204:207], a[108:111], a[228:231], v[204:207]
buffer_load_dwordx4 v59, s[4:7], s55 offen offset:1024  lds
v_mfma_f32_16x16x32_bf16 v[236:239], a[104:107], a[232:235], v[236:239]
s_add_u32 s50, s50, 128
v_mfma_f32_16x16x32_bf16 v[236:239], a[108:111], a[236:239], v[236:239]
ds_read_b64_tr_b16 a[104:105], v41 offset:8
ds_read_b64_tr_b16 a[106:107], v41 offset:1032
v_mfma_f32_16x16x32_bf16 v[80:83], a[112:115], a[192:195], v[80:83]
ds_read_b64_tr_b16 a[108:109], v41 offset:8200
ds_read_b64_tr_b16 a[110:111], v41 offset:9224
v_mfma_f32_16x16x32_bf16 v[80:83], a[116:119], a[196:199], v[80:83]
s_cmp_eq_u32 s50, s96
s_cselect_b32 s50, s49, s50
v_mfma_f32_16x16x32_bf16 v[112:115], a[112:115], a[200:203], v[112:115]
s_add_u32 m0, s54, 32768
v_mfma_f32_16x16x32_bf16 v[112:115], a[116:119], a[204:207], v[112:115]
s_add_u32 s55, s51, 0
v_mfma_f32_16x16x32_bf16 v[144:147], a[112:115], a[208:211], v[144:147]
v_mfma_f32_16x16x32_bf16 v[144:147], a[116:119], a[212:215], v[144:147]
v_mfma_f32_16x16x32_bf16 v[176:179], a[112:115], a[216:219], v[176:179]
buffer_load_dwordx4 v6, s[8:11], s55 offen offset:0  lds
v_mfma_f32_16x16x32_bf16 v[176:179], a[116:119], a[220:223], v[176:179]
v_mfma_f32_16x16x32_bf16 v[208:211], a[112:115], a[224:227], v[208:211]
v_mfma_f32_16x16x32_bf16 v[208:211], a[116:119], a[228:231], v[208:211]
buffer_load_dwordx4 v7, s[8:11], s55 offen offset:1024  lds
v_mfma_f32_16x16x32_bf16 v[240:243], a[112:115], a[232:235], v[240:243]
v_mfma_f32_16x16x32_bf16 v[240:243], a[116:119], a[236:239], v[240:243]
ds_read_b64_tr_b16 a[112:113], v42 offset:0
ds_read_b64_tr_b16 a[114:115], v42 offset:1024
v_mfma_f32_16x16x32_bf16 v[84:87], a[120:123], a[192:195], v[84:87]
ds_read_b64_tr_b16 a[116:117], v42 offset:8192
ds_read_b64_tr_b16 a[118:119], v42 offset:9216
v_mfma_f32_16x16x32_bf16 v[84:87], a[124:127], a[196:199], v[84:87]
v_mfma_f32_16x16x32_bf16 v[116:119], a[120:123], a[200:203], v[116:119]
v_mfma_f32_16x16x32_bf16 v[116:119], a[124:127], a[204:207], v[116:119]
buffer_load_dwordx4 v8, s[8:11], s55 offen offset:2048  lds
v_mfma_f32_16x16x32_bf16 v[148:151], a[120:123], a[208:211], v[148:151]
v_mfma_f32_16x16x32_bf16 v[148:151], a[124:127], a[212:215], v[148:151]
v_mfma_f32_16x16x32_bf16 v[180:183], a[120:123], a[216:219], v[180:183]
buffer_load_dwordx4 v9, s[8:11], s55 offen offset:3072  lds
v_mfma_f32_16x16x32_bf16 v[180:183], a[124:127], a[220:223], v[180:183]
s_add_u32 m0, s54, 36864
v_mfma_f32_16x16x32_bf16 v[212:215], a[120:123], a[224:227], v[212:215]
s_add_u32 s55, s51, 131072
v_mfma_f32_16x16x32_bf16 v[212:215], a[124:127], a[228:231], v[212:215]
buffer_load_dwordx4 v6, s[8:11], s55 offen offset:0  lds
v_mfma_f32_16x16x32_bf16 v[244:247], a[120:123], a[232:235], v[244:247]
v_mfma_f32_16x16x32_bf16 v[244:247], a[124:127], a[236:239], v[244:247]
ds_read_b64_tr_b16 a[120:121], v42 offset:8
ds_read_b64_tr_b16 a[122:123], v42 offset:1032
v_mfma_f32_16x16x32_bf16 v[88:91], a[128:131], a[192:195], v[88:91]
ds_read_b64_tr_b16 a[124:125], v42 offset:8200
ds_read_b64_tr_b16 a[126:127], v42 offset:9224
v_mfma_f32_16x16x32_bf16 v[88:91], a[132:135], a[196:199], v[88:91]
v_mfma_f32_16x16x32_bf16 v[120:123], a[128:131], a[200:203], v[120:123]
v_mfma_f32_16x16x32_bf16 v[120:123], a[132:135], a[204:207], v[120:123]
buffer_load_dwordx4 v7, s[8:11], s55 offen offset:1024  lds
v_mfma_f32_16x16x32_bf16 v[152:155], a[128:131], a[208:211], v[152:155]
v_mfma_f32_16x16x32_bf16 v[152:155], a[132:135], a[212:215], v[152:155]
v_mfma_f32_16x16x32_bf16 v[184:187], a[128:131], a[216:219], v[184:187]
buffer_load_dwordx4 v8, s[8:11], s55 offen offset:2048  lds
v_mfma_f32_16x16x32_bf16 v[184:187], a[132:135], a[220:223], v[184:187]
v_mfma_f32_16x16x32_bf16 v[216:219], a[128:131], a[224:227], v[216:219]
v_mfma_f32_16x16x32_bf16 v[216:219], a[132:135], a[228:231], v[216:219]
buffer_load_dwordx4 v9, s[8:11], s55 offen offset:3072  lds
v_mfma_f32_16x16x32_bf16 v[248:251], a[128:131], a[232:235], v[248:251]
s_add_u32 s51, s51, 0x80000
v_mfma_f32_16x16x32_bf16 v[248:251], a[132:135], a[236:239], v[248:251]
ds_read_b64_tr_b16 a[128:129], v43 offset:0
ds_read_b64_tr_b16 a[130:131], v43 offset:1024
v_mfma_f32_16x16x32_bf16 v[92:95], a[136:139], a[192:195], v[92:95]
ds_read_b64_tr_b16 a[132:133], v43 offset:8192
ds_read_b64_tr_b16 a[134:135], v43 offset:9216
v_mfma_f32_16x16x32_bf16 v[92:95], a[140:143], a[196:199], v[92:95]
s_cmp_eq_u32 s51, s97
s_cselect_b32 s51, s53, s51
v_mfma_f32_16x16x32_bf16 v[124:127], a[136:139], a[200:203], v[124:127]
v_mfma_f32_16x16x32_bf16 v[124:127], a[140:143], a[204:207], v[124:127]
v_mfma_f32_16x16x32_bf16 v[156:159], a[136:139], a[208:211], v[156:159]
v_mfma_f32_16x16x32_bf16 v[156:159], a[140:143], a[212:215], v[156:159]
v_mfma_f32_16x16x32_bf16 v[188:191], a[136:139], a[216:219], v[188:191]
v_mfma_f32_16x16x32_bf16 v[188:191], a[140:143], a[220:223], v[188:191]
v_mfma_f32_16x16x32_bf16 v[220:223], a[136:139], a[224:227], v[220:223]
v_mfma_f32_16x16x32_bf16 v[220:223], a[140:143], a[228:231], v[220:223]
v_mfma_f32_16x16x32_bf16 v[252:255], a[136:139], a[232:235], v[252:255]
v_mfma_f32_16x16x32_bf16 v[252:255], a[140:143], a[236:239], v[252:255]
ds_read_b64_tr_b16 a[136:137], v43 offset:8
ds_read_b64_tr_b16 a[138:139], v43 offset:1032
ds_read_b64_tr_b16 a[140:141], v43 offset:8200
ds_read_b64_tr_b16 a[142:143], v43 offset:9224
s_waitcnt lgkmcnt(15)
v_mfma_f32_16x16x32_bf16 v[64:67], a[80:83], a[144:147], v[64:67]
v_mfma_f32_16x16x32_bf16 v[64:67], a[84:87], a[148:151], v[64:67]
v_mfma_f32_16x16x32_bf16 v[96:99], a[80:83], a[152:155], v[96:99]
v_mfma_f32_16x16x32_bf16 v[96:99], a[84:87], a[156:159], v[96:99]
v_mfma_f32_16x16x32_bf16 v[128:131], a[80:83], a[160:163], v[128:131]
v_mfma_f32_16x16x32_bf16 v[128:131], a[84:87], a[164:167], v[128:131]
v_mfma_f32_16x16x32_bf16 v[160:163], a[80:83], a[168:171], v[160:163]
v_mfma_f32_16x16x32_bf16 v[160:163], a[84:87], a[172:175], v[160:163]
v_mfma_f32_16x16x32_bf16 v[192:195], a[80:83], a[176:179], v[192:195]
v_mfma_f32_16x16x32_bf16 v[192:195], a[84:87], a[180:183], v[192:195]
v_mfma_f32_16x16x32_bf16 v[224:227], a[80:83], a[184:187], v[224:227]
s_waitcnt vmcnt(8) lgkmcnt(0)
v_mfma_f32_16x16x32_bf16 v[224:227], a[84:87], a[188:191], v[224:227]
s_barrier
v_mfma_f32_16x16x32_bf16 v[68:71], a[88:91], a[144:147], v[68:71]
ds_read_b64_tr_b16 a[80:81], v40 offset:16384
ds_read_b64_tr_b16 a[82:83], v40 offset:17408
v_mfma_f32_16x16x32_bf16 v[68:71], a[92:95], a[148:151], v[68:71]
ds_read_b64_tr_b16 a[84:85], v40 offset:24576
ds_read_b64_tr_b16 a[86:87], v40 offset:25600
v_mfma_f32_16x16x32_bf16 v[100:103], a[88:91], a[152:155], v[100:103]
ds_read_b128 a[192:195], v52 offset:24576
ds_read_b128 a[196:199], v53 offset:24576
v_mfma_f32_16x16x32_bf16 v[100:103], a[92:95], a[156:159], v[100:103]
ds_read_b128 a[200:203], v52 offset:26624
ds_read_b128 a[204:207], v53 offset:26624
v_mfma_f32_16x16x32_bf16 v[132:135], a[88:91], a[160:163], v[132:135]
ds_read_b128 a[208:211], v52 offset:28672
ds_read_b128 a[212:215], v53 offset:28672
v_mfma_f32_16x16x32_bf16 v[132:135], a[92:95], a[164:167], v[132:135]
ds_read_b128 a[216:219], v52 offset:30720
ds_read_b128 a[220:223], v53 offset:30720
v_mfma_f32_16x16x32_bf16 v[164:167], a[88:91], a[168:171], v[164:167]
ds_read_b128 a[224:227], v52 offset:32768
ds_read_b128 a[228:231], v53 offset:32768
v_mfma_f32_16x16x32_bf16 v[164:167], a[92:95], a[172:175], v[164:167]
ds_read_b128 a[232:235], v52 offset:34816
ds_read_b128 a[236:239], v53 offset:34816
v_mfma_f32_16x16x32_bf16 v[196:199], a[88:91], a[176:179], v[196:199]
s_add_u32 m0, s48, 114688
v_mfma_f32_16x16x32_bf16 v[196:199], a[92:95], a[180:183], v[196:199]
s_add_u32 s55, s50, 0
v_mfma_f32_16x16x32_bf16 v[228:231], a[88:91], a[184:187], v[228:231]
v_mfma_f32_16x16x32_bf16 v[228:231], a[92:95], a[188:191], v[228:231]
ds_read_b64_tr_b16 a[88:89], v40 offset:16392
ds_read_b64_tr_b16 a[90:91], v40 offset:17416
v_mfma_f32_16x16x32_bf16 v[72:75], a[96:99], a[144:147], v[72:75]
ds_read_b64_tr_b16 a[92:93], v40 offset:24584
ds_read_b64_tr_b16 a[94:95], v40 offset:25608
v_mfma_f32_16x16x32_bf16 v[72:75], a[100:103], a[148:151], v[72:75]
v_mfma_f32_16x16x32_bf16 v[104:107], a[96:99], a[152:155], v[104:107]
v_mfma_f32_16x16x32_bf16 v[104:107], a[100:103], a[156:159], v[104:107]
buffer_load_dwordx4 v58, s[4:7], s55 offen offset:0  lds
v_mfma_f32_16x16x32_bf16 v[136:139], a[96:99], a[160:163], v[136:139]
v_mfma_f32_16x16x32_bf16 v[136:139], a[100:103], a[164:167], v[136:139]
v_mfma_f32_16x16x32_bf16 v[168:171], a[96:99], a[168:171], v[168:171]
buffer_load_dwordx4 v59, s[4:7], s55 offen offset:1024  lds
v_mfma_f32_16x16x32_bf16 v[168:171], a[100:103], a[172:175], v[168:171]
v_mfma_f32_16x16x32_bf16 v[200:203], a[96:99], a[176:179], v[200:203]
v_mfma_f32_16x16x32_bf16 v[200:203], a[100:103], a[180:183], v[200:203]
buffer_load_dwordx4 v60, s[4:7], s55 offen offset:2048  lds
v_mfma_f32_16x16x32_bf16 v[232:235], a[96:99], a[184:187], v[232:235]
v_mfma_f32_16x16x32_bf16 v[232:235], a[100:103], a[188:191], v[232:235]
ds_read_b64_tr_b16 a[96:97], v41 offset:16384
ds_read_b64_tr_b16 a[98:99], v41 offset:17408
v_mfma_f32_16x16x32_bf16 v[76:79], a[104:107], a[144:147], v[76:79]
ds_read_b64_tr_b16 a[100:101], v41 offset:24576
ds_read_b64_tr_b16 a[102:103], v41 offset:25600
v_mfma_f32_16x16x32_bf16 v[76:79], a[108:111], a[148:151], v[76:79]
v_mfma_f32_16x16x32_bf16 v[108:111], a[104:107], a[152:155], v[108:111]
v_mfma_f32_16x16x32_bf16 v[108:111], a[108:111], a[156:159], v[108:111]
buffer_load_dwordx4 v61, s[4:7], s55 offen offset:3072  lds
v_mfma_f32_16x16x32_bf16 v[140:143], a[104:107], a[160:163], v[140:143]
s_add_u32 m0, s48, 118784
v_mfma_f32_16x16x32_bf16 v[140:143], a[108:111], a[164:167], v[140:143]
s_add_u32 s55, s50, 40960
v_mfma_f32_16x16x32_bf16 v[172:175], a[104:107], a[168:171], v[172:175]
buffer_load_dwordx4 v58, s[4:7], s55 offen offset:0  lds
v_mfma_f32_16x16x32_bf16 v[172:175], a[108:111], a[172:175], v[172:175]
v_mfma_f32_16x16x32_bf16 v[204:207], a[104:107], a[176:179], v[204:207]
v_mfma_f32_16x16x32_bf16 v[204:207], a[108:111], a[180:183], v[204:207]
buffer_load_dwordx4 v59, s[4:7], s55 offen offset:1024  lds
v_mfma_f32_16x16x32_bf16 v[236:239], a[104:107], a[184:187], v[236:239]
s_add_u32 s50, s50, 128
v_mfma_f32_16x16x32_bf16 v[236:239], a[108:111], a[188:191], v[236:239]
ds_read_b64_tr_b16 a[104:105], v41 offset:16392
ds_read_b64_tr_b16 a[106:107], v41 offset:17416
v_mfma_f32_16x16x32_bf16 v[80:83], a[112:115], a[144:147], v[80:83]
ds_read_b64_tr_b16 a[108:109], v41 offset:24584
ds_read_b64_tr_b16 a[110:111], v41 offset:25608
v_mfma_f32_16x16x32_bf16 v[80:83], a[116:119], a[148:151], v[80:83]
s_cmp_eq_u32 s50, s96
s_cselect_b32 s50, s49, s50
v_mfma_f32_16x16x32_bf16 v[112:115], a[112:115], a[152:155], v[112:115]
s_add_u32 m0, s54, 0
v_mfma_f32_16x16x32_bf16 v[112:115], a[116:119], a[156:159], v[112:115]
s_add_u32 s55, s51, 0
v_mfma_f32_16x16x32_bf16 v[144:147], a[112:115], a[160:163], v[144:147]
v_mfma_f32_16x16x32_bf16 v[144:147], a[116:119], a[164:167], v[144:147]
v_mfma_f32_16x16x32_bf16 v[176:179], a[112:115], a[168:171], v[176:179]
buffer_load_dwordx4 v6, s[8:11], s55 offen offset:0  lds
v_mfma_f32_16x16x32_bf16 v[176:179], a[116:119], a[172:175], v[176:179]
v_mfma_f32_16x16x32_bf16 v[208:211], a[112:115], a[176:179], v[208:211]
v_mfma_f32_16x16x32_bf16 v[208:211], a[116:119], a[180:183], v[208:211]
buffer_load_dwordx4 v7, s[8:11], s55 offen offset:1024  lds
v_mfma_f32_16x16x32_bf16 v[240:243], a[112:115], a[184:187], v[240:243]
v_mfma_f32_16x16x32_bf16 v[240:243], a[116:119], a[188:191], v[240:243]
ds_read_b64_tr_b16 a[112:113], v42 offset:16384
ds_read_b64_tr_b16 a[114:115], v42 offset:17408
v_mfma_f32_16x16x32_bf16 v[84:87], a[120:123], a[144:147], v[84:87]
ds_read_b64_tr_b16 a[116:117], v42 offset:24576
ds_read_b64_tr_b16 a[118:119], v42 offset:25600
v_mfma_f32_16x16x32_bf16 v[84:87], a[124:127], a[148:151], v[84:87]
v_mfma_f32_16x16x32_bf16 v[116:119], a[120:123], a[152:155], v[116:119]
v_mfma_f32_16x16x32_bf16 v[116:119], a[124:127], a[156:159], v[116:119]
buffer_load_dwordx4 v8, s[8:11], s55 offen offset:2048  lds
v_mfma_f32_16x16x32_bf16 v[148:151], a[120:123], a[160:163], v[148:151]
v_mfma_f32_16x16x32_bf16 v[148:151], a[124:127], a[164:167], v[148:151]
v_mfma_f32_16x16x32_bf16 v[180:183], a[120:123], a[168:171], v[180:183]
buffer_load_dwordx4 v9, s[8:11], s55 offen offset:3072  lds
v_mfma_f32_16x16x32_bf16 v[180:183], a[124:127], a[172:175], v[180:183]
s_add_u32 m0, s54, 4096
v_mfma_f32_16x16x32_bf16 v[212:215], a[120:123], a[176:179], v[212:215]
s_add_u32 s55, s51, 131072
v_mfma_f32_16x16x32_bf16 v[212:215], a[124:127], a[180:183], v[212:215]
buffer_load_dwordx4 v6, s[8:11], s55 offen offset:0  lds
v_mfma_f32_16x16x32_bf16 v[244:247], a[120:123], a[184:187], v[244:247]
v_mfma_f32_16x16x32_bf16 v[244:247], a[124:127], a[188:191], v[244:247]
ds_read_b64_tr_b16 a[120:121], v42 offset:16392
ds_read_b64_tr_b16 a[122:123], v42 offset:17416
v_mfma_f32_16x16x32_bf16 v[88:91], a[128:131], a[144:147], v[88:91]
ds_read_b64_tr_b16 a[124:125], v42 offset:24584
ds_read_b64_tr_b16 a[126:127], v42 offset:25608
v_mfma_f32_16x16x32_bf16 v[88:91], a[132:135], a[148:151], v[88:91]
v_mfma_f32_16x16x32_bf16 v[120:123], a[128:131], a[152:155], v[120:123]
v_mfma_f32_16x16x32_bf16 v[120:123], a[132:135], a[156:159], v[120:123]
buffer_load_dwordx4 v7, s[8:11], s55 offen offset:1024  lds
v_mfma_f32_16x16x32_bf16 v[152:155], a[128:131], a[160:163], v[152:155]
v_mfma_f32_16x16x32_bf16 v[152:155], a[132:135], a[164:167], v[152:155]
v_mfma_f32_16x16x32_bf16 v[184:187], a[128:131], a[168:171], v[184:187]
buffer_load_dwordx4 v8, s[8:11], s55 offen offset:2048  lds
v_mfma_f32_16x16x32_bf16 v[184:187], a[132:135], a[172:175], v[184:187]
v_mfma_f32_16x16x32_bf16 v[216:219], a[128:131], a[176:179], v[216:219]
v_mfma_f32_16x16x32_bf16 v[216:219], a[132:135], a[180:183], v[216:219]
buffer_load_dwordx4 v9, s[8:11], s55 offen offset:3072  lds
v_mfma_f32_16x16x32_bf16 v[248:251], a[128:131], a[184:187], v[248:251]
s_add_u32 s51, s51, 0x80000
v_mfma_f32_16x16x32_bf16 v[248:251], a[132:135], a[188:191], v[248:251]
ds_read_b64_tr_b16 a[128:129], v43 offset:16384
ds_read_b64_tr_b16 a[130:131], v43 offset:17408
v_mfma_f32_16x16x32_bf16 v[92:95], a[136:139], a[144:147], v[92:95]
ds_read_b64_tr_b16 a[132:133], v43 offset:24576
ds_read_b64_tr_b16 a[134:135], v43 offset:25600
v_mfma_f32_16x16x32_bf16 v[92:95], a[140:143], a[148:151], v[92:95]
s_cmp_eq_u32 s51, s97
s_cselect_b32 s51, s53, s51
v_mfma_f32_16x16x32_bf16 v[124:127], a[136:139], a[152:155], v[124:127]
v_mfma_f32_16x16x32_bf16 v[124:127], a[140:143], a[156:159], v[124:127]
v_mfma_f32_16x16x32_bf16 v[156:159], a[136:139], a[160:163], v[156:159]
v_mfma_f32_16x16x32_bf16 v[156:159], a[140:143], a[164:167], v[156:159]
v_mfma_f32_16x16x32_bf16 v[188:191], a[136:139], a[168:171], v[188:191]
v_mfma_f32_16x16x32_bf16 v[188:191], a[140:143], a[172:175], v[188:191]
v_mfma_f32_16x16x32_bf16 v[220:223], a[136:139], a[176:179], v[220:223]
v_mfma_f32_16x16x32_bf16 v[220:223], a[140:143], a[180:183], v[220:223]
v_mfma_f32_16x16x32_bf16 v[252:255], a[136:139], a[184:187], v[252:255]
v_mfma_f32_16x16x32_bf16 v[252:255], a[140:143], a[188:191], v[252:255]
ds_read_b64_tr_b16 a[136:137], v43 offset:16392
ds_read_b64_tr_b16 a[138:139], v43 offset:17416
ds_read_b64_tr_b16 a[140:141], v43 offset:24584
ds_read_b64_tr_b16 a[142:143], v43 offset:25608
s_waitcnt lgkmcnt(15)
v_mfma_f32_16x16x32_bf16 v[64:67], a[80:83], a[192:195], v[64:67]
v_mfma_f32_16x16x32_bf16 v[64:67], a[84:87], a[196:199], v[64:67]
v_mfma_f32_16x16x32_bf16 v[96:99], a[80:83], a[200:203], v[96:99]
v_mfma_f32_16x16x32_bf16 v[96:99], a[84:87], a[204:207], v[96:99]
v_mfma_f32_16x16x32_bf16 v[128:131], a[80:83], a[208:211], v[128:131]
v_mfma_f32_16x16x32_bf16 v[128:131], a[84:87], a[212:215], v[128:131]
v_mfma_f32_16x16x32_bf16 v[160:163], a[80:83], a[216:219], v[160:163]
v_mfma_f32_16x16x32_bf16 v[160:163], a[84:87], a[220:223], v[160:163]
v_mfma_f32_16x16x32_bf16 v[192:195], a[80:83], a[224:227], v[192:195]
v_mfma_f32_16x16x32_bf16 v[192:195], a[84:87], a[228:231], v[192:195]
v_mfma_f32_16x16x32_bf16 v[224:227], a[80:83], a[232:235], v[224:227]
s_waitcnt vmcnt(8) lgkmcnt(0)
v_mfma_f32_16x16x32_bf16 v[224:227], a[84:87], a[236:239], v[224:227]
s_barrier
v_mfma_f32_16x16x32_bf16 v[68:71], a[88:91], a[192:195], v[68:71]
ds_read_b64_tr_b16 a[80:81], v40 offset:32768
ds_read_b64_tr_b16 a[82:83], v40 offset:33792
v_mfma_f32_16x16x32_bf16 v[68:71], a[92:95], a[196:199], v[68:71]
ds_read_b64_tr_b16 a[84:85], v40 offset:40960
ds_read_b64_tr_b16 a[86:87], v40 offset:41984
v_mfma_f32_16x16x32_bf16 v[100:103], a[88:91], a[200:203], v[100:103]
ds_read_b128 a[144:147], v52 offset:0
ds_read_b128 a[148:151], v53 offset:0
v_mfma_f32_16x16x32_bf16 v[100:103], a[92:95], a[204:207], v[100:103]
ds_read_b128 a[152:155], v52 offset:2048
ds_read_b128 a[156:159], v53 offset:2048
v_mfma_f32_16x16x32_bf16 v[132:135], a[88:91], a[208:211], v[132:135]
ds_read_b128 a[160:163], v52 offset:4096
ds_read_b128 a[164:167], v53 offset:4096
v_mfma_f32_16x16x32_bf16 v[132:135], a[92:95], a[212:215], v[132:135]
ds_read_b128 a[168:171], v52 offset:6144
ds_read_b128 a[172:175], v53 offset:6144
v_mfma_f32_16x16x32_bf16 v[164:167], a[88:91], a[216:219], v[164:167]
ds_read_b128 a[176:179], v52 offset:8192
ds_read_b128 a[180:183], v53 offset:8192
v_mfma_f32_16x16x32_bf16 v[164:167], a[92:95], a[220:223], v[164:167]
ds_read_b128 a[184:187], v52 offset:10240
ds_read_b128 a[188:191], v53 offset:10240
v_mfma_f32_16x16x32_bf16 v[196:199], a[88:91], a[224:227], v[196:199]
s_add_u32 m0, s48, 139264
v_mfma_f32_16x16x32_bf16 v[196:199], a[92:95], a[228:231], v[196:199]
s_add_u32 s55, s50, 0
v_mfma_f32_16x16x32_bf16 v[228:231], a[88:91], a[232:235], v[228:231]
v_mfma_f32_16x16x32_bf16 v[228:231], a[92:95], a[236:239], v[228:231]
ds_read_b64_tr_b16 a[88:89], v40 offset:32776
ds_read_b64_tr_b16 a[90:91], v40 offset:33800
v_mfma_f32_16x16x32_bf16 v[72:75], a[96:99], a[192:195], v[72:75]
ds_read_b64_tr_b16 a[92:93], v40 offset:40968
ds_read_b64_tr_b16 a[94:95], v40 offset:41992
v_mfma_f32_16x16x32_bf16 v[72:75], a[100:103], a[196:199], v[72:75]
v_mfma_f32_16x16x32_bf16 v[104:107], a[96:99], a[200:203], v[104:107]
v_mfma_f32_16x16x32_bf16 v[104:107], a[100:103], a[204:207], v[104:107]
buffer_load_dwordx4 v58, s[4:7], s55 offen offset:0  lds
v_mfma_f32_16x16x32_bf16 v[136:139], a[96:99], a[208:211], v[136:139]
v_mfma_f32_16x16x32_bf16 v[136:139], a[100:103], a[212:215], v[136:139]
v_mfma_f32_16x16x32_bf16 v[168:171], a[96:99], a[216:219], v[168:171]
buffer_load_dwordx4 v59, s[4:7], s55 offen offset:1024  lds
v_mfma_f32_16x16x32_bf16 v[168:171], a[100:103], a[220:223], v[168:171]
v_mfma_f32_16x16x32_bf16 v[200:203], a[96:99], a[224:227], v[200:203]
v_mfma_f32_16x16x32_bf16 v[200:203], a[100:103], a[228:231], v[200:203]
buffer_load_dwordx4 v60, s[4:7], s55 offen offset:2048  lds
v_mfma_f32_16x16x32_bf16 v[232:235], a[96:99], a[232:235], v[232:235]
v_mfma_f32_16x16x32_bf16 v[232:235], a[100:103], a[236:239], v[232:235]
ds_read_b64_tr_b16 a[96:97], v41 offset:32768
ds_read_b64_tr_b16 a[98:99], v41 offset:33792
v_mfma_f32_16x16x32_bf16 v[76:79], a[104:107], a[192:195], v[76:79]
ds_read_b64_tr_b16 a[100:101], v41 offset:40960
ds_read_b64_tr_b16 a[102:103], v41 offset:41984
v_mfma_f32_16x16x32_bf16 v[76:79], a[108:111], a[196:199], v[76:79]
v_mfma_f32_16x16x32_bf16 v[108:111], a[104:107], a[200:203], v[108:111]
v_mfma_f32_16x16x32_bf16 v[108:111], a[108:111], a[204:207], v[108:111]
buffer_load_dwordx4 v61, s[4:7], s55 offen offset:3072  lds
v_mfma_f32_16x16x32_bf16 v[140:143], a[104:107], a[208:211], v[140:143]
s_add_u32 m0, s48, 143360
v_mfma_f32_16x16x32_bf16 v[140:143], a[108:111], a[212:215], v[140:143]
s_add_u32 s55, s50, 40960
v_mfma_f32_16x16x32_bf16 v[172:175], a[104:107], a[216:219], v[172:175]
buffer_load_dwordx4 v58, s[4:7], s55 offen offset:0  lds
v_mfma_f32_16x16x32_bf16 v[172:175], a[108:111], a[220:223], v[172:175]
v_mfma_f32_16x16x32_bf16 v[204:207], a[104:107], a[224:227], v[204:207]
v_mfma_f32_16x16x32_bf16 v[204:207], a[108:111], a[228:231], v[204:207]
buffer_load_dwordx4 v59, s[4:7], s55 offen offset:1024  lds
v_mfma_f32_16x16x32_bf16 v[236:239], a[104:107], a[232:235], v[236:239]
s_add_u32 s50, s50, 128
v_mfma_f32_16x16x32_bf16 v[236:239], a[108:111], a[236:239], v[236:239]
ds_read_b64_tr_b16 a[104:105], v41 offset:32776
ds_read_b64_tr_b16 a[106:107], v41 offset:33800
v_mfma_f32_16x16x32_bf16 v[80:83], a[112:115], a[192:195], v[80:83]
ds_read_b64_tr_b16 a[108:109], v41 offset:40968
ds_read_b64_tr_b16 a[110:111], v41 offset:41992
v_mfma_f32_16x16x32_bf16 v[80:83], a[116:119], a[196:199], v[80:83]
s_cmp_eq_u32 s50, s96
s_cselect_b32 s50, s49, s50
v_mfma_f32_16x16x32_bf16 v[112:115], a[112:115], a[200:203], v[112:115]
s_add_u32 m0, s54, 16384
v_mfma_f32_16x16x32_bf16 v[112:115], a[116:119], a[204:207], v[112:115]
s_add_u32 s55, s51, 0
v_mfma_f32_16x16x32_bf16 v[144:147], a[112:115], a[208:211], v[144:147]
v_mfma_f32_16x16x32_bf16 v[144:147], a[116:119], a[212:215], v[144:147]
v_mfma_f32_16x16x32_bf16 v[176:179], a[112:115], a[216:219], v[176:179]
buffer_load_dwordx4 v6, s[8:11], s55 offen offset:0  lds
v_mfma_f32_16x16x32_bf16 v[176:179], a[116:119], a[220:223], v[176:179]
v_mfma_f32_16x16x32_bf16 v[208:211], a[112:115], a[224:227], v[208:211]
v_mfma_f32_16x16x32_bf16 v[208:211], a[116:119], a[228:231], v[208:211]
buffer_load_dwordx4 v7, s[8:11], s55 offen offset:1024  lds
v_mfma_f32_16x16x32_bf16 v[240:243], a[112:115], a[232:235], v[240:243]
v_mfma_f32_16x16x32_bf16 v[240:243], a[116:119], a[236:239], v[240:243]
ds_read_b64_tr_b16 a[112:113], v42 offset:32768
ds_read_b64_tr_b16 a[114:115], v42 offset:33792
v_mfma_f32_16x16x32_bf16 v[84:87], a[120:123], a[192:195], v[84:87]
ds_read_b64_tr_b16 a[116:117], v42 offset:40960
ds_read_b64_tr_b16 a[118:119], v42 offset:41984
v_mfma_f32_16x16x32_bf16 v[84:87], a[124:127], a[196:199], v[84:87]
v_mfma_f32_16x16x32_bf16 v[116:119], a[120:123], a[200:203], v[116:119]
v_mfma_f32_16x16x32_bf16 v[116:119], a[124:127], a[204:207], v[116:119]
buffer_load_dwordx4 v8, s[8:11], s55 offen offset:2048  lds
v_mfma_f32_16x16x32_bf16 v[148:151], a[120:123], a[208:211], v[148:151]
v_mfma_f32_16x16x32_bf16 v[148:151], a[124:127], a[212:215], v[148:151]
v_mfma_f32_16x16x32_bf16 v[180:183], a[120:123], a[216:219], v[180:183]
buffer_load_dwordx4 v9, s[8:11], s55 offen offset:3072  lds
v_mfma_f32_16x16x32_bf16 v[180:183], a[124:127], a[220:223], v[180:183]
s_add_u32 m0, s54, 20480
v_mfma_f32_16x16x32_bf16 v[212:215], a[120:123], a[224:227], v[212:215]
s_add_u32 s55, s51, 131072
v_mfma_f32_16x16x32_bf16 v[212:215], a[124:127], a[228:231], v[212:215]
buffer_load_dwordx4 v6, s[8:11], s55 offen offset:0  lds
v_mfma_f32_16x16x32_bf16 v[244:247], a[120:123], a[232:235], v[244:247]
v_mfma_f32_16x16x32_bf16 v[244:247], a[124:127], a[236:239], v[244:247]
ds_read_b64_tr_b16 a[120:121], v42 offset:32776
ds_read_b64_tr_b16 a[122:123], v42 offset:33800
v_mfma_f32_16x16x32_bf16 v[88:91], a[128:131], a[192:195], v[88:91]
ds_read_b64_tr_b16 a[124:125], v42 offset:40968
ds_read_b64_tr_b16 a[126:127], v42 offset:41992
v_mfma_f32_16x16x32_bf16 v[88:91], a[132:135], a[196:199], v[88:91]
v_mfma_f32_16x16x32_bf16 v[120:123], a[128:131], a[200:203], v[120:123]
v_mfma_f32_16x16x32_bf16 v[120:123], a[132:135], a[204:207], v[120:123]
buffer_load_dwordx4 v7, s[8:11], s55 offen offset:1024  lds
v_mfma_f32_16x16x32_bf16 v[152:155], a[128:131], a[208:211], v[152:155]
v_mfma_f32_16x16x32_bf16 v[152:155], a[132:135], a[212:215], v[152:155]
v_mfma_f32_16x16x32_bf16 v[184:187], a[128:131], a[216:219], v[184:187]
buffer_load_dwordx4 v8, s[8:11], s55 offen offset:2048  lds
v_mfma_f32_16x16x32_bf16 v[184:187], a[132:135], a[220:223], v[184:187]
v_mfma_f32_16x16x32_bf16 v[216:219], a[128:131], a[224:227], v[216:219]
v_mfma_f32_16x16x32_bf16 v[216:219], a[132:135], a[228:231], v[216:219]
buffer_load_dwordx4 v9, s[8:11], s55 offen offset:3072  lds
v_mfma_f32_16x16x32_bf16 v[248:251], a[128:131], a[232:235], v[248:251]
s_add_u32 s51, s51, 0x80000
v_mfma_f32_16x16x32_bf16 v[248:251], a[132:135], a[236:239], v[248:251]
ds_read_b64_tr_b16 a[128:129], v43 offset:32768
ds_read_b64_tr_b16 a[130:131], v43 offset:33792
v_mfma_f32_16x16x32_bf16 v[92:95], a[136:139], a[192:195], v[92:95]
ds_read_b64_tr_b16 a[132:133], v43 offset:40960
ds_read_b64_tr_b16 a[134:135], v43 offset:41984
v_mfma_f32_16x16x32_bf16 v[92:95], a[140:143], a[196:199], v[92:95]
s_cmp_eq_u32 s51, s97
s_cselect_b32 s51, s53, s51
v_mfma_f32_16x16x32_bf16 v[124:127], a[136:139], a[200:203], v[124:127]
v_mfma_f32_16x16x32_bf16 v[124:127], a[140:143], a[204:207], v[124:127]
v_mfma_f32_16x16x32_bf16 v[156:159], a[136:139], a[208:211], v[156:159]
v_mfma_f32_16x16x32_bf16 v[156:159], a[140:143], a[212:215], v[156:159]
v_mfma_f32_16x16x32_bf16 v[188:191], a[136:139], a[216:219], v[188:191]
v_mfma_f32_16x16x32_bf16 v[188:191], a[140:143], a[220:223], v[188:191]
v_mfma_f32_16x16x32_bf16 v[220:223], a[136:139], a[224:227], v[220:223]
v_mfma_f32_16x16x32_bf16 v[220:223], a[140:143], a[228:231], v[220:223]
v_mfma_f32_16x16x32_bf16 v[252:255], a[136:139], a[232:235], v[252:255]
v_mfma_f32_16x16x32_bf16 v[252:255], a[140:143], a[236:239], v[252:255]
ds_read_b64_tr_b16 a[136:137], v43 offset:32776
ds_read_b64_tr_b16 a[138:139], v43 offset:33800
ds_read_b64_tr_b16 a[140:141], v43 offset:40968
ds_read_b64_tr_b16 a[142:143], v43 offset:41992
s_waitcnt lgkmcnt(15)
v_mfma_f32_16x16x32_bf16 v[64:67], a[80:83], a[144:147], v[64:67]
v_mfma_f32_16x16x32_bf16 v[64:67], a[84:87], a[148:151], v[64:67]
v_mfma_f32_16x16x32_bf16 v[96:99], a[80:83], a[152:155], v[96:99]
v_mfma_f32_16x16x32_bf16 v[96:99], a[84:87], a[156:159], v[96:99]
v_mfma_f32_16x16x32_bf16 v[128:131], a[80:83], a[160:163], v[128:131]
v_mfma_f32_16x16x32_bf16 v[128:131], a[84:87], a[164:167], v[128:131]
v_mfma_f32_16x16x32_bf16 v[160:163], a[80:83], a[168:171], v[160:163]
v_mfma_f32_16x16x32_bf16 v[160:163], a[84:87], a[172:175], v[160:163]
v_mfma_f32_16x16x32_bf16 v[192:195], a[80:83], a[176:179], v[192:195]
v_mfma_f32_16x16x32_bf16 v[192:195], a[84:87], a[180:183], v[192:195]
v_mfma_f32_16x16x32_bf16 v[224:227], a[80:83], a[184:187], v[224:227]
s_waitcnt vmcnt(8) lgkmcnt(0)
v_mfma_f32_16x16x32_bf16 v[224:227], a[84:87], a[188:191], v[224:227]
s_barrier
v_mfma_f32_16x16x32_bf16 v[68:71], a[88:91], a[144:147], v[68:71]
ds_read_b64_tr_b16 a[80:81], v40 offset:0
ds_read_b64_tr_b16 a[82:83], v40 offset:1024
v_mfma_f32_16x16x32_bf16 v[68:71], a[92:95], a[148:151], v[68:71]
ds_read_b64_tr_b16 a[84:85], v40 offset:8192
ds_read_b64_tr_b16 a[86:87], v40 offset:9216
v_mfma_f32_16x16x32_bf16 v[100:103], a[88:91], a[152:155], v[100:103]
ds_read_b128 a[192:195], v52 offset:24576
ds_read_b128 a[196:199], v53 offset:24576
v_mfma_f32_16x16x32_bf16 v[100:103], a[92:95], a[156:159], v[100:103]
ds_read_b128 a[200:203], v52 offset:26624
ds_read_b128 a[204:207], v53 offset:26624
v_mfma_f32_16x16x32_bf16 v[132:135], a[88:91], a[160:163], v[132:135]
ds_read_b128 a[208:211], v52 offset:28672
ds_read_b128 a[212:215], v53 offset:28672
v_mfma_f32_16x16x32_bf16 v[132:135], a[92:95], a[164:167], v[132:135]
ds_read_b128 a[216:219], v52 offset:30720
ds_read_b128 a[220:223], v53 offset:30720
v_mfma_f32_16x16x32_bf16 v[164:167], a[88:91], a[168:171], v[164:167]
ds_read_b128 a[224:227], v52 offset:32768
ds_read_b128 a[228:231], v53 offset:32768
v_mfma_f32_16x16x32_bf16 v[164:167], a[92:95], a[172:175], v[164:167]
ds_read_b128 a[232:235], v52 offset:34816
ds_read_b128 a[236:239], v53 offset:34816
v_mfma_f32_16x16x32_bf16 v[196:199], a[88:91], a[176:179], v[196:199]
s_add_u32 m0, s48, 114688
v_mfma_f32_16x16x32_bf16 v[196:199], a[92:95], a[180:183], v[196:199]
s_add_u32 s55, s50, 0
v_mfma_f32_16x16x32_bf16 v[228:231], a[88:91], a[184:187], v[228:231]
v_mfma_f32_16x16x32_bf16 v[228:231], a[92:95], a[188:191], v[228:231]
ds_read_b64_tr_b16 a[88:89], v40 offset:8
ds_read_b64_tr_b16 a[90:91], v40 offset:1032
v_mfma_f32_16x16x32_bf16 v[72:75], a[96:99], a[144:147], v[72:75]
ds_read_b64_tr_b16 a[92:93], v40 offset:8200
ds_read_b64_tr_b16 a[94:95], v40 offset:9224
v_mfma_f32_16x16x32_bf16 v[72:75], a[100:103], a[148:151], v[72:75]
v_mfma_f32_16x16x32_bf16 v[104:107], a[96:99], a[152:155], v[104:107]
v_mfma_f32_16x16x32_bf16 v[104:107], a[100:103], a[156:159], v[104:107]
buffer_load_dwordx4 v58, s[4:7], s55 offen offset:0  lds
v_mfma_f32_16x16x32_bf16 v[136:139], a[96:99], a[160:163], v[136:139]
v_mfma_f32_16x16x32_bf16 v[136:139], a[100:103], a[164:167], v[136:139]
v_mfma_f32_16x16x32_bf16 v[168:171], a[96:99], a[168:171], v[168:171]
buffer_load_dwordx4 v59, s[4:7], s55 offen offset:1024  lds
v_mfma_f32_16x16x32_bf16 v[168:171], a[100:103], a[172:175], v[168:171]
v_mfma_f32_16x16x32_bf16 v[200:203], a[96:99], a[176:179], v[200:203]
v_mfma_f32_16x16x32_bf16 v[200:203], a[100:103], a[180:183], v[200:203]
buffer_load_dwordx4 v60, s[4:7], s55 offen offset:2048  lds
v_mfma_f32_16x16x32_bf16 v[232:235], a[96:99], a[184:187], v[232:235]
v_mfma_f32_16x16x32_bf16 v[232:235], a[100:103], a[188:191], v[232:235]
ds_read_b64_tr_b16 a[96:97], v41 offset:0
ds_read_b64_tr_b16 a[98:99], v41 offset:1024
v_mfma_f32_16x16x32_bf16 v[76:79], a[104:107], a[144:147], v[76:79]
ds_read_b64_tr_b16 a[100:101], v41 offset:8192
ds_read_b64_tr_b16 a[102:103], v41 offset:9216
v_mfma_f32_16x16x32_bf16 v[76:79], a[108:111], a[148:151], v[76:79]
v_mfma_f32_16x16x32_bf16 v[108:111], a[104:107], a[152:155], v[108:111]
v_mfma_f32_16x16x32_bf16 v[108:111], a[108:111], a[156:159], v[108:111]
buffer_load_dwordx4 v61, s[4:7], s55 offen offset:3072  lds
v_mfma_f32_16x16x32_bf16 v[140:143], a[104:107], a[160:163], v[140:143]
s_add_u32 m0, s48, 118784
v_mfma_f32_16x16x32_bf16 v[140:143], a[108:111], a[164:167], v[140:143]
s_add_u32 s55, s50, 40960
v_mfma_f32_16x16x32_bf16 v[172:175], a[104:107], a[168:171], v[172:175]
buffer_load_dwordx4 v58, s[4:7], s55 offen offset:0  lds
v_mfma_f32_16x16x32_bf16 v[172:175], a[108:111], a[172:175], v[172:175]
v_mfma_f32_16x16x32_bf16 v[204:207], a[104:107], a[176:179], v[204:207]
v_mfma_f32_16x16x32_bf16 v[204:207], a[108:111], a[180:183], v[204:207]
buffer_load_dwordx4 v59, s[4:7], s55 offen offset:1024  lds
v_mfma_f32_16x16x32_bf16 v[236:239], a[104:107], a[184:187], v[236:239]
s_add_u32 s50, s50, 128
v_mfma_f32_16x16x32_bf16 v[236:239], a[108:111], a[188:191], v[236:239]
ds_read_b64_tr_b16 a[104:105], v41 offset:8
ds_read_b64_tr_b16 a[106:107], v41 offset:1032
v_mfma_f32_16x16x32_bf16 v[80:83], a[112:115], a[144:147], v[80:83]
ds_read_b64_tr_b16 a[108:109], v41 offset:8200
ds_read_b64_tr_b16 a[110:111], v41 offset:9224
v_mfma_f32_16x16x32_bf16 v[80:83], a[116:119], a[148:151], v[80:83]
s_cmp_eq_u32 s50, s96
s_cselect_b32 s50, s49, s50
v_mfma_f32_16x16x32_bf16 v[112:115], a[112:115], a[152:155], v[112:115]
s_add_u32 m0, s54, 32768
v_mfma_f32_16x16x32_bf16 v[112:115], a[116:119], a[156:159], v[112:115]
s_add_u32 s55, s51, 0
v_mfma_f32_16x16x32_bf16 v[144:147], a[112:115], a[160:163], v[144:147]
v_mfma_f32_16x16x32_bf16 v[144:147], a[116:119], a[164:167], v[144:147]
v_mfma_f32_16x16x32_bf16 v[176:179], a[112:115], a[168:171], v[176:179]
buffer_load_dwordx4 v6, s[8:11], s55 offen offset:0  lds
v_mfma_f32_16x16x32_bf16 v[176:179], a[116:119], a[172:175], v[176:179]
v_mfma_f32_16x16x32_bf16 v[208:211], a[112:115], a[176:179], v[208:211]
v_mfma_f32_16x16x32_bf16 v[208:211], a[116:119], a[180:183], v[208:211]
buffer_load_dwordx4 v7, s[8:11], s55 offen offset:1024  lds
v_mfma_f32_16x16x32_bf16 v[240:243], a[112:115], a[184:187], v[240:243]
v_mfma_f32_16x16x32_bf16 v[240:243], a[116:119], a[188:191], v[240:243]
ds_read_b64_tr_b16 a[112:113], v42 offset:0
ds_read_b64_tr_b16 a[114:115], v42 offset:1024
v_mfma_f32_16x16x32_bf16 v[84:87], a[120:123], a[144:147], v[84:87]
ds_read_b64_tr_b16 a[116:117], v42 offset:8192
ds_read_b64_tr_b16 a[118:119], v42 offset:9216
v_mfma_f32_16x16x32_bf16 v[84:87], a[124:127], a[148:151], v[84:87]
v_mfma_f32_16x16x32_bf16 v[116:119], a[120:123], a[152:155], v[116:119]
v_mfma_f32_16x16x32_bf16 v[116:119], a[124:127], a[156:159], v[116:119]
buffer_load_dwordx4 v8, s[8:11], s55 offen offset:2048  lds
v_mfma_f32_16x16x32_bf16 v[148:151], a[120:123], a[160:163], v[148:151]
v_mfma_f32_16x16x32_bf16 v[148:151], a[124:127], a[164:167], v[148:151]
v_mfma_f32_16x16x32_bf16 v[180:183], a[120:123], a[168:171], v[180:183]
buffer_load_dwordx4 v9, s[8:11], s55 offen offset:3072  lds
v_mfma_f32_16x16x32_bf16 v[180:183], a[124:127], a[172:175], v[180:183]
s_add_u32 m0, s54, 36864
v_mfma_f32_16x16x32_bf16 v[212:215], a[120:123], a[176:179], v[212:215]
s_add_u32 s55, s51, 131072
v_mfma_f32_16x16x32_bf16 v[212:215], a[124:127], a[180:183], v[212:215]
buffer_load_dwordx4 v6, s[8:11], s55 offen offset:0  lds
v_mfma_f32_16x16x32_bf16 v[244:247], a[120:123], a[184:187], v[244:247]
v_mfma_f32_16x16x32_bf16 v[244:247], a[124:127], a[188:191], v[244:247]
ds_read_b64_tr_b16 a[120:121], v42 offset:8
ds_read_b64_tr_b16 a[122:123], v42 offset:1032
v_mfma_f32_16x16x32_bf16 v[88:91], a[128:131], a[144:147], v[88:91]
ds_read_b64_tr_b16 a[124:125], v42 offset:8200
ds_read_b64_tr_b16 a[126:127], v42 offset:9224
v_mfma_f32_16x16x32_bf16 v[88:91], a[132:135], a[148:151], v[88:91]
v_mfma_f32_16x16x32_bf16 v[120:123], a[128:131], a[152:155], v[120:123]
v_mfma_f32_16x16x32_bf16 v[120:123], a[132:135], a[156:159], v[120:123]
buffer_load_dwordx4 v7, s[8:11], s55 offen offset:1024  lds
v_mfma_f32_16x16x32_bf16 v[152:155], a[128:131], a[160:163], v[152:155]
v_mfma_f32_16x16x32_bf16 v[152:155], a[132:135], a[164:167], v[152:155]
v_mfma_f32_16x16x32_bf16 v[184:187], a[128:131], a[168:171], v[184:187]
buffer_load_dwordx4 v8, s[8:11], s55 offen offset:2048  lds
v_mfma_f32_16x16x32_bf16 v[184:187], a[132:135], a[172:175], v[184:187]
v_mfma_f32_16x16x32_bf16 v[216:219], a[128:131], a[176:179], v[216:219]
v_mfma_f32_16x16x32_bf16 v[216:219], a[132:135], a[180:183], v[216:219]
buffer_load_dwordx4 v9, s[8:11], s55 offen offset:3072  lds
v_mfma_f32_16x16x32_bf16 v[248:251], a[128:131], a[184:187], v[248:251]
s_add_u32 s51, s51, 0x80000
v_mfma_f32_16x16x32_bf16 v[248:251], a[132:135], a[188:191], v[248:251]
ds_read_b64_tr_b16 a[128:129], v43 offset:0
ds_read_b64_tr_b16 a[130:131], v43 offset:1024
v_mfma_f32_16x16x32_bf16 v[92:95], a[136:139], a[144:147], v[92:95]
ds_read_b64_tr_b16 a[132:133], v43 offset:8192
ds_read_b64_tr_b16 a[134:135], v43 offset:9216
v_mfma_f32_16x16x32_bf16 v[92:95], a[140:143], a[148:151], v[92:95]
s_cmp_eq_u32 s51, s97
s_cselect_b32 s51, s53, s51
v_mfma_f32_16x16x32_bf16 v[124:127], a[136:139], a[152:155], v[124:127]
v_mfma_f32_16x16x32_bf16 v[124:127], a[140:143], a[156:159], v[124:127]
v_mfma_f32_16x16x32_bf16 v[156:159], a[136:139], a[160:163], v[156:159]
v_mfma_f32_16x16x32_bf16 v[156:159], a[140:143], a[164:167], v[156:159]
v_mfma_f32_16x16x32_bf16 v[188:191], a[136:139], a[168:171], v[188:191]
v_mfma_f32_16x16x32_bf16 v[188:191], a[140:143], a[172:175], v[188:191]
v_mfma_f32_16x16x32_bf16 v[220:223], a[136:139], a[176:179], v[220:223]
v_mfma_f32_16x16x32_bf16 v[220:223], a[140:143], a[180:183], v[220:223]
v_mfma_f32_16x16x32_bf16 v[252:255], a[136:139], a[184:187], v[252:255]
v_mfma_f32_16x16x32_bf16 v[252:255], a[140:143], a[188:191], v[252:255]
ds_read_b64_tr_b16 a[136:137], v43 offset:8
ds_read_b64_tr_b16 a[138:139], v43 offset:1032
ds_read_b64_tr_b16 a[140:141], v43 offset:8200
ds_read_b64_tr_b16 a[142:143], v43 offset:9224
s_waitcnt lgkmcnt(15)
v_mfma_f32_16x16x32_bf16 v[64:67], a[80:83], a[192:195], v[64:67]
v_mfma_f32_16x16x32_bf16 v[64:67], a[84:87], a[196:199], v[64:67]
v_mfma_f32_16x16x32_bf16 v[96:99], a[80:83], a[200:203], v[96:99]
v_mfma_f32_16x16x32_bf16 v[96:99], a[84:87], a[204:207], v[96:99]
v_mfma_f32_16x16x32_bf16 v[128:131], a[80:83], a[208:211], v[128:131]
v_mfma_f32_16x16x32_bf16 v[128:131], a[84:87], a[212:215], v[128:131]
v_mfma_f32_16x16x32_bf16 v[160:163], a[80:83], a[216:219], v[160:163]
v_mfma_f32_16x16x32_bf16 v[160:163], a[84:87], a[220:223], v[160:163]
v_mfma_f32_16x16x32_bf16 v[192:195], a[80:83], a[224:227], v[192:195]
v_mfma_f32_16x16x32_bf16 v[192:195], a[84:87], a[228:231], v[192:195]
v_mfma_f32_16x16x32_bf16 v[224:227], a[80:83], a[232:235], v[224:227]
s_waitcnt vmcnt(8) lgkmcnt(0)
v_mfma_f32_16x16x32_bf16 v[224:227], a[84:87], a[236:239], v[224:227]
s_barrier
v_mfma_f32_16x16x32_bf16 v[68:71], a[88:91], a[192:195], v[68:71]
ds_read_b64_tr_b16 a[80:81], v40 offset:16384
ds_read_b64_tr_b16 a[82:83], v40 offset:17408
v_mfma_f32_16x16x32_bf16 v[68:71], a[92:95], a[196:199], v[68:71]
ds_read_b64_tr_b16 a[84:85], v40 offset:24576
ds_read_b64_tr_b16 a[86:87], v40 offset:25600
v_mfma_f32_16x16x32_bf16 v[100:103], a[88:91], a[200:203], v[100:103]
ds_read_b128 a[144:147], v52 offset:0
ds_read_b128 a[148:151], v53 offset:0
v_mfma_f32_16x16x32_bf16 v[100:103], a[92:95], a[204:207], v[100:103]
ds_read_b128 a[152:155], v52 offset:2048
ds_read_b128 a[156:159], v53 offset:2048
v_mfma_f32_16x16x32_bf16 v[132:135], a[88:91], a[208:211], v[132:135]
ds_read_b128 a[160:163], v52 offset:4096
ds_read_b128 a[164:167], v53 offset:4096
v_mfma_f32_16x16x32_bf16 v[132:135], a[92:95], a[212:215], v[132:135]
ds_read_b128 a[168:171], v52 offset:6144
ds_read_b128 a[172:175], v53 offset:6144
v_mfma_f32_16x16x32_bf16 v[164:167], a[88:91], a[216:219], v[164:167]
ds_read_b128 a[176:179], v52 offset:8192
ds_read_b128 a[180:183], v53 offset:8192
v_mfma_f32_16x16x32_bf16 v[164:167], a[92:95], a[220:223], v[164:167]
ds_read_b128 a[184:187], v52 offset:10240
ds_read_b128 a[188:191], v53 offset:10240
v_mfma_f32_16x16x32_bf16 v[196:199], a[88:91], a[224:227], v[196:199]
s_add_u32 m0, s48, 139264
v_mfma_f32_16x16x32_bf16 v[196:199], a[92:95], a[228:231], v[196:199]
s_add_u32 s55, s50, 0
v_mfma_f32_16x16x32_bf16 v[228:231], a[88:91], a[232:235], v[228:231]
v_mfma_f32_16x16x32_bf16 v[228:231], a[92:95], a[236:239], v[228:231]
ds_read_b64_tr_b16 a[88:89], v40 offset:16392
ds_read_b64_tr_b16 a[90:91], v40 offset:17416
v_mfma_f32_16x16x32_bf16 v[72:75], a[96:99], a[192:195], v[72:75]
ds_read_b64_tr_b16 a[92:93], v40 offset:24584
ds_read_b64_tr_b16 a[94:95], v40 offset:25608
v_mfma_f32_16x16x32_bf16 v[72:75], a[100:103], a[196:199], v[72:75]
v_mfma_f32_16x16x32_bf16 v[104:107], a[96:99], a[200:203], v[104:107]
v_mfma_f32_16x16x32_bf16 v[104:107], a[100:103], a[204:207], v[104:107]
buffer_load_dwordx4 v58, s[4:7], s55 offen offset:0  lds
v_mfma_f32_16x16x32_bf16 v[136:139], a[96:99], a[208:211], v[136:139]
v_mfma_f32_16x16x32_bf16 v[136:139], a[100:103], a[212:215], v[136:139]
v_mfma_f32_16x16x32_bf16 v[168:171], a[96:99], a[216:219], v[168:171]
buffer_load_dwordx4 v59, s[4:7], s55 offen offset:1024  lds
v_mfma_f32_16x16x32_bf16 v[168:171], a[100:103], a[220:223], v[168:171]
v_mfma_f32_16x16x32_bf16 v[200:203], a[96:99], a[224:227], v[200:203]
v_mfma_f32_16x16x32_bf16 v[200:203], a[100:103], a[228:231], v[200:203]
buffer_load_dwordx4 v60, s[4:7], s55 offen offset:2048  lds
v_mfma_f32_16x16x32_bf16 v[232:235], a[96:99], a[232:235], v[232:235]
v_mfma_f32_16x16x32_bf16 v[232:235], a[100:103], a[236:239], v[232:235]
ds_read_b64_tr_b16 a[96:97], v41 offset:16384
ds_read_b64_tr_b16 a[98:99], v41 offset:17408
v_mfma_f32_16x16x32_bf16 v[76:79], a[104:107], a[192:195], v[76:79]
ds_read_b64_tr_b16 a[100:101], v41 offset:24576
ds_read_b64_tr_b16 a[102:103], v41 offset:25600
v_mfma_f32_16x16x32_bf16 v[76:79], a[108:111], a[196:199], v[76:79]
v_mfma_f32_16x16x32_bf16 v[108:111], a[104:107], a[200:203], v[108:111]
v_mfma_f32_16x16x32_bf16 v[108:111], a[108:111], a[204:207], v[108:111]
buffer_load_dwordx4 v61, s[4:7], s55 offen offset:3072  lds
v_mfma_f32_16x16x32_bf16 v[140:143], a[104:107], a[208:211], v[140:143]
s_add_u32 m0, s48, 143360
v_mfma_f32_16x16x32_bf16 v[140:143], a[108:111], a[212:215], v[140:143]
s_add_u32 s55, s50, 40960
v_mfma_f32_16x16x32_bf16 v[172:175], a[104:107], a[216:219], v[172:175]
buffer_load_dwordx4 v58, s[4:7], s55 offen offset:0  lds
v_mfma_f32_16x16x32_bf16 v[172:175], a[108:111], a[220:223], v[172:175]
v_mfma_f32_16x16x32_bf16 v[204:207], a[104:107], a[224:227], v[204:207]
v_mfma_f32_16x16x32_bf16 v[204:207], a[108:111], a[228:231], v[204:207]
buffer_load_dwordx4 v59, s[4:7], s55 offen offset:1024  lds
v_mfma_f32_16x16x32_bf16 v[236:239], a[104:107], a[232:235], v[236:239]
s_add_u32 s50, s50, 128
v_mfma_f32_16x16x32_bf16 v[236:239], a[108:111], a[236:239], v[236:239]
ds_read_b64_tr_b16 a[104:105], v41 offset:16392
ds_read_b64_tr_b16 a[106:107], v41 offset:17416
v_mfma_f32_16x16x32_bf16 v[80:83], a[112:115], a[192:195], v[80:83]
ds_read_b64_tr_b16 a[108:109], v41 offset:24584
ds_read_b64_tr_b16 a[110:111], v41 offset:25608
v_mfma_f32_16x16x32_bf16 v[80:83], a[116:119], a[196:199], v[80:83]
s_cmp_eq_u32 s50, s96
s_cselect_b32 s50, s49, s50
v_mfma_f32_16x16x32_bf16 v[112:115], a[112:115], a[200:203], v[112:115]
s_add_u32 m0, s54, 0
v_mfma_f32_16x16x32_bf16 v[112:115], a[116:119], a[204:207], v[112:115]
s_and_b32 s55, s30, 0x3ffff
v_mfma_f32_16x16x32_bf16 v[144:147], a[112:115], a[208:211], v[144:147]
s_add_u32 s30, s30, 4096
v_mfma_f32_16x16x32_bf16 v[144:147], a[116:119], a[212:215], v[144:147]
v_mfma_f32_16x16x32_bf16 v[176:179], a[112:115], a[216:219], v[176:179]
buffer_load_dwordx4 v16, s[12:15], s55 offen offset:0 sc1 nt lds
v_mfma_f32_16x16x32_bf16 v[176:179], a[116:119], a[220:223], v[176:179]
v_mfma_f32_16x16x32_bf16 v[208:211], a[112:115], a[224:227], v[208:211]
v_mfma_f32_16x16x32_bf16 v[208:211], a[116:119], a[228:231], v[208:211]
buffer_load_dwordx4 v17, s[12:15], s55 offen offset:1024 sc1 nt lds
v_mfma_f32_16x16x32_bf16 v[240:243], a[112:115], a[232:235], v[240:243]
v_mfma_f32_16x16x32_bf16 v[240:243], a[116:119], a[236:239], v[240:243]
ds_read_b64_tr_b16 a[112:113], v42 offset:16384
ds_read_b64_tr_b16 a[114:115], v42 offset:17408
v_mfma_f32_16x16x32_bf16 v[84:87], a[120:123], a[192:195], v[84:87]
ds_read_b64_tr_b16 a[116:117], v42 offset:24576
ds_read_b64_tr_b16 a[118:119], v42 offset:25600
v_mfma_f32_16x16x32_bf16 v[84:87], a[124:127], a[196:199], v[84:87]
v_mfma_f32_16x16x32_bf16 v[116:119], a[120:123], a[200:203], v[116:119]
v_mfma_f32_16x16x32_bf16 v[116:119], a[124:127], a[204:207], v[116:119]
buffer_load_dwordx4 v18, s[12:15], s55 offen offset:2048 sc1 nt lds
v_mfma_f32_16x16x32_bf16 v[148:151], a[120:123], a[208:211], v[148:151]
v_mfma_f32_16x16x32_bf16 v[148:151], a[124:127], a[212:215], v[148:151]
v_mfma_f32_16x16x32_bf16 v[180:183], a[120:123], a[216:219], v[180:183]
buffer_load_dwordx4 v19, s[12:15], s55 offen offset:3072 sc1 nt lds
v_mfma_f32_16x16x32_bf16 v[180:183], a[124:127], a[220:223], v[180:183]
s_add_u32 m0, s54, 4096
v_mfma_f32_16x16x32_bf16 v[212:215], a[120:123], a[224:227], v[212:215]
s_and_b32 s55, s30, 0x3ffff
v_mfma_f32_16x16x32_bf16 v[212:215], a[124:127], a[228:231], v[212:215]
s_add_u32 s30, s30, s101
v_mfma_f32_16x16x32_bf16 v[244:247], a[120:123], a[232:235], v[244:247]
v_mfma_f32_16x16x32_bf16 v[244:247], a[124:127], a[236:239], v[244:247]
ds_read_b64_tr_b16 a[120:121], v42 offset:16392
ds_read_b64_tr_b16 a[122:123], v42 offset:17416
v_mfma_f32_16x16x32_bf16 v[88:91], a[128:131], a[192:195], v[88:91]
ds_read_b64_tr_b16 a[124:125], v42 offset:24584
ds_read_b64_tr_b16 a[126:127], v42 offset:25608
v_mfma_f32_16x16x32_bf16 v[88:91], a[132:135], a[196:199], v[88:91]
v_mfma_f32_16x16x32_bf16 v[120:123], a[128:131], a[200:203], v[120:123]
v_mfma_f32_16x16x32_bf16 v[120:123], a[132:135], a[204:207], v[120:123]
buffer_load_dwordx4 v16, s[12:15], s55 offen offset:0 sc1 nt lds
v_mfma_f32_16x16x32_bf16 v[152:155], a[128:131], a[208:211], v[152:155]
v_mfma_f32_16x16x32_bf16 v[152:155], a[132:135], a[212:215], v[152:155]
v_mfma_f32_16x16x32_bf16 v[184:187], a[128:131], a[216:219], v[184:187]
buffer_load_dwordx4 v17, s[12:15], s55 offen offset:1024 sc1 nt lds
v_mfma_f32_16x16x32_bf16 v[184:187], a[132:135], a[220:223], v[184:187]
v_mfma_f32_16x16x32_bf16 v[216:219], a[128:131], a[224:227], v[216:219]
v_mfma_f32_16x16x32_bf16 v[216:219], a[132:135], a[228:231], v[216:219]
buffer_load_dwordx4 v18, s[12:15], s55 offen offset:2048 sc1 nt lds
v_mfma_f32_16x16x32_bf16 v[248:251], a[128:131], a[232:235], v[248:251]
v_mfma_f32_16x16x32_bf16 v[248:251], a[132:135], a[236:239], v[248:251]
ds_read_b64_tr_b16 a[128:129], v43 offset:16384
ds_read_b64_tr_b16 a[130:131], v43 offset:17408
v_mfma_f32_16x16x32_bf16 v[92:95], a[136:139], a[192:195], v[92:95]
ds_read_b64_tr_b16 a[132:133], v43 offset:24576
ds_read_b64_tr_b16 a[134:135], v43 offset:25600
v_mfma_f32_16x16x32_bf16 v[92:95], a[140:143], a[196:199], v[92:95]
v_mfma_f32_16x16x32_bf16 v[124:127], a[136:139], a[200:203], v[124:127]
v_mfma_f32_16x16x32_bf16 v[124:127], a[140:143], a[204:207], v[124:127]
buffer_load_dwordx4 v19, s[12:15], s55 offen offset:3072 sc1 nt lds
v_mfma_f32_16x16x32_bf16 v[156:159], a[136:139], a[208:211], v[156:159]
v_mfma_f32_16x16x32_bf16 v[156:159], a[140:143], a[212:215], v[156:159]
v_mfma_f32_16x16x32_bf16 v[188:191], a[136:139], a[216:219], v[188:191]
v_mfma_f32_16x16x32_bf16 v[188:191], a[140:143], a[220:223], v[188:191]
v_mfma_f32_16x16x32_bf16 v[220:223], a[136:139], a[224:227], v[220:223]
v_mfma_f32_16x16x32_bf16 v[220:223], a[140:143], a[228:231], v[220:223]
v_mfma_f32_16x16x32_bf16 v[252:255], a[136:139], a[232:235], v[252:255]
v_mfma_f32_16x16x32_bf16 v[252:255], a[140:143], a[236:239], v[252:255]
ds_read_b64_tr_b16 a[136:137], v43 offset:16392
ds_read_b64_tr_b16 a[138:139], v43 offset:17416
ds_read_b64_tr_b16 a[140:141], v43 offset:24584
ds_read_b64_tr_b16 a[142:143], v43 offset:25608
s_waitcnt lgkmcnt(15)
v_mfma_f32_16x16x32_bf16 v[64:67], a[80:83], a[144:147], v[64:67]
v_mfma_f32_16x16x32_bf16 v[64:67], a[84:87], a[148:151], v[64:67]
v_mfma_f32_16x16x32_bf16 v[96:99], a[80:83], a[152:155], v[96:99]
v_mfma_f32_16x16x32_bf16 v[96:99], a[84:87], a[156:159], v[96:99]
v_mfma_f32_16x16x32_bf16 v[128:131], a[80:83], a[160:163], v[128:131]
v_mfma_f32_16x16x32_bf16 v[128:131], a[84:87], a[164:167], v[128:131]
v_mfma_f32_16x16x32_bf16 v[160:163], a[80:83], a[168:171], v[160:163]
v_mfma_f32_16x16x32_bf16 v[160:163], a[84:87], a[172:175], v[160:163]
v_mfma_f32_16x16x32_bf16 v[192:195], a[80:83], a[176:179], v[192:195]
v_mfma_f32_16x16x32_bf16 v[192:195], a[84:87], a[180:183], v[192:195]
v_mfma_f32_16x16x32_bf16 v[224:227], a[80:83], a[184:187], v[224:227]
s_waitcnt vmcnt(8) lgkmcnt(0)
v_mfma_f32_16x16x32_bf16 v[224:227], a[84:87], a[188:191], v[224:227]
s_barrier
v_mfma_f32_16x16x32_bf16 v[68:71], a[88:91], a[144:147], v[68:71]
ds_read_b64_tr_b16 a[80:81], v40 offset:32768
ds_read_b64_tr_b16 a[82:83], v40 offset:33792
v_mfma_f32_16x16x32_bf16 v[68:71], a[92:95], a[148:151], v[68:71]
ds_read_b64_tr_b16 a[84:85], v40 offset:40960
ds_read_b64_tr_b16 a[86:87], v40 offset:41984
v_mfma_f32_16x16x32_bf16 v[100:103], a[88:91], a[152:155], v[100:103]
ds_read_b128 a[192:195], v52 offset:24576
ds_read_b128 a[196:199], v53 offset:24576
v_mfma_f32_16x16x32_bf16 v[100:103], a[92:95], a[156:159], v[100:103]
ds_read_b128 a[200:203], v52 offset:26624
ds_read_b128 a[204:207], v53 offset:26624
v_mfma_f32_16x16x32_bf16 v[132:135], a[88:91], a[160:163], v[132:135]
ds_read_b128 a[208:211], v52 offset:28672
ds_read_b128 a[212:215], v53 offset:28672
v_mfma_f32_16x16x32_bf16 v[132:135], a[92:95], a[164:167], v[132:135]
ds_read_b128 a[216:219], v52 offset:30720
ds_read_b128 a[220:223], v53 offset:30720
v_mfma_f32_16x16x32_bf16 v[164:167], a[88:91], a[168:171], v[164:167]
ds_read_b128 a[224:227], v52 offset:32768
ds_read_b128 a[228:231], v53 offset:32768
v_mfma_f32_16x16x32_bf16 v[164:167], a[92:95], a[172:175], v[164:167]
ds_read_b128 a[232:235], v52 offset:34816
ds_read_b128 a[236:239], v53 offset:34816
v_mfma_f32_16x16x32_bf16 v[196:199], a[88:91], a[176:179], v[196:199]
s_add_u32 m0, s54, 16384
v_mfma_f32_16x16x32_bf16 v[196:199], a[92:95], a[180:183], v[196:199]
s_and_b32 s55, s30, 0x3ffff
v_mfma_f32_16x16x32_bf16 v[228:231], a[88:91], a[184:187], v[228:231]
s_add_u32 s30, s30, 4096
v_mfma_f32_16x16x32_bf16 v[228:231], a[92:95], a[188:191], v[228:231]
ds_read_b64_tr_b16 a[88:89], v40 offset:32776
ds_read_b64_tr_b16 a[90:91], v40 offset:33800
v_mfma_f32_16x16x32_bf16 v[72:75], a[96:99], a[144:147], v[72:75]
ds_read_b64_tr_b16 a[92:93], v40 offset:40968
ds_read_b64_tr_b16 a[94:95], v40 offset:41992
v_mfma_f32_16x16x32_bf16 v[72:75], a[100:103], a[148:151], v[72:75]
v_mfma_f32_16x16x32_bf16 v[104:107], a[96:99], a[152:155], v[104:107]
v_mfma_f32_16x16x32_bf16 v[104:107], a[100:103], a[156:159], v[104:107]
buffer_load_dwordx4 v16, s[12:15], s55 offen offset:0 sc1 nt lds
v_mfma_f32_16x16x32_bf16 v[136:139], a[96:99], a[160:163], v[136:139]
v_mfma_f32_16x16x32_bf16 v[136:139], a[100:103], a[164:167], v[136:139]
v_mfma_f32_16x16x32_bf16 v[168:171], a[96:99], a[168:171], v[168:171]
buffer_load_dwordx4 v17, s[12:15], s55 offen offset:1024 sc1 nt lds
v_mfma_f32_16x16x32_bf16 v[168:171], a[100:103], a[172:175], v[168:171]
v_mfma_f32_16x16x32_bf16 v[200:203], a[96:99], a[176:179], v[200:203]
v_mfma_f32_16x16x32_bf16 v[200:203], a[100:103], a[180:183], v[200:203]
buffer_load_dwordx4 v18, s[12:15], s55 offen offset:2048 sc1 nt lds
v_mfma_f32_16x16x32_bf16 v[232:235], a[96:99], a[184:187], v[232:235]
v_mfma_f32_16x16x32_bf16 v[232:235], a[100:103], a[188:191], v[232:235]
ds_read_b64_tr_b16 a[96:97], v41 offset:32768
ds_read_b64_tr_b16 a[98:99], v41 offset:33792
v_mfma_f32_16x16x32_bf16 v[76:79], a[104:107], a[144:147], v[76:79]
ds_read_b64_tr_b16 a[100:101], v41 offset:40960
ds_read_b64_tr_b16 a[102:103], v41 offset:41984
v_mfma_f32_16x16x32_bf16 v[76:79], a[108:111], a[148:151], v[76:79]
v_mfma_f32_16x16x32_bf16 v[108:111], a[104:107], a[152:155], v[108:111]
v_mfma_f32_16x16x32_bf16 v[108:111], a[108:111], a[156:159], v[108:111]
buffer_load_dwordx4 v19, s[12:15], s55 offen offset:3072 sc1 nt lds
v_mfma_f32_16x16x32_bf16 v[140:143], a[104:107], a[160:163], v[140:143]
s_add_u32 m0, s54, 20480
v_mfma_f32_16x16x32_bf16 v[140:143], a[108:111], a[164:167], v[140:143]
s_and_b32 s55, s30, 0x3ffff
v_mfma_f32_16x16x32_bf16 v[172:175], a[104:107], a[168:171], v[172:175]
s_add_u32 s30, s30, s101
v_mfma_f32_16x16x32_bf16 v[172:175], a[108:111], a[172:175], v[172:175]
v_mfma_f32_16x16x32_bf16 v[204:207], a[104:107], a[176:179], v[204:207]
v_mfma_f32_16x16x32_bf16 v[204:207], a[108:111], a[180:183], v[204:207]
buffer_load_dwordx4 v16, s[12:15], s55 offen offset:0 sc1 nt lds
v_mfma_f32_16x16x32_bf16 v[236:239], a[104:107], a[184:187], v[236:239]
v_mfma_f32_16x16x32_bf16 v[236:239], a[108:111], a[188:191], v[236:239]
ds_read_b64_tr_b16 a[104:105], v41 offset:32776
ds_read_b64_tr_b16 a[106:107], v41 offset:33800
v_mfma_f32_16x16x32_bf16 v[80:83], a[112:115], a[144:147], v[80:83]
ds_read_b64_tr_b16 a[108:109], v41 offset:40968
ds_read_b64_tr_b16 a[110:111], v41 offset:41992
v_mfma_f32_16x16x32_bf16 v[80:83], a[116:119], a[148:151], v[80:83]
v_mfma_f32_16x16x32_bf16 v[112:115], a[112:115], a[152:155], v[112:115]
v_mfma_f32_16x16x32_bf16 v[112:115], a[116:119], a[156:159], v[112:115]
buffer_load_dwordx4 v17, s[12:15], s55 offen offset:1024 sc1 nt lds
v_mfma_f32_16x16x32_bf16 v[144:147], a[112:115], a[160:163], v[144:147]
v_mfma_f32_16x16x32_bf16 v[144:147], a[116:119], a[164:167], v[144:147]
v_mfma_f32_16x16x32_bf16 v[176:179], a[112:115], a[168:171], v[176:179]
buffer_load_dwordx4 v18, s[12:15], s55 offen offset:2048 sc1 nt lds
v_mfma_f32_16x16x32_bf16 v[176:179], a[116:119], a[172:175], v[176:179]
v_mfma_f32_16x16x32_bf16 v[208:211], a[112:115], a[176:179], v[208:211]
v_mfma_f32_16x16x32_bf16 v[208:211], a[116:119], a[180:183], v[208:211]
buffer_load_dwordx4 v19, s[12:15], s55 offen offset:3072 sc1 nt lds
v_mfma_f32_16x16x32_bf16 v[240:243], a[112:115], a[184:187], v[240:243]
v_mfma_f32_16x16x32_bf16 v[240:243], a[116:119], a[188:191], v[240:243]
ds_read_b64_tr_b16 a[112:113], v42 offset:32768
ds_read_b64_tr_b16 a[114:115], v42 offset:33792
v_mfma_f32_16x16x32_bf16 v[84:87], a[120:123], a[144:147], v[84:87]
ds_read_b64_tr_b16 a[116:117], v42 offset:40960
ds_read_b64_tr_b16 a[118:119], v42 offset:41984
v_mfma_f32_16x16x32_bf16 v[84:87], a[124:127], a[148:151], v[84:87]
v_mfma_f32_16x16x32_bf16 v[116:119], a[120:123], a[152:155], v[116:119]
v_mfma_f32_16x16x32_bf16 v[116:119], a[124:127], a[156:159], v[116:119]
v_mfma_f32_16x16x32_bf16 v[148:151], a[120:123], a[160:163], v[148:151]
v_mfma_f32_16x16x32_bf16 v[148:151], a[124:127], a[164:167], v[148:151]
v_mfma_f32_16x16x32_bf16 v[180:183], a[120:123], a[168:171], v[180:183]
v_mfma_f32_16x16x32_bf16 v[180:183], a[124:127], a[172:175], v[180:183]
v_mfma_f32_16x16x32_bf16 v[212:215], a[120:123], a[176:179], v[212:215]
v_mfma_f32_16x16x32_bf16 v[212:215], a[124:127], a[180:183], v[212:215]
v_mfma_f32_16x16x32_bf16 v[244:247], a[120:123], a[184:187], v[244:247]
v_mfma_f32_16x16x32_bf16 v[244:247], a[124:127], a[188:191], v[244:247]
ds_read_b64_tr_b16 a[120:121], v42 offset:32776
ds_read_b64_tr_b16 a[122:123], v42 offset:33800
v_mfma_f32_16x16x32_bf16 v[88:91], a[128:131], a[144:147], v[88:91]
ds_read_b64_tr_b16 a[124:125], v42 offset:40968
ds_read_b64_tr_b16 a[126:127], v42 offset:41992
v_mfma_f32_16x16x32_bf16 v[88:91], a[132:135], a[148:151], v[88:91]
v_mfma_f32_16x16x32_bf16 v[120:123], a[128:131], a[152:155], v[120:123]
v_mfma_f32_16x16x32_bf16 v[120:123], a[132:135], a[156:159], v[120:123]
v_mfma_f32_16x16x32_bf16 v[152:155], a[128:131], a[160:163], v[152:155]
v_mfma_f32_16x16x32_bf16 v[152:155], a[132:135], a[164:167], v[152:155]
v_mfma_f32_16x16x32_bf16 v[184:187], a[128:131], a[168:171], v[184:187]
v_mfma_f32_16x16x32_bf16 v[184:187], a[132:135], a[172:175], v[184:187]
v_mfma_f32_16x16x32_bf16 v[216:219], a[128:131], a[176:179], v[216:219]
v_mfma_f32_16x16x32_bf16 v[216:219], a[132:135], a[180:183], v[216:219]
v_mfma_f32_16x16x32_bf16 v[248:251], a[128:131], a[184:187], v[248:251]
v_mfma_f32_16x16x32_bf16 v[248:251], a[132:135], a[188:191], v[248:251]
ds_read_b64_tr_b16 a[128:129], v43 offset:32768
ds_read_b64_tr_b16 a[130:131], v43 offset:33792
v_mfma_f32_16x16x32_bf16 v[92:95], a[136:139], a[144:147], v[92:95]
ds_read_b64_tr_b16 a[132:133], v43 offset:40960
ds_read_b64_tr_b16 a[134:135], v43 offset:41984
v_mfma_f32_16x16x32_bf16 v[92:95], a[140:143], a[148:151], v[92:95]
v_mfma_f32_16x16x32_bf16 v[124:127], a[136:139], a[152:155], v[124:127]
v_mfma_f32_16x16x32_bf16 v[124:127], a[140:143], a[156:159], v[124:127]
v_mfma_f32_16x16x32_bf16 v[156:159], a[136:139], a[160:163], v[156:159]
v_mfma_f32_16x16x32_bf16 v[156:159], a[140:143], a[164:167], v[156:159]
v_mfma_f32_16x16x32_bf16 v[188:191], a[136:139], a[168:171], v[188:191]
v_mfma_f32_16x16x32_bf16 v[188:191], a[140:143], a[172:175], v[188:191]
v_mfma_f32_16x16x32_bf16 v[220:223], a[136:139], a[176:179], v[220:223]
v_mfma_f32_16x16x32_bf16 v[220:223], a[140:143], a[180:183], v[220:223]
v_mfma_f32_16x16x32_bf16 v[252:255], a[136:139], a[184:187], v[252:255]
v_mfma_f32_16x16x32_bf16 v[252:255], a[140:143], a[188:191], v[252:255]
ds_read_b64_tr_b16 a[136:137], v43 offset:32776
ds_read_b64_tr_b16 a[138:139], v43 offset:33800
ds_read_b64_tr_b16 a[140:141], v43 offset:40968
ds_read_b64_tr_b16 a[142:143], v43 offset:41992
s_waitcnt lgkmcnt(15)
v_mfma_f32_16x16x32_bf16 v[64:67], a[80:83], a[192:195], v[64:67]
v_accvgpr_write_b32 a144, 0
v_accvgpr_write_b32 a145, 0
v_mfma_f32_16x16x32_bf16 v[64:67], a[84:87], a[196:199], v[64:67]
v_accvgpr_write_b32 a146, 0
v_accvgpr_write_b32 a147, 0
v_mfma_f32_16x16x32_bf16 v[96:99], a[80:83], a[200:203], v[96:99]
v_accvgpr_write_b32 a148, 0
v_accvgpr_write_b32 a149, 0
v_mfma_f32_16x16x32_bf16 v[96:99], a[84:87], a[204:207], v[96:99]
v_accvgpr_write_b32 a150, 0
v_accvgpr_write_b32 a151, 0
v_mfma_f32_16x16x32_bf16 v[128:131], a[80:83], a[208:211], v[128:131]
v_accvgpr_write_b32 a152, 0
v_accvgpr_write_b32 a153, 0
v_mfma_f32_16x16x32_bf16 v[128:131], a[84:87], a[212:215], v[128:131]
v_accvgpr_write_b32 a154, 0
v_accvgpr_write_b32 a155, 0
v_mfma_f32_16x16x32_bf16 v[160:163], a[80:83], a[216:219], v[160:163]
v_accvgpr_write_b32 a156, 0
v_accvgpr_write_b32 a157, 0
v_mfma_f32_16x16x32_bf16 v[160:163], a[84:87], a[220:223], v[160:163]
v_accvgpr_write_b32 a158, 0
v_accvgpr_write_b32 a159, 0
v_mfma_f32_16x16x32_bf16 v[192:195], a[80:83], a[224:227], v[192:195]
v_accvgpr_write_b32 a160, 0
v_accvgpr_write_b32 a161, 0
v_mfma_f32_16x16x32_bf16 v[192:195], a[84:87], a[228:231], v[192:195]
v_accvgpr_write_b32 a162, 0
v_accvgpr_write_b32 a163, 0
v_mfma_f32_16x16x32_bf16 v[224:227], a[80:83], a[232:235], v[224:227]
v_accvgpr_write_b32 a164, 0
v_accvgpr_write_b32 a165, 0
v_mfma_f32_16x16x32_bf16 v[224:227], a[84:87], a[236:239], v[224:227]
s_waitcnt lgkmcnt(0)
v_accvgpr_write_b32 a166, 0
v_accvgpr_write_b32 a167, 0
v_mfma_f32_16x16x32_bf16 v[68:71], a[88:91], a[192:195], v[68:71]
buffer_load_dword v56, v54, s[88:91], 0 offen
v_mfma_f32_16x16x32_bf16 v[68:71], a[92:95], a[196:199], v[68:71]
v_accvgpr_write_b32 a168, 0
v_accvgpr_write_b32 a169, 0
v_mfma_f32_16x16x32_bf16 v[100:103], a[88:91], a[200:203], v[100:103]
v_accvgpr_write_b32 a170, 0
v_accvgpr_write_b32 a171, 0
v_mfma_f32_16x16x32_bf16 v[100:103], a[92:95], a[204:207], v[100:103]
buffer_load_dword v56, v55, s[88:91], 0 offen
v_mfma_f32_16x16x32_bf16 v[132:135], a[88:91], a[208:211], v[132:135]
v_accvgpr_write_b32 a172, 0
v_accvgpr_write_b32 a173, 0
v_mfma_f32_16x16x32_bf16 v[132:135], a[92:95], a[212:215], v[132:135]
v_accvgpr_write_b32 a174, 0
v_accvgpr_write_b32 a175, 0
v_mfma_f32_16x16x32_bf16 v[164:167], a[88:91], a[216:219], v[164:167]
v_accvgpr_write_b32 a176, 0
v_accvgpr_write_b32 a177, 0
v_mfma_f32_16x16x32_bf16 v[164:167], a[92:95], a[220:223], v[164:167]
v_accvgpr_write_b32 a178, 0
v_accvgpr_write_b32 a179, 0
v_mfma_f32_16x16x32_bf16 v[196:199], a[88:91], a[224:227], v[196:199]
v_accvgpr_write_b32 a180, 0
v_accvgpr_write_b32 a181, 0
v_mfma_f32_16x16x32_bf16 v[196:199], a[92:95], a[228:231], v[196:199]
v_accvgpr_write_b32 a182, 0
v_accvgpr_write_b32 a183, 0
v_mfma_f32_16x16x32_bf16 v[228:231], a[88:91], a[232:235], v[228:231]
v_accvgpr_write_b32 a184, 0
v_accvgpr_write_b32 a185, 0
v_mfma_f32_16x16x32_bf16 v[228:231], a[92:95], a[236:239], v[228:231]
v_accvgpr_write_b32 a186, 0
v_accvgpr_write_b32 a187, 0
v_mfma_f32_16x16x32_bf16 v[72:75], a[96:99], a[192:195], v[72:75]
v_accvgpr_write_b32 a188, 0
v_accvgpr_write_b32 a189, 0
v_mfma_f32_16x16x32_bf16 v[72:75], a[100:103], a[196:199], v[72:75]
v_accvgpr_write_b32 a190, 0
v_accvgpr_write_b32 a191, 0
v_mfma_f32_16x16x32_bf16 v[104:107], a[96:99], a[200:203], v[104:107]
v_add_u32 v14, 0, v2
v_mul_u32_u24 v15, 3277, v14
v_mfma_f32_16x16x32_bf16 v[104:107], a[100:103], a[204:207], v[104:107]
v_lshrrev_b32 v15, 16, v15
v_mul_u32_u24 v34, 20, v15
v_mfma_f32_16x16x32_bf16 v[136:139], a[96:99], a[208:211], v[136:139]
v_sub_u32 v14, v14, v34
v_bfe_u32 v34, v15, 2, 1
v_mfma_f32_16x16x32_bf16 v[136:139], a[100:103], a[212:215], v[136:139]
v_lshlrev_b32 v34, 1, v34
v_xor_b32 v14, v14, v34
v_mfma_f32_16x16x32_bf16 v[168:171], a[96:99], a[216:219], v[168:171]
v_mul_u32_u24 v15, 1280, v15
v_lshl_add_u32 v5, v14, 4, v15
v_mfma_f32_16x16x32_bf16 v[168:171], a[100:103], a[220:223], v[168:171]
v_add_u32 v14, 64, v2
v_mul_u32_u24 v15, 3277, v14
v_mfma_f32_16x16x32_bf16 v[200:203], a[96:99], a[224:227], v[200:203]
v_lshrrev_b32 v15, 16, v15
v_mul_u32_u24 v34, 20, v15
v_mfma_f32_16x16x32_bf16 v[200:203], a[100:103], a[228:231], v[200:203]
v_sub_u32 v14, v14, v34
v_bfe_u32 v34, v15, 2, 1
v_mfma_f32_16x16x32_bf16 v[232:235], a[96:99], a[232:235], v[232:235]
v_lshlrev_b32 v34, 1, v34
v_xor_b32 v14, v14, v34
v_mfma_f32_16x16x32_bf16 v[232:235], a[100:103], a[236:239], v[232:235]
v_mul_u32_u24 v15, 1280, v15
v_lshl_add_u32 v6, v14, 4, v15
v_mfma_f32_16x16x32_bf16 v[76:79], a[104:107], a[192:195], v[76:79]
v_subrev_u32 v6, 1024, v6
v_add_u32 v14, 128, v2
v_mfma_f32_16x16x32_bf16 v[76:79], a[108:111], a[196:199], v[76:79]
v_mul_u32_u24 v15, 3277, v14
v_lshrrev_b32 v15, 16, v15
v_mfma_f32_16x16x32_bf16 v[108:111], a[104:107], a[200:203], v[108:111]
v_mul_u32_u24 v34, 20, v15
v_sub_u32 v14, v14, v34
v_mfma_f32_16x16x32_bf16 v[108:111], a[108:111], a[204:207], v[108:111]
v_bfe_u32 v34, v15, 2, 1
v_lshlrev_b32 v34, 1, v34
v_mfma_f32_16x16x32_bf16 v[140:143], a[104:107], a[208:211], v[140:143]
v_xor_b32 v14, v14, v34
v_mul_u32_u24 v15, 1280, v15
v_mfma_f32_16x16x32_bf16 v[140:143], a[108:111], a[212:215], v[140:143]
v_lshl_add_u32 v7, v14, 4, v15
v_subrev_u32 v7, 2048, v7
v_mfma_f32_16x16x32_bf16 v[172:175], a[104:107], a[216:219], v[172:175]
v_add_u32 v14, 192, v2
v_mul_u32_u24 v15, 3277, v14
v_mfma_f32_16x16x32_bf16 v[172:175], a[108:111], a[220:223], v[172:175]
v_lshrrev_b32 v15, 16, v15
v_mul_u32_u24 v34, 20, v15
v_mfma_f32_16x16x32_bf16 v[204:207], a[104:107], a[224:227], v[204:207]
v_sub_u32 v14, v14, v34
v_bfe_u32 v34, v15, 2, 1
v_mfma_f32_16x16x32_bf16 v[204:207], a[108:111], a[228:231], v[204:207]
v_lshlrev_b32 v34, 1, v34
v_xor_b32 v14, v14, v34
v_mfma_f32_16x16x32_bf16 v[236:239], a[104:107], a[232:235], v[236:239]
v_mul_u32_u24 v15, 1280, v15
v_lshl_add_u32 v8, v14, 4, v15
v_mfma_f32_16x16x32_bf16 v[236:239], a[108:111], a[236:239], v[236:239]
v_subrev_u32 v8, 3072, v8
v_add_u32 v14, 256, v2
v_mfma_f32_16x16x32_bf16 v[80:83], a[112:115], a[192:195], v[80:83]
v_mul_u32_u24 v15, 3277, v14
v_lshrrev_b32 v15, 16, v15
v_mfma_f32_16x16x32_bf16 v[80:83], a[116:119], a[196:199], v[80:83]
v_mul_u32_u24 v34, 20, v15
v_sub_u32 v14, v14, v34
v_mfma_f32_16x16x32_bf16 v[112:115], a[112:115], a[200:203], v[112:115]
v_bfe_u32 v34, v15, 2, 1
v_lshlrev_b32 v34, 1, v34
v_mfma_f32_16x16x32_bf16 v[112:115], a[116:119], a[204:207], v[112:115]
v_xor_b32 v14, v14, v34
v_mul_u32_u24 v15, 1280, v15
v_mfma_f32_16x16x32_bf16 v[144:147], a[112:115], a[208:211], v[144:147]
v_lshl_add_u32 v9, v14, 4, v15
v_accvgpr_write_b32 a80, 0
v_mfma_f32_16x16x32_bf16 v[144:147], a[116:119], a[212:215], v[144:147]
v_accvgpr_write_b32 a81, 0
v_accvgpr_write_b32 a82, 0
v_mfma_f32_16x16x32_bf16 v[176:179], a[112:115], a[216:219], v[176:179]
v_accvgpr_write_b32 a83, 0
v_accvgpr_write_b32 a84, 0
v_mfma_f32_16x16x32_bf16 v[176:179], a[116:119], a[220:223], v[176:179]
v_accvgpr_write_b32 a85, 0
v_accvgpr_write_b32 a86, 0
v_mfma_f32_16x16x32_bf16 v[208:211], a[112:115], a[224:227], v[208:211]
v_accvgpr_write_b32 a87, 0
v_accvgpr_write_b32 a88, 0
v_mfma_f32_16x16x32_bf16 v[208:211], a[116:119], a[228:231], v[208:211]
v_accvgpr_write_b32 a89, 0
v_accvgpr_write_b32 a90, 0
v_mfma_f32_16x16x32_bf16 v[240:243], a[112:115], a[232:235], v[240:243]
v_accvgpr_write_b32 a91, 0
v_accvgpr_write_b32 a92, 0
v_mfma_f32_16x16x32_bf16 v[240:243], a[116:119], a[236:239], v[240:243]
v_accvgpr_write_b32 a93, 0
v_accvgpr_write_b32 a94, 0
v_mfma_f32_16x16x32_bf16 v[84:87], a[120:123], a[192:195], v[84:87]
v_accvgpr_write_b32 a95, 0
v_accvgpr_write_b32 a96, 0
v_mfma_f32_16x16x32_bf16 v[84:87], a[124:127], a[196:199], v[84:87]
v_accvgpr_write_b32 a97, 0
v_accvgpr_write_b32 a98, 0
v_mfma_f32_16x16x32_bf16 v[116:119], a[120:123], a[200:203], v[116:119]
v_accvgpr_write_b32 a99, 0
v_accvgpr_write_b32 a100, 0
v_mfma_f32_16x16x32_bf16 v[116:119], a[124:127], a[204:207], v[116:119]
v_accvgpr_write_b32 a101, 0
v_accvgpr_write_b32 a102, 0
v_mfma_f32_16x16x32_bf16 v[148:151], a[120:123], a[208:211], v[148:151]
v_accvgpr_write_b32 a103, 0
v_accvgpr_write_b32 a104, 0
v_mfma_f32_16x16x32_bf16 v[148:151], a[124:127], a[212:215], v[148:151]
v_accvgpr_write_b32 a105, 0
v_accvgpr_write_b32 a106, 0
v_mfma_f32_16x16x32_bf16 v[180:183], a[120:123], a[216:219], v[180:183]
v_accvgpr_write_b32 a107, 0
v_accvgpr_write_b32 a108, 0
v_mfma_f32_16x16x32_bf16 v[180:183], a[124:127], a[220:223], v[180:183]
v_accvgpr_write_b32 a109, 0
v_accvgpr_write_b32 a110, 0
v_mfma_f32_16x16x32_bf16 v[212:215], a[120:123], a[224:227], v[212:215]
v_accvgpr_write_b32 a111, 0
v_accvgpr_write_b32 a112, 0
v_mfma_f32_16x16x32_bf16 v[212:215], a[124:127], a[228:231], v[212:215]
v_accvgpr_write_b32 a113, 0
v_accvgpr_write_b32 a114, 0
v_mfma_f32_16x16x32_bf16 v[244:247], a[120:123], a[232:235], v[244:247]
v_accvgpr_write_b32 a115, 0
v_accvgpr_write_b32 a116, 0
v_mfma_f32_16x16x32_bf16 v[244:247], a[124:127], a[236:239], v[244:247]
v_accvgpr_write_b32 a117, 0
v_accvgpr_write_b32 a118, 0
v_mfma_f32_16x16x32_bf16 v[88:91], a[128:131], a[192:195], v[88:91]
v_accvgpr_write_b32 a119, 0
v_accvgpr_write_b32 a120, 0
v_mfma_f32_16x16x32_bf16 v[88:91], a[132:135], a[196:199], v[88:91]
v_accvgpr_write_b32 a121, 0
v_accvgpr_write_b32 a122, 0
v_mfma_f32_16x16x32_bf16 v[120:123], a[128:131], a[200:203], v[120:123]
v_accvgpr_write_b32 a123, 0
v_accvgpr_write_b32 a124, 0
v_mfma_f32_16x16x32_bf16 v[120:123], a[132:135], a[204:207], v[120:123]
v_accvgpr_write_b32 a125, 0
v_accvgpr_write_b32 a126, 0
v_mfma_f32_16x16x32_bf16 v[152:155], a[128:131], a[208:211], v[152:155]
v_accvgpr_write_b32 a127, 0
v_mfma_f32_16x16x32_bf16 v[152:155], a[132:135], a[212:215], v[152:155]
v_mfma_f32_16x16x32_bf16 v[184:187], a[128:131], a[216:219], v[184:187]
v_mfma_f32_16x16x32_bf16 v[184:187], a[132:135], a[220:223], v[184:187]
v_mfma_f32_16x16x32_bf16 v[216:219], a[128:131], a[224:227], v[216:219]
v_mfma_f32_16x16x32_bf16 v[216:219], a[132:135], a[228:231], v[216:219]
v_mfma_f32_16x16x32_bf16 v[248:251], a[128:131], a[232:235], v[248:251]
v_mfma_f32_16x16x32_bf16 v[248:251], a[132:135], a[236:239], v[248:251]
v_accvgpr_write_b32 a128, 0
v_accvgpr_write_b32 a129, 0
v_mfma_f32_16x16x32_bf16 v[92:95], a[136:139], a[192:195], v[92:95]
v_accvgpr_write_b32 a130, 0
v_accvgpr_write_b32 a131, 0
v_mfma_f32_16x16x32_bf16 v[92:95], a[140:143], a[196:199], v[92:95]
v_accvgpr_write_b32 a132, 0
v_accvgpr_write_b32 a133, 0
v_mfma_f32_16x16x32_bf16 v[124:127], a[136:139], a[200:203], v[124:127]
v_accvgpr_write_b32 a134, 0
v_accvgpr_write_b32 a135, 0
v_mfma_f32_16x16x32_bf16 v[124:127], a[140:143], a[204:207], v[124:127]
v_mfma_f32_16x16x32_bf16 v[156:159], a[136:139], a[208:211], v[156:159]
v_mfma_f32_16x16x32_bf16 v[156:159], a[140:143], a[212:215], v[156:159]
v_mfma_f32_16x16x32_bf16 v[188:191], a[136:139], a[216:219], v[188:191]
v_mfma_f32_16x16x32_bf16 v[188:191], a[140:143], a[220:223], v[188:191]
v_mfma_f32_16x16x32_bf16 v[220:223], a[136:139], a[224:227], v[220:223]
v_mfma_f32_16x16x32_bf16 v[220:223], a[140:143], a[228:231], v[220:223]
v_mfma_f32_16x16x32_bf16 v[252:255], a[136:139], a[232:235], v[252:255]
v_mfma_f32_16x16x32_bf16 v[252:255], a[140:143], a[236:239], v[252:255]
s_barrier
s_load_dwordx4 s[48:51], s[0:1], 80
s_lshl_b32 s41, s40, 2
s_add_u32 s42, s41, s23
s_add_u32 s41, s41, s28
s_add_u32 s8, s44, 31457280
s_addc_u32 s9, s45, 0
s_mov_b32 s10, 0x8000
s_mov_b32 s11, 0x20000
s_lshl_b32 s99, s41, 8
s_lshl_b32 s100, s42, 8
s_add_u32 s100, s100, 0x4000
v_mov_b32 v57, 0
buffer_load_dword v62, v57, s[8:11], s99 offen sc1
buffer_load_dword v63, v57, s[8:11], s100 offen sc1
v_accvgpr_write_b32 a136, 0
v_accvgpr_write_b32 a137, 0
v_accvgpr_write_b32 a138, 0
v_accvgpr_write_b32 a139, 0
v_accvgpr_write_b32 a140, 0
v_accvgpr_write_b32 a141, 0
v_accvgpr_write_b32 a142, 0
v_accvgpr_write_b32 a143, 0
v_pk_mul_f32 v[64:65], v[64:65], v[46:47]
v_pk_mul_f32 v[66:67], v[66:67], v[46:47]
v_cvt_pk_bf16_f32 v64, v64, v65
v_pk_mul_f32 v[68:69], v[68:69], v[46:47]
v_cvt_pk_bf16_f32 v65, v66, v67
v_pk_mul_f32 v[70:71], v[70:71], v[46:47]
v_cvt_pk_bf16_f32 v66, v68, v69
v_pk_mul_f32 v[72:73], v[72:73], v[46:47]
v_cvt_pk_bf16_f32 v67, v70, v71
v_pk_mul_f32 v[74:75], v[74:75], v[46:47]
v_cvt_pk_bf16_f32 v68, v72, v73
v_pk_mul_f32 v[76:77], v[76:77], v[46:47]
v_cvt_pk_bf16_f32 v69, v74, v75
v_pk_mul_f32 v[78:79], v[78:79], v[46:47]
v_cvt_pk_bf16_f32 v70, v76, v77
v_pk_mul_f32 v[80:81], v[80:81], v[46:47]
v_cvt_pk_bf16_f32 v71, v78, v79
v_pk_mul_f32 v[82:83], v[82:83], v[46:47]
v_cvt_pk_bf16_f32 v72, v80, v81
v_pk_mul_f32 v[84:85], v[84:85], v[46:47]
v_cvt_pk_bf16_f32 v73, v82, v83
v_pk_mul_f32 v[86:87], v[86:87], v[46:47]
v_cvt_pk_bf16_f32 v74, v84, v85
v_pk_mul_f32 v[88:89], v[88:89], v[46:47]
v_cvt_pk_bf16_f32 v75, v86, v87
v_pk_mul_f32 v[90:91], v[90:91], v[46:47]
v_cvt_pk_bf16_f32 v76, v88, v89
v_pk_mul_f32 v[92:93], v[92:93], v[46:47]
v_cvt_pk_bf16_f32 v77, v90, v91
v_pk_mul_f32 v[94:95], v[94:95], v[46:47]
v_cvt_pk_bf16_f32 v78, v92, v93
v_pk_mul_f32 v[96:97], v[96:97], v[46:47]
v_cvt_pk_bf16_f32 v79, v94, v95
v_pk_mul_f32 v[98:99], v[98:99], v[46:47]
v_cvt_pk_bf16_f32 v80, v96, v97
v_pk_mul_f32 v[100:101], v[100:101], v[46:47]
v_cvt_pk_bf16_f32 v81, v98, v99
v_pk_mul_f32 v[102:103], v[102:103], v[46:47]
v_cvt_pk_bf16_f32 v82, v100, v101
v_pk_mul_f32 v[104:105], v[104:105], v[46:47]
v_cvt_pk_bf16_f32 v83, v102, v103
v_pk_mul_f32 v[106:107], v[106:107], v[46:47]
v_cvt_pk_bf16_f32 v84, v104, v105
v_pk_mul_f32 v[108:109], v[108:109], v[46:47]
v_cvt_pk_bf16_f32 v85, v106, v107
v_pk_mul_f32 v[110:111], v[110:111], v[46:47]
v_cvt_pk_bf16_f32 v86, v108, v109
v_pk_mul_f32 v[112:113], v[112:113], v[46:47]
v_cvt_pk_bf16_f32 v87, v110, v111
v_pk_mul_f32 v[114:115], v[114:115], v[46:47]
v_cvt_pk_bf16_f32 v88, v112, v113
v_pk_mul_f32 v[116:117], v[116:117], v[46:47]
v_cvt_pk_bf16_f32 v89, v114, v115
v_pk_mul_f32 v[118:119], v[118:119], v[46:47]
v_cvt_pk_bf16_f32 v90, v116, v117
v_pk_mul_f32 v[120:121], v[120:121], v[46:47]
v_cvt_pk_bf16_f32 v91, v118, v119
v_pk_mul_f32 v[122:123], v[122:123], v[46:47]
v_cvt_pk_bf16_f32 v92, v120, v121
v_pk_mul_f32 v[124:125], v[124:125], v[46:47]
v_cvt_pk_bf16_f32 v93, v122, v123
v_pk_mul_f32 v[126:127], v[126:127], v[46:47]
v_cvt_pk_bf16_f32 v94, v124, v125
v_pk_mul_f32 v[128:129], v[128:129], v[46:47]
v_cvt_pk_bf16_f32 v95, v126, v127
v_pk_mul_f32 v[130:131], v[130:131], v[46:47]
v_cvt_pk_bf16_f32 v96, v128, v129
v_pk_mul_f32 v[132:133], v[132:133], v[46:47]
v_cvt_pk_bf16_f32 v97, v130, v131
v_pk_mul_f32 v[134:135], v[134:135], v[46:47]
v_cvt_pk_bf16_f32 v98, v132, v133
v_pk_mul_f32 v[136:137], v[136:137], v[46:47]
v_cvt_pk_bf16_f32 v99, v134, v135
v_pk_mul_f32 v[138:139], v[138:139], v[46:47]
v_cvt_pk_bf16_f32 v100, v136, v137
v_pk_mul_f32 v[140:141], v[140:141], v[46:47]
v_cvt_pk_bf16_f32 v101, v138, v139
v_pk_mul_f32 v[142:143], v[142:143], v[46:47]
v_cvt_pk_bf16_f32 v102, v140, v141
v_pk_mul_f32 v[144:145], v[144:145], v[46:47]
v_cvt_pk_bf16_f32 v103, v142, v143
v_pk_mul_f32 v[146:147], v[146:147], v[46:47]
v_cvt_pk_bf16_f32 v104, v144, v145
v_pk_mul_f32 v[148:149], v[148:149], v[46:47]
v_cvt_pk_bf16_f32 v105, v146, v147
v_pk_mul_f32 v[150:151], v[150:151], v[46:47]
v_cvt_pk_bf16_f32 v106, v148, v149
v_pk_mul_f32 v[152:153], v[152:153], v[46:47]
v_cvt_pk_bf16_f32 v107, v150, v151
v_pk_mul_f32 v[154:155], v[154:155], v[46:47]
v_cvt_pk_bf16_f32 v108, v152, v153
v_pk_mul_f32 v[156:157], v[156:157], v[46:47]
v_cvt_pk_bf16_f32 v109, v154, v155
v_pk_mul_f32 v[158:159], v[158:159], v[46:47]
v_cvt_pk_bf16_f32 v110, v156, v157
v_pk_mul_f32 v[160:161], v[160:161], v[46:47]
v_cvt_pk_bf16_f32 v111, v158, v159
v_pk_mul_f32 v[162:163], v[162:163], v[46:47]
v_cvt_pk_bf16_f32 v112, v160, v161
v_pk_mul_f32 v[164:165], v[164:165], v[46:47]
v_cvt_pk_bf16_f32 v113, v162, v163
v_pk_mul_f32 v[166:167], v[166:167], v[46:47]
v_cvt_pk_bf16_f32 v114, v164, v165
v_pk_mul_f32 v[168:169], v[168:169], v[46:47]
v_cvt_pk_bf16_f32 v115, v166, v167
v_pk_mul_f32 v[170:171], v[170:171], v[46:47]
v_cvt_pk_bf16_f32 v116, v168, v169
v_pk_mul_f32 v[172:173], v[172:173], v[46:47]
v_cvt_pk_bf16_f32 v117, v170, v171
v_pk_mul_f32 v[174:175], v[174:175], v[46:47]
v_cvt_pk_bf16_f32 v118, v172, v173
v_pk_mul_f32 v[176:177], v[176:177], v[46:47]
v_cvt_pk_bf16_f32 v119, v174, v175
v_pk_mul_f32 v[178:179], v[178:179], v[46:47]
v_cvt_pk_bf16_f32 v120, v176, v177
v_pk_mul_f32 v[180:181], v[180:181], v[46:47]
v_cvt_pk_bf16_f32 v121, v178, v179
v_pk_mul_f32 v[182:183], v[182:183], v[46:47]
v_cvt_pk_bf16_f32 v122, v180, v181
v_pk_mul_f32 v[184:185], v[184:185], v[46:47]
v_cvt_pk_bf16_f32 v123, v182, v183
v_pk_mul_f32 v[186:187], v[186:187], v[46:47]
v_cvt_pk_bf16_f32 v124, v184, v185
v_pk_mul_f32 v[188:189], v[188:189], v[46:47]
v_cvt_pk_bf16_f32 v125, v186, v187
v_pk_mul_f32 v[190:191], v[190:191], v[46:47]
v_cvt_pk_bf16_f32 v126, v188, v189
v_pk_mul_f32 v[192:193], v[192:193], v[46:47]
v_cvt_pk_bf16_f32 v127, v190, v191
v_pk_mul_f32 v[194:195], v[194:195], v[46:47]
v_cvt_pk_bf16_f32 v128, v192, v193
v_pk_mul_f32 v[196:197], v[196:197], v[46:47]
v_cvt_pk_bf16_f32 v129, v194, v195
v_pk_mul_f32 v[198:199], v[198:199], v[46:47]
v_cvt_pk_bf16_f32 v130, v196, v197
v_pk_mul_f32 v[200:201], v[200:201], v[46:47]
v_cvt_pk_bf16_f32 v131, v198, v199
v_pk_mul_f32 v[202:203], v[202:203], v[46:47]
v_cvt_pk_bf16_f32 v132, v200, v201
v_pk_mul_f32 v[204:205], v[204:205], v[46:47]
v_cvt_pk_bf16_f32 v133, v202, v203
v_pk_mul_f32 v[206:207], v[206:207], v[46:47]
v_cvt_pk_bf16_f32 v134, v204, v205
v_pk_mul_f32 v[208:209], v[208:209], v[46:47]
v_cvt_pk_bf16_f32 v135, v206, v207
v_pk_mul_f32 v[210:211], v[210:211], v[46:47]
v_cvt_pk_bf16_f32 v136, v208, v209
v_pk_mul_f32 v[212:213], v[212:213], v[46:47]
v_cvt_pk_bf16_f32 v137, v210, v211
v_pk_mul_f32 v[214:215], v[214:215], v[46:47]
v_cvt_pk_bf16_f32 v138, v212, v213
v_pk_mul_f32 v[216:217], v[216:217], v[46:47]
v_cvt_pk_bf16_f32 v139, v214, v215
v_pk_mul_f32 v[218:219], v[218:219], v[46:47]
v_cvt_pk_bf16_f32 v140, v216, v217
v_pk_mul_f32 v[220:221], v[220:221], v[46:47]
v_cvt_pk_bf16_f32 v141, v218, v219
v_pk_mul_f32 v[222:223], v[222:223], v[46:47]
v_cvt_pk_bf16_f32 v142, v220, v221
v_pk_mul_f32 v[224:225], v[224:225], v[46:47]
v_cvt_pk_bf16_f32 v143, v222, v223
v_pk_mul_f32 v[226:227], v[226:227], v[46:47]
v_cvt_pk_bf16_f32 v144, v224, v225
v_pk_mul_f32 v[228:229], v[228:229], v[46:47]
v_cvt_pk_bf16_f32 v145, v226, v227
v_pk_mul_f32 v[230:231], v[230:231], v[46:47]
v_cvt_pk_bf16_f32 v146, v228, v229
v_pk_mul_f32 v[232:233], v[232:233], v[46:47]
v_cvt_pk_bf16_f32 v147, v230, v231
v_pk_mul_f32 v[234:235], v[234:235], v[46:47]
v_cvt_pk_bf16_f32 v148, v232, v233
v_pk_mul_f32 v[236:237], v[236:237], v[46:47]
v_cvt_pk_bf16_f32 v149, v234, v235
v_pk_mul_f32 v[238:239], v[238:239], v[46:47]
v_cvt_pk_bf16_f32 v150, v236, v237
v_pk_mul_f32 v[240:241], v[240:241], v[46:47]
v_cvt_pk_bf16_f32 v151, v238, v239
v_pk_mul_f32 v[242:243], v[242:243], v[46:47]
v_cvt_pk_bf16_f32 v152, v240, v241
v_pk_mul_f32 v[244:245], v[244:245], v[46:47]
v_cvt_pk_bf16_f32 v153, v242, v243
v_pk_mul_f32 v[246:247], v[246:247], v[46:47]
v_cvt_pk_bf16_f32 v154, v244, v245
v_pk_mul_f32 v[248:249], v[248:249], v[46:47]
v_cvt_pk_bf16_f32 v155, v246, v247
v_pk_mul_f32 v[250:251], v[250:251], v[46:47]
v_cvt_pk_bf16_f32 v156, v248, v249
v_pk_mul_f32 v[252:253], v[252:253], v[46:47]
v_cvt_pk_bf16_f32 v157, v250, v251
v_pk_mul_f32 v[254:255], v[254:255], v[46:47]
v_cvt_pk_bf16_f32 v158, v252, v253
v_cvt_pk_bf16_f32 v159, v254, v255
s_waitcnt lgkmcnt(0)
s_waitcnt vmcnt(12)
s_barrier
ds_read_b128 v[176:179], v45 offset:0
ds_read_b128 v[180:183], v45 offset:64
ds_read_b128 v[184:187], v45 offset:128
ds_read_b128 v[188:191], v45 offset:192
ds_read_b128 a[192:195], v20 offset:0
ds_read_b128 a[196:199], v21 offset:0
ds_read_b128 a[200:203], v22 offset:0
ds_read_b128 a[204:207], v23 offset:0
ds_read_b128 a[208:211], v20 offset:4096
ds_read_b128 a[212:215], v21 offset:4096
ds_read_b128 a[216:219], v22 offset:4096
ds_read_b128 a[220:223], v23 offset:4096
v_mov_b32 v232, 0
v_mov_b32 v233, 0
v_mov_b32 v234, 0
v_mov_b32 v235, 0
v_mov_b32 v236, 0
v_mov_b32 v237, 0
v_mov_b32 v238, 0
v_mov_b32 v239, 0
v_mov_b32 v240, 0
v_mov_b32 v241, 0
v_mov_b32 v242, 0
v_mov_b32 v243, 0
v_mov_b32 v244, 0
v_mov_b32 v245, 0
v_mov_b32 v246, 0
v_mov_b32 v247, 0
v_mov_b32 v248, 0
v_mov_b32 v249, 0
v_mov_b32 v250, 0
v_mov_b32 v251, 0
v_mov_b32 v252, 0
v_mov_b32 v253, 0
v_mov_b32 v254, 0
v_mov_b32 v255, 0
s_waitcnt lgkmcnt(8)
v_xor_b32 v176, 0x80008000, v176
v_xor_b32 v177, 0x80008000, v177
v_xor_b32 v178, 0x80008000, v178
v_xor_b32 v179, 0x80008000, v179
v_xor_b32 v180, 0x80008000, v180
v_xor_b32 v181, 0x80008000, v181
v_xor_b32 v182, 0x80008000, v182
v_xor_b32 v183, 0x80008000, v183
v_xor_b32 v184, 0x80008000, v184
v_xor_b32 v185, 0x80008000, v185
v_xor_b32 v186, 0x80008000, v186
v_xor_b32 v187, 0x80008000, v187
v_xor_b32 v188, 0x80008000, v188
v_xor_b32 v189, 0x80008000, v189
v_xor_b32 v190, 0x80008000, v190
v_xor_b32 v191, 0x80008000, v191
s_nop 1
v_mfma_f32_16x16x32_bf16 v[208:211], v[176:179], v[64:67], 0
s_add_u32 m0, s54, 32768
v_mfma_f32_16x16x32_bf16 v[208:211], v[180:183], v[68:71], v[208:211]
s_and_b32 s55, s30, 0x3ffff
v_mfma_f32_16x16x32_bf16 v[208:211], v[184:187], v[72:75], v[208:211]
s_add_u32 s30, s30, 4096
v_mfma_f32_16x16x32_bf16 v[208:211], v[188:191], v[76:79], v[208:211]
v_and_b32 v14, 1, v4
v_xor_b32 v15, 1, v14
v_mfma_f32_16x16x32_bf16 v[212:215], v[176:179], v[80:83], 0
buffer_load_dwordx4 v16, s[12:15], s55 offen offset:0 sc1 nt lds
v_mfma_f32_16x16x32_bf16 v[212:215], v[180:183], v[84:87], v[212:215]
v_lshrrev_b32 v34, 2, v3
v_lshl_add_u32 v34, v4, 2, v34
v_mfma_f32_16x16x32_bf16 v[212:215], v[184:187], v[88:91], v[212:215]
buffer_load_dwordx4 v17, s[12:15], s55 offen offset:1024 sc1 nt lds
v_mfma_f32_16x16x32_bf16 v[212:215], v[188:191], v[92:95], v[212:215]
v_mul_u32_u24 v34, 320, v34
v_and_b32 v35, 3, v3
v_mfma_f32_16x16x32_bf16 v[216:219], v[176:179], v[96:99], 0
buffer_load_dwordx4 v18, s[12:15], s55 offen offset:2048 sc1 nt lds
v_mfma_f32_16x16x32_bf16 v[216:219], v[180:183], v[100:103], v[216:219]
v_lshl_add_u32 v34, v35, 3, v34
v_add_u32 v34, s46, v34
v_mfma_f32_16x16x32_bf16 v[216:219], v[184:187], v[104:107], v[216:219]
buffer_load_dwordx4 v19, s[12:15], s55 offen offset:3072 sc1 nt lds
v_mfma_f32_16x16x32_bf16 v[216:219], v[188:191], v[108:111], v[216:219]
s_add_u32 m0, s54, 36864
v_mfma_f32_16x16x32_bf16 v[220:223], v[176:179], v[112:115], 0
s_and_b32 s55, s30, 0x3ffff
v_mfma_f32_16x16x32_bf16 v[220:223], v[180:183], v[116:119], v[220:223]
s_add_u32 s30, s30, s101
v_mfma_f32_16x16x32_bf16 v[220:223], v[184:187], v[120:123], v[220:223]
buffer_load_dwordx4 v16, s[12:15], s55 offen offset:0 sc1 nt lds
v_mfma_f32_16x16x32_bf16 v[220:223], v[188:191], v[124:127], v[220:223]
v_lshl_add_u32 v36, v14, 5, v34
v_lshl_add_u32 v37, v15, 5, v34
v_mfma_f32_16x16x32_bf16 v[224:227], v[176:179], v[128:131], 0
v_add_u32 v38, 128, v37
v_add_u32 v39, 192, v36
v_mfma_f32_16x16x32_bf16 v[224:227], v[180:183], v[132:135], v[224:227]
s_cmp_eq_u32 s21, 1
s_cselect_b64 s[32:33], -1, 0
v_cndmask_b32 v10, v36, v38, s[32:33]
v_mfma_f32_16x16x32_bf16 v[224:227], v[184:187], v[136:139], v[224:227]
v_cndmask_b32 v11, v37, v39, s[32:33]
v_cndmask_b32 v12, v38, v36, s[32:33]
v_mfma_f32_16x16x32_bf16 v[224:227], v[188:191], v[140:143], v[224:227]
v_cndmask_b32 v13, v39, v37, s[32:33]
v_mul_u32_u24 v34, 2560, v3
v_mfma_f32_16x16x32_bf16 v[228:231], v[176:179], v[144:147], 0
v_lshl_add_u32 v34, v4, 3, v34
v_lshlrev_b32 v35, 7, v0
v_mfma_f32_16x16x32_bf16 v[228:231], v[180:183], v[148:151], v[228:231]
v_add_u32 v36, 0x8000, v35
v_mfma_f32_16x16x32_bf16 v[228:231], v[184:187], v[152:155], v[228:231]
v_mfma_f32_16x16x32_bf16 v[228:231], v[188:191], v[156:159], v[228:231]
s_waitcnt lgkmcnt(0)
v_mfma_f32_16x16x32_bf16 v[160:163], a[192:195], v[64:67], v[208:211]
v_mfma_f32_16x16x32_bf16 v[160:163], a[196:199], v[68:71], v[160:163]
v_mfma_f32_16x16x32_bf16 v[160:163], a[200:203], v[72:75], v[160:163]
v_mfma_f32_16x16x32_bf16 v[160:163], a[204:207], v[76:79], v[160:163]
v_mfma_f32_16x16x32_bf16 v[164:167], a[208:211], v[64:67], v[208:211]
v_mfma_f32_16x16x32_bf16 v[164:167], a[212:215], v[68:71], v[164:167]
v_mfma_f32_16x16x32_bf16 v[164:167], a[216:219], v[72:75], v[164:167]
v_mfma_f32_16x16x32_bf16 v[164:167], a[220:223], v[76:79], v[164:167]
v_mfma_f32_16x16x32_bf16 v[168:171], a[192:195], v[80:83], v[212:215]
v_mfma_f32_16x16x32_bf16 v[168:171], a[196:199], v[84:87], v[168:171]
v_mfma_f32_16x16x32_bf16 v[168:171], a[200:203], v[88:91], v[168:171]
v_mfma_f32_16x16x32_bf16 v[168:171], a[204:207], v[92:95], v[168:171]
v_mfma_f32_16x16x32_bf16 v[172:175], a[208:211], v[80:83], v[212:215]
v_mfma_f32_16x16x32_bf16 v[172:175], a[212:215], v[84:87], v[172:175]
v_mfma_f32_16x16x32_bf16 v[172:175], a[216:219], v[88:91], v[172:175]
v_mfma_f32_16x16x32_bf16 v[172:175], a[220:223], v[92:95], v[172:175]
s_lshl_b32 s34, s26, 3
s_add_u32 s34, s34, s27
s_mul_i32 s34, s34, 40960
s_add_u32 s88, s92, s34
s_addc_u32 s89, s93, 0
s_mov_b32 s90, 40960
s_mov_b32 s91, 0x20000
s_lshl_b32 s34, s28, 10
s_lshl_b32 s35, s21, 7
s_add_u32 s34, s34, s35
s_lshl_b32 s35, s22, 4
s_add_u32 s34, s34, s35
s_mul_i32 s34, s34, 1280
s_mul_i32 s35, s23, 320
s_add_u32 s34, s34, s35
s_add_u32 s92, s92, s34
s_addc_u32 s93, s93, 0
s_sub_u32 s94, 5242880, s34
s_mov_b32 s95, 0x20000
v_exp_f32 v160, v160
v_exp_f32 v161, v161
v_exp_f32 v162, v162
v_exp_f32 v163, v163
v_exp_f32 v164, v164
v_exp_f32 v165, v165
v_exp_f32 v166, v166
v_exp_f32 v167, v167
v_exp_f32 v168, v168
v_exp_f32 v169, v169
v_exp_f32 v170, v170
v_exp_f32 v171, v171
v_exp_f32 v172, v172
v_exp_f32 v173, v173
v_exp_f32 v174, v174
v_exp_f32 v175, v175
v_cvt_pk_bf16_f32 v192, v160, v161
v_cvt_pk_bf16_f32 v193, v162, v163
v_cvt_pk_bf16_f32 v194, v164, v165
v_cvt_pk_bf16_f32 v195, v166, v167
s_mul_i32 s96, s23, 327680
s_mov_b32 s57, 7
s_mov_b64 vcc, -1
.p2align 6
L_loop:
v_mfma_f32_16x16x32_bf16 v[176:179], a[192:195], v[96:99], v[216:219]
v_cvt_pk_bf16_f32 v196, v168, v169
v_cvt_pk_bf16_f32 v197, v170, v171
v_mfma_f32_16x16x32_bf16 v[176:179], a[196:199], v[100:103], v[176:179]
v_cvt_pk_bf16_f32 v198, v172, v173
v_cvt_pk_bf16_f32 v199, v174, v175
v_mfma_f32_16x16x32_bf16 v[176:179], a[200:203], v[104:107], v[176:179]
s_waitcnt vmcnt(4)
ds_read_b64_tr_b16 a[224:225], v24 offset:0
ds_read_b64_tr_b16 a[226:227], v24 offset:4096
v_mfma_f32_16x16x32_bf16 v[176:179], a[204:207], v[108:111], v[176:179]
ds_read_b64_tr_b16 a[228:229], v25 offset:0
ds_read_b64_tr_b16 a[230:231], v25 offset:4096
v_mfma_f32_16x16x32_bf16 v[180:183], a[208:211], v[96:99], v[216:219]
ds_read_b64_tr_b16 a[232:233], v26 offset:0
ds_read_b64_tr_b16 a[234:235], v26 offset:4096
v_mfma_f32_16x16x32_bf16 v[180:183], a[212:215], v[100:103], v[180:183]
ds_read_b64_tr_b16 a[236:237], v27 offset:0
ds_read_b64_tr_b16 a[238:239], v27 offset:4096
v_mfma_f32_16x16x32_bf16 v[180:183], a[216:219], v[104:107], v[180:183]
ds_read_b64_tr_b16 a[240:241], v28 offset:0
ds_read_b64_tr_b16 a[242:243], v28 offset:4096
v_mfma_f32_16x16x32_bf16 v[180:183], a[220:223], v[108:111], v[180:183]
ds_read_b64_tr_b16 a[244:245], v29 offset:0
ds_read_b64_tr_b16 a[246:247], v29 offset:4096
v_mfma_f32_16x16x32_bf16 v[184:187], a[192:195], v[112:115], v[220:223]
ds_read_b64_tr_b16 a[248:249], v30 offset:0
ds_read_b64_tr_b16 a[250:251], v30 offset:4096
v_mfma_f32_16x16x32_bf16 v[184:187], a[196:199], v[116:119], v[184:187]
ds_read_b64_tr_b16 a[252:253], v31 offset:0
ds_read_b64_tr_b16 a[254:255], v31 offset:4096
v_mfma_f32_16x16x32_bf16 v[184:187], a[200:203], v[120:123], v[184:187]
v_mfma_f32_16x16x32_bf16 v[184:187], a[204:207], v[124:127], v[184:187]
buffer_load_dwordx4 v17, s[12:15], s55 offen offset:1024 sc1 nt lds
v_mfma_f32_16x16x32_bf16 v[188:191], a[208:211], v[112:115], v[220:223]
v_mfma_f32_16x16x32_bf16 v[188:191], a[212:215], v[116:119], v[188:191]
v_mfma_f32_16x16x32_bf16 v[188:191], a[216:219], v[120:123], v[188:191]
v_mfma_f32_16x16x32_bf16 v[188:191], a[220:223], v[124:127], v[188:191]
s_waitcnt vmcnt(4)
s_waitcnt lgkmcnt(0)
v_mfma_f32_16x16x32_bf16 a[0:3], a[224:227], v[192:195], a[0:3]
v_exp_f32 v176, v176
v_mfma_f32_16x16x32_bf16 a[32:35], a[224:227], v[196:199], a[32:35]
v_exp_f32 v177, v177
v_mfma_f32_16x16x32_bf16 a[4:7], a[228:231], v[192:195], a[4:7]
v_exp_f32 v178, v178
v_mfma_f32_16x16x32_bf16 a[36:39], a[228:231], v[196:199], a[36:39]
v_exp_f32 v179, v179
v_mfma_f32_16x16x32_bf16 a[8:11], a[232:235], v[192:195], a[8:11]
v_exp_f32 v180, v180
v_mfma_f32_16x16x32_bf16 a[40:43], a[232:235], v[196:199], a[40:43]
v_exp_f32 v181, v181
v_mfma_f32_16x16x32_bf16 a[12:15], a[236:239], v[192:195], a[12:15]
v_exp_f32 v182, v182
v_mfma_f32_16x16x32_bf16 a[44:47], a[236:239], v[196:199], a[44:47]
v_exp_f32 v183, v183
v_mfma_f32_16x16x32_bf16 a[16:19], a[240:243], v[192:195], a[16:19]
buffer_load_dwordx4 v18, s[12:15], s55 offen offset:2048 sc1 nt lds
v_exp_f32 v184, v184
v_mfma_f32_16x16x32_bf16 a[48:51], a[240:243], v[196:199], a[48:51]
v_exp_f32 v185, v185
v_mfma_f32_16x16x32_bf16 a[20:23], a[244:247], v[192:195], a[20:23]
v_exp_f32 v186, v186
v_mfma_f32_16x16x32_bf16 a[52:55], a[244:247], v[196:199], a[52:55]
s_waitcnt vmcnt(4)
v_exp_f32 v187, v187
v_mfma_f32_16x16x32_bf16 a[24:27], a[248:251], v[192:195], a[24:27]
v_exp_f32 v188, v188
v_mfma_f32_16x16x32_bf16 a[56:59], a[248:251], v[196:199], a[56:59]
v_exp_f32 v189, v189
v_mfma_f32_16x16x32_bf16 a[28:31], a[252:255], v[192:195], a[28:31]
v_exp_f32 v190, v190
v_mfma_f32_16x16x32_bf16 a[60:63], a[252:255], v[196:199], a[60:63]
v_exp_f32 v191, v191
v_mfma_f32_16x16x32_bf16 v[232:235], v[48:51], v[192:195], v[232:235]
v_cvt_pk_bf16_f32 v200, v176, v177
v_cvt_pk_bf16_f32 v201, v178, v179
v_mfma_f32_16x16x32_bf16 v[236:239], v[48:51], v[196:199], v[236:239]
v_cvt_pk_bf16_f32 v202, v180, v181
v_cvt_pk_bf16_f32 v203, v182, v183
v_mfma_f32_16x16x32_bf16 v[160:163], a[192:195], v[128:131], v[224:227]
v_cvt_pk_bf16_f32 v204, v184, v185
v_cvt_pk_bf16_f32 v205, v186, v187
v_mfma_f32_16x16x32_bf16 v[160:163], a[196:199], v[132:135], v[160:163]
v_cvt_pk_bf16_f32 v206, v188, v189
v_cvt_pk_bf16_f32 v207, v190, v191
v_mfma_f32_16x16x32_bf16 v[160:163], a[200:203], v[136:139], v[160:163]
buffer_load_dwordx4 v19, s[12:15], s55 offen offset:3072 sc1 nt lds
v_mfma_f32_16x16x32_bf16 v[160:163], a[204:207], v[140:143], v[160:163]
v_mfma_f32_16x16x32_bf16 v[164:167], a[208:211], v[128:131], v[224:227]
v_mfma_f32_16x16x32_bf16 v[164:167], a[212:215], v[132:135], v[164:167]
s_waitcnt vmcnt(8)
v_mfma_f32_16x16x32_bf16 v[164:167], a[216:219], v[136:139], v[164:167]
s_barrier
v_mfma_f32_16x16x32_bf16 v[164:167], a[220:223], v[140:143], v[164:167]
v_mfma_f32_16x16x32_bf16 v[168:171], a[192:195], v[144:147], v[228:231]
ds_read_b128 a[192:195], v20 offset:16384
v_mfma_f32_16x16x32_bf16 v[168:171], a[196:199], v[148:151], v[168:171]
ds_read_b128 a[196:199], v21 offset:16384
s_waitcnt vmcnt(4)
v_mfma_f32_16x16x32_bf16 v[168:171], a[200:203], v[152:155], v[168:171]
ds_read_b128 a[200:203], v22 offset:16384
v_mfma_f32_16x16x32_bf16 v[168:171], a[204:207], v[156:159], v[168:171]
ds_read_b128 a[204:207], v23 offset:16384
v_mfma_f32_16x16x32_bf16 v[172:175], a[208:211], v[144:147], v[228:231]
ds_read_b128 a[208:211], v20 offset:20480
v_mfma_f32_16x16x32_bf16 v[172:175], a[212:215], v[148:151], v[172:175]
ds_read_b128 a[212:215], v21 offset:20480
v_mfma_f32_16x16x32_bf16 v[172:175], a[216:219], v[152:155], v[172:175]
ds_read_b128 a[216:219], v22 offset:20480
v_mfma_f32_16x16x32_bf16 v[172:175], a[220:223], v[156:159], v[172:175]
ds_read_b128 a[220:223], v23 offset:20480
s_add_u32 m0, s54, 49152
v_mfma_f32_16x16x32_bf16 a[64:67], a[224:227], v[200:203], a[64:67]
s_and_b32 s55, s30, 0x3ffff
v_exp_f32 v160, v160
v_mfma_f32_16x16x32_bf16 a[96:99], a[224:227], v[204:207], a[96:99]
v_exp_f32 v161, v161
v_mfma_f32_16x16x32_bf16 a[68:71], a[228:231], v[200:203], a[68:71]
buffer_load_dwordx4 v16, s[12:15], s55 offen offset:0 sc1 nt lds
v_exp_f32 v162, v162
v_mfma_f32_16x16x32_bf16 a[100:103], a[228:231], v[204:207], a[100:103]
s_add_u32 s30, s30, 4096
v_exp_f32 v163, v163
v_mfma_f32_16x16x32_bf16 a[72:75], a[232:235], v[200:203], a[72:75]
v_exp_f32 v164, v164
v_mfma_f32_16x16x32_bf16 a[104:107], a[232:235], v[204:207], a[104:107]
s_waitcnt vmcnt(4)
v_exp_f32 v165, v165
v_mfma_f32_16x16x32_bf16 a[76:79], a[236:239], v[200:203], a[76:79]
v_exp_f32 v166, v166
v_mfma_f32_16x16x32_bf16 a[108:111], a[236:239], v[204:207], a[108:111]
v_exp_f32 v167, v167
v_mfma_f32_16x16x32_bf16 a[80:83], a[240:243], v[200:203], a[80:83]
v_exp_f32 v168, v168
v_mfma_f32_16x16x32_bf16 a[112:115], a[240:243], v[204:207], a[112:115]
v_exp_f32 v169, v169
v_mfma_f32_16x16x32_bf16 a[84:87], a[244:247], v[200:203], a[84:87]
v_exp_f32 v170, v170
v_mfma_f32_16x16x32_bf16 a[116:119], a[244:247], v[204:207], a[116:119]
v_exp_f32 v171, v171
v_mfma_f32_16x16x32_bf16 a[88:91], a[248:251], v[200:203], a[88:91]
v_exp_f32 v172, v172
v_mfma_f32_16x16x32_bf16 a[120:123], a[248:251], v[204:207], a[120:123]
v_exp_f32 v173, v173
v_mfma_f32_16x16x32_bf16 a[92:95], a[252:255], v[200:203], a[92:95]
buffer_load_dwordx4 v17, s[12:15], s55 offen offset:1024 sc1 nt lds
v_exp_f32 v174, v174
v_mfma_f32_16x16x32_bf16 a[124:127], a[252:255], v[204:207], a[124:127]
v_exp_f32 v175, v175
v_mfma_f32_16x16x32_bf16 v[240:243], v[48:51], v[200:203], v[240:243]
v_cvt_pk_bf16_f32 v192, v160, v161
v_cvt_pk_bf16_f32 v193, v162, v163
v_mfma_f32_16x16x32_bf16 v[244:247], v[48:51], v[204:207], v[244:247]
s_waitcnt lgkmcnt(0)
s_waitcnt vmcnt(4)
v_cvt_pk_bf16_f32 v194, v164, v165
v_cvt_pk_bf16_f32 v195, v166, v167
v_mfma_f32_16x16x32_bf16 v[176:179], a[192:195], v[64:67], v[208:211]
v_cvt_pk_bf16_f32 v196, v168, v169
v_cvt_pk_bf16_f32 v197, v170, v171
v_mfma_f32_16x16x32_bf16 v[176:179], a[196:199], v[68:71], v[176:179]
v_cvt_pk_bf16_f32 v198, v172, v173
v_cvt_pk_bf16_f32 v199, v174, v175
v_mfma_f32_16x16x32_bf16 v[176:179], a[200:203], v[72:75], v[176:179]
v_mfma_f32_16x16x32_bf16 v[176:179], a[204:207], v[76:79], v[176:179]
v_mfma_f32_16x16x32_bf16 v[180:183], a[208:211], v[64:67], v[208:211]
v_mfma_f32_16x16x32_bf16 v[180:183], a[212:215], v[68:71], v[180:183]
v_mfma_f32_16x16x32_bf16 v[180:183], a[216:219], v[72:75], v[180:183]
v_mfma_f32_16x16x32_bf16 v[180:183], a[220:223], v[76:79], v[180:183]
v_mfma_f32_16x16x32_bf16 v[184:187], a[192:195], v[80:83], v[212:215]
buffer_load_dwordx4 v18, s[12:15], s55 offen offset:2048 sc1 nt lds
v_mfma_f32_16x16x32_bf16 v[184:187], a[196:199], v[84:87], v[184:187]
v_mfma_f32_16x16x32_bf16 v[184:187], a[200:203], v[88:91], v[184:187]
v_mfma_f32_16x16x32_bf16 v[184:187], a[204:207], v[92:95], v[184:187]
s_waitcnt vmcnt(4)
v_mfma_f32_16x16x32_bf16 v[188:191], a[208:211], v[80:83], v[212:215]
v_mfma_f32_16x16x32_bf16 v[188:191], a[212:215], v[84:87], v[188:191]
v_mfma_f32_16x16x32_bf16 v[188:191], a[216:219], v[88:91], v[188:191]
v_mfma_f32_16x16x32_bf16 v[188:191], a[220:223], v[92:95], v[188:191]
v_mfma_f32_16x16x32_bf16 a[128:131], a[224:227], v[192:195], a[128:131]
v_exp_f32 v176, v176
v_mfma_f32_16x16x32_bf16 a[160:163], a[224:227], v[196:199], a[160:163]
v_exp_f32 v177, v177
v_mfma_f32_16x16x32_bf16 a[132:135], a[228:231], v[192:195], a[132:135]
v_exp_f32 v178, v178
v_mfma_f32_16x16x32_bf16 a[164:167], a[228:231], v[196:199], a[164:167]
v_exp_f32 v179, v179
v_mfma_f32_16x16x32_bf16 a[136:139], a[232:235], v[192:195], a[136:139]
buffer_load_dwordx4 v19, s[12:15], s55 offen offset:3072 sc1 nt lds
v_exp_f32 v180, v180
v_mfma_f32_16x16x32_bf16 a[168:171], a[232:235], v[196:199], a[168:171]
v_exp_f32 v181, v181
v_mfma_f32_16x16x32_bf16 a[140:143], a[236:239], v[192:195], a[140:143]
s_waitcnt vmcnt(4)
v_exp_f32 v182, v182
v_mfma_f32_16x16x32_bf16 a[172:175], a[236:239], v[196:199], a[172:175]
v_exp_f32 v183, v183
v_mfma_f32_16x16x32_bf16 a[144:147], a[240:243], v[192:195], a[144:147]
v_exp_f32 v184, v184
v_mfma_f32_16x16x32_bf16 a[176:179], a[240:243], v[196:199], a[176:179]
v_exp_f32 v185, v185
v_mfma_f32_16x16x32_bf16 a[148:151], a[244:247], v[192:195], a[148:151]
v_exp_f32 v186, v186
v_mfma_f32_16x16x32_bf16 a[180:183], a[244:247], v[196:199], a[180:183]
v_exp_f32 v187, v187
v_mfma_f32_16x16x32_bf16 a[152:155], a[248:251], v[192:195], a[152:155]
s_add_u32 m0, s54, 53248
v_exp_f32 v188, v188
v_mfma_f32_16x16x32_bf16 a[184:187], a[248:251], v[196:199], a[184:187]
s_and_b32 s55, s30, 0x3ffff
v_exp_f32 v189, v189
v_mfma_f32_16x16x32_bf16 a[156:159], a[252:255], v[192:195], a[156:159]
v_exp_f32 v190, v190
v_mfma_f32_16x16x32_bf16 a[188:191], a[252:255], v[196:199], a[188:191]
buffer_load_dwordx4 v16, s[12:15], s55 offen offset:0 sc1 nt lds
v_exp_f32 v191, v191
v_mfma_f32_16x16x32_bf16 v[248:251], v[48:51], v[192:195], v[248:251]
s_add_u32 s30, s30, s101
v_cvt_pk_bf16_f32 v200, v176, v177
v_cvt_pk_bf16_f32 v201, v178, v179
v_mfma_f32_16x16x32_bf16 v[252:255], v[48:51], v[196:199], v[252:255]
v_cvt_pk_bf16_f32 v202, v180, v181
v_cvt_pk_bf16_f32 v203, v182, v183
v_mfma_f32_16x16x32_bf16 v[160:163], a[192:195], v[96:99], v[216:219]
v_cvt_pk_bf16_f32 v204, v184, v185
v_cvt_pk_bf16_f32 v205, v186, v187
v_mfma_f32_16x16x32_bf16 v[160:163], a[196:199], v[100:103], v[160:163]
v_cvt_pk_bf16_f32 v206, v188, v189
v_cvt_pk_bf16_f32 v207, v190, v191
v_mfma_f32_16x16x32_bf16 v[160:163], a[200:203], v[104:107], v[160:163]
s_waitcnt vmcnt(4)
ds_read_b64_tr_b16 a[224:225], v24 offset:16384
ds_read_b64_tr_b16 a[226:227], v24 offset:20480
v_mfma_f32_16x16x32_bf16 v[160:163], a[204:207], v[108:111], v[160:163]
ds_read_b64_tr_b16 a[228:229], v25 offset:16384
ds_read_b64_tr_b16 a[230:231], v25 offset:20480
v_mfma_f32_16x16x32_bf16 v[164:167], a[208:211], v[96:99], v[216:219]
ds_read_b64_tr_b16 a[232:233], v26 offset:16384
ds_read_b64_tr_b16 a[234:235], v26 offset:20480
v_mfma_f32_16x16x32_bf16 v[164:167], a[212:215], v[100:103], v[164:167]
ds_read_b64_tr_b16 a[236:237], v27 offset:16384
ds_read_b64_tr_b16 a[238:239], v27 offset:20480
v_mfma_f32_16x16x32_bf16 v[164:167], a[216:219], v[104:107], v[164:167]
ds_read_b64_tr_b16 a[240:241], v28 offset:16384
ds_read_b64_tr_b16 a[242:243], v28 offset:20480
v_mfma_f32_16x16x32_bf16 v[164:167], a[220:223], v[108:111], v[164:167]
ds_read_b64_tr_b16 a[244:245], v29 offset:16384
ds_read_b64_tr_b16 a[246:247], v29 offset:20480
v_mfma_f32_16x16x32_bf16 v[168:171], a[192:195], v[112:115], v[220:223]
ds_read_b64_tr_b16 a[248:249], v30 offset:16384
ds_read_b64_tr_b16 a[250:251], v30 offset:20480
v_mfma_f32_16x16x32_bf16 v[168:171], a[196:199], v[116:119], v[168:171]
ds_read_b64_tr_b16 a[252:253], v31 offset:16384
ds_read_b64_tr_b16 a[254:255], v31 offset:20480
v_mfma_f32_16x16x32_bf16 v[168:171], a[200:203], v[120:123], v[168:171]
v_mfma_f32_16x16x32_bf16 v[168:171], a[204:207], v[124:127], v[168:171]
buffer_load_dwordx4 v17, s[12:15], s55 offen offset:1024 sc1 nt lds
v_mfma_f32_16x16x32_bf16 v[172:175], a[208:211], v[112:115], v[220:223]
v_mfma_f32_16x16x32_bf16 v[172:175], a[212:215], v[116:119], v[172:175]
v_mfma_f32_16x16x32_bf16 v[172:175], a[216:219], v[120:123], v[172:175]
v_mfma_f32_16x16x32_bf16 v[172:175], a[220:223], v[124:127], v[172:175]
s_waitcnt vmcnt(4)
s_waitcnt lgkmcnt(0)
v_mfma_f32_16x16x32_bf16 a[0:3], a[224:227], v[200:203], a[0:3]
v_exp_f32 v160, v160
v_mfma_f32_16x16x32_bf16 a[32:35], a[224:227], v[204:207], a[32:35]
v_exp_f32 v161, v161
v_mfma_f32_16x16x32_bf16 a[4:7], a[228:231], v[200:203], a[4:7]
v_exp_f32 v162, v162
v_mfma_f32_16x16x32_bf16 a[36:39], a[228:231], v[204:207], a[36:39]
v_exp_f32 v163, v163
v_mfma_f32_16x16x32_bf16 a[8:11], a[232:235], v[200:203], a[8:11]
v_exp_f32 v164, v164
v_mfma_f32_16x16x32_bf16 a[40:43], a[232:235], v[204:207], a[40:43]
v_exp_f32 v165, v165
v_mfma_f32_16x16x32_bf16 a[12:15], a[236:239], v[200:203], a[12:15]
v_exp_f32 v166, v166
v_mfma_f32_16x16x32_bf16 a[44:47], a[236:239], v[204:207], a[44:47]
v_exp_f32 v167, v167
v_mfma_f32_16x16x32_bf16 a[16:19], a[240:243], v[200:203], a[16:19]
buffer_load_dwordx4 v18, s[12:15], s55 offen offset:2048 sc1 nt lds
v_exp_f32 v168, v168
v_mfma_f32_16x16x32_bf16 a[48:51], a[240:243], v[204:207], a[48:51]
v_exp_f32 v169, v169
v_mfma_f32_16x16x32_bf16 a[20:23], a[244:247], v[200:203], a[20:23]
v_exp_f32 v170, v170
v_mfma_f32_16x16x32_bf16 a[52:55], a[244:247], v[204:207], a[52:55]
s_waitcnt vmcnt(4)
v_exp_f32 v171, v171
v_mfma_f32_16x16x32_bf16 a[24:27], a[248:251], v[200:203], a[24:27]
v_exp_f32 v172, v172
v_mfma_f32_16x16x32_bf16 a[56:59], a[248:251], v[204:207], a[56:59]
v_exp_f32 v173, v173
v_mfma_f32_16x16x32_bf16 a[28:31], a[252:255], v[200:203], a[28:31]
v_exp_f32 v174, v174
v_mfma_f32_16x16x32_bf16 a[60:63], a[252:255], v[204:207], a[60:63]
v_exp_f32 v175, v175
v_mfma_f32_16x16x32_bf16 v[232:235], v[48:51], v[200:203], v[232:235]
v_cvt_pk_bf16_f32 v192, v160, v161
v_cvt_pk_bf16_f32 v193, v162, v163
v_mfma_f32_16x16x32_bf16 v[236:239], v[48:51], v[204:207], v[236:239]
v_cvt_pk_bf16_f32 v194, v164, v165
v_cvt_pk_bf16_f32 v195, v166, v167
v_mfma_f32_16x16x32_bf16 v[176:179], a[192:195], v[128:131], v[224:227]
v_cvt_pk_bf16_f32 v196, v168, v169
v_cvt_pk_bf16_f32 v197, v170, v171
v_mfma_f32_16x16x32_bf16 v[176:179], a[196:199], v[132:135], v[176:179]
v_cvt_pk_bf16_f32 v198, v172, v173
v_cvt_pk_bf16_f32 v199, v174, v175
v_mfma_f32_16x16x32_bf16 v[176:179], a[200:203], v[136:139], v[176:179]
buffer_load_dwordx4 v19, s[12:15], s55 offen offset:3072 sc1 nt lds
v_mfma_f32_16x16x32_bf16 v[176:179], a[204:207], v[140:143], v[176:179]
v_mfma_f32_16x16x32_bf16 v[180:183], a[208:211], v[128:131], v[224:227]
v_mfma_f32_16x16x32_bf16 v[180:183], a[212:215], v[132:135], v[180:183]
s_waitcnt vmcnt(8)
v_mfma_f32_16x16x32_bf16 v[180:183], a[216:219], v[136:139], v[180:183]
s_barrier
v_mfma_f32_16x16x32_bf16 v[180:183], a[220:223], v[140:143], v[180:183]
v_mfma_f32_16x16x32_bf16 v[184:187], a[192:195], v[144:147], v[228:231]
ds_read_b128 a[192:195], v20 offset:32768
v_mfma_f32_16x16x32_bf16 v[184:187], a[196:199], v[148:151], v[184:187]
ds_read_b128 a[196:199], v21 offset:32768
s_waitcnt vmcnt(4)
v_mfma_f32_16x16x32_bf16 v[184:187], a[200:203], v[152:155], v[184:187]
ds_read_b128 a[200:203], v22 offset:32768
v_mfma_f32_16x16x32_bf16 v[184:187], a[204:207], v[156:159], v[184:187]
ds_read_b128 a[204:207], v23 offset:32768
v_mfma_f32_16x16x32_bf16 v[188:191], a[208:211], v[144:147], v[228:231]
ds_read_b128 a[208:211], v20 offset:36864
v_mfma_f32_16x16x32_bf16 v[188:191], a[212:215], v[148:151], v[188:191]
ds_read_b128 a[212:215], v21 offset:36864
v_mfma_f32_16x16x32_bf16 v[188:191], a[216:219], v[152:155], v[188:191]
ds_read_b128 a[216:219], v22 offset:36864
v_mfma_f32_16x16x32_bf16 v[188:191], a[220:223], v[156:159], v[188:191]
ds_read_b128 a[220:223], v23 offset:36864
s_add_u32 m0, s54, 0
v_mfma_f32_16x16x32_bf16 a[64:67], a[224:227], v[192:195], a[64:67]
s_and_b32 s55, s30, 0x3ffff
v_exp_f32 v176, v176
v_mfma_f32_16x16x32_bf16 a[96:99], a[224:227], v[196:199], a[96:99]
v_exp_f32 v177, v177
v_mfma_f32_16x16x32_bf16 a[68:71], a[228:231], v[192:195], a[68:71]
buffer_load_dwordx4 v16, s[12:15], s55 offen offset:0 sc1 nt lds
v_exp_f32 v178, v178
v_mfma_f32_16x16x32_bf16 a[100:103], a[228:231], v[196:199], a[100:103]
s_add_u32 s30, s30, 4096
v_exp_f32 v179, v179
v_mfma_f32_16x16x32_bf16 a[72:75], a[232:235], v[192:195], a[72:75]
v_exp_f32 v180, v180
v_mfma_f32_16x16x32_bf16 a[104:107], a[232:235], v[196:199], a[104:107]
s_waitcnt vmcnt(4)
v_exp_f32 v181, v181
v_mfma_f32_16x16x32_bf16 a[76:79], a[236:239], v[192:195], a[76:79]
v_exp_f32 v182, v182
v_mfma_f32_16x16x32_bf16 a[108:111], a[236:239], v[196:199], a[108:111]
v_exp_f32 v183, v183
v_mfma_f32_16x16x32_bf16 a[80:83], a[240:243], v[192:195], a[80:83]
v_exp_f32 v184, v184
v_mfma_f32_16x16x32_bf16 a[112:115], a[240:243], v[196:199], a[112:115]
v_exp_f32 v185, v185
v_mfma_f32_16x16x32_bf16 a[84:87], a[244:247], v[192:195], a[84:87]
v_exp_f32 v186, v186
v_mfma_f32_16x16x32_bf16 a[116:119], a[244:247], v[196:199], a[116:119]
v_exp_f32 v187, v187
v_mfma_f32_16x16x32_bf16 a[88:91], a[248:251], v[192:195], a[88:91]
v_exp_f32 v188, v188
v_mfma_f32_16x16x32_bf16 a[120:123], a[248:251], v[196:199], a[120:123]
v_exp_f32 v189, v189
v_mfma_f32_16x16x32_bf16 a[92:95], a[252:255], v[192:195], a[92:95]
buffer_load_dwordx4 v17, s[12:15], s55 offen offset:1024 sc1 nt lds
v_exp_f32 v190, v190
v_mfma_f32_16x16x32_bf16 a[124:127], a[252:255], v[196:199], a[124:127]
v_exp_f32 v191, v191
v_mfma_f32_16x16x32_bf16 v[240:243], v[48:51], v[192:195], v[240:243]
v_cvt_pk_bf16_f32 v200, v176, v177
v_cvt_pk_bf16_f32 v201, v178, v179
v_mfma_f32_16x16x32_bf16 v[244:247], v[48:51], v[196:199], v[244:247]
s_waitcnt lgkmcnt(0)
s_waitcnt vmcnt(4)
v_cvt_pk_bf16_f32 v202, v180, v181
v_cvt_pk_bf16_f32 v203, v182, v183
v_mfma_f32_16x16x32_bf16 v[160:163], a[192:195], v[64:67], v[208:211]
v_cvt_pk_bf16_f32 v204, v184, v185
v_cvt_pk_bf16_f32 v205, v186, v187
v_mfma_f32_16x16x32_bf16 v[160:163], a[196:199], v[68:71], v[160:163]
v_cvt_pk_bf16_f32 v206, v188, v189
v_cvt_pk_bf16_f32 v207, v190, v191
v_mfma_f32_16x16x32_bf16 v[160:163], a[200:203], v[72:75], v[160:163]
v_mfma_f32_16x16x32_bf16 v[160:163], a[204:207], v[76:79], v[160:163]
v_mfma_f32_16x16x32_bf16 v[164:167], a[208:211], v[64:67], v[208:211]
v_mfma_f32_16x16x32_bf16 v[164:167], a[212:215], v[68:71], v[164:167]
v_mfma_f32_16x16x32_bf16 v[164:167], a[216:219], v[72:75], v[164:167]
v_mfma_f32_16x16x32_bf16 v[164:167], a[220:223], v[76:79], v[164:167]
v_mfma_f32_16x16x32_bf16 v[168:171], a[192:195], v[80:83], v[212:215]
buffer_load_dwordx4 v18, s[12:15], s55 offen offset:2048 sc1 nt lds
v_mfma_f32_16x16x32_bf16 v[168:171], a[196:199], v[84:87], v[168:171]
v_mfma_f32_16x16x32_bf16 v[168:171], a[200:203], v[88:91], v[168:171]
v_mfma_f32_16x16x32_bf16 v[168:171], a[204:207], v[92:95], v[168:171]
s_waitcnt vmcnt(4)
v_mfma_f32_16x16x32_bf16 v[172:175], a[208:211], v[80:83], v[212:215]
v_mfma_f32_16x16x32_bf16 v[172:175], a[212:215], v[84:87], v[172:175]
v_mfma_f32_16x16x32_bf16 v[172:175], a[216:219], v[88:91], v[172:175]
v_mfma_f32_16x16x32_bf16 v[172:175], a[220:223], v[92:95], v[172:175]
v_mfma_f32_16x16x32_bf16 a[128:131], a[224:227], v[200:203], a[128:131]
v_exp_f32 v160, v160
v_mfma_f32_16x16x32_bf16 a[160:163], a[224:227], v[204:207], a[160:163]
v_exp_f32 v161, v161
v_mfma_f32_16x16x32_bf16 a[132:135], a[228:231], v[200:203], a[132:135]
v_exp_f32 v162, v162
v_mfma_f32_16x16x32_bf16 a[164:167], a[228:231], v[204:207], a[164:167]
v_exp_f32 v163, v163
v_mfma_f32_16x16x32_bf16 a[136:139], a[232:235], v[200:203], a[136:139]
buffer_load_dwordx4 v19, s[12:15], s55 offen offset:3072 sc1 nt lds
v_exp_f32 v164, v164
v_mfma_f32_16x16x32_bf16 a[168:171], a[232:235], v[204:207], a[168:171]
v_exp_f32 v165, v165
v_mfma_f32_16x16x32_bf16 a[140:143], a[236:239], v[200:203], a[140:143]
s_waitcnt vmcnt(4)
v_exp_f32 v166, v166
v_mfma_f32_16x16x32_bf16 a[172:175], a[236:239], v[204:207], a[172:175]
v_exp_f32 v167, v167
v_mfma_f32_16x16x32_bf16 a[144:147], a[240:243], v[200:203], a[144:147]
v_exp_f32 v168, v168
v_mfma_f32_16x16x32_bf16 a[176:179], a[240:243], v[204:207], a[176:179]
v_exp_f32 v169, v169
v_mfma_f32_16x16x32_bf16 a[148:151], a[244:247], v[200:203], a[148:151]
v_exp_f32 v170, v170
v_mfma_f32_16x16x32_bf16 a[180:183], a[244:247], v[204:207], a[180:183]
v_exp_f32 v171, v171
v_mfma_f32_16x16x32_bf16 a[152:155], a[248:251], v[200:203], a[152:155]
s_add_u32 m0, s54, 4096
v_exp_f32 v172, v172
v_mfma_f32_16x16x32_bf16 a[184:187], a[248:251], v[204:207], a[184:187]
s_and_b32 s55, s30, 0x3ffff
v_exp_f32 v173, v173
v_mfma_f32_16x16x32_bf16 a[156:159], a[252:255], v[200:203], a[156:159]
v_exp_f32 v174, v174
v_mfma_f32_16x16x32_bf16 a[188:191], a[252:255], v[204:207], a[188:191]
buffer_load_dwordx4 v16, s[12:15], s55 offen offset:0 sc1 nt lds
v_exp_f32 v175, v175
v_mfma_f32_16x16x32_bf16 v[248:251], v[48:51], v[200:203], v[248:251]
s_add_u32 s30, s30, s101
v_cvt_pk_bf16_f32 v192, v160, v161
v_cvt_pk_bf16_f32 v193, v162, v163
v_mfma_f32_16x16x32_bf16 v[252:255], v[48:51], v[204:207], v[252:255]
v_cvt_pk_bf16_f32 v194, v164, v165
v_cvt_pk_bf16_f32 v195, v166, v167
v_mfma_f32_16x16x32_bf16 v[176:179], a[192:195], v[96:99], v[216:219]
v_cvt_pk_bf16_f32 v196, v168, v169
v_cvt_pk_bf16_f32 v197, v170, v171
v_mfma_f32_16x16x32_bf16 v[176:179], a[196:199], v[100:103], v[176:179]
v_cvt_pk_bf16_f32 v198, v172, v173
v_cvt_pk_bf16_f32 v199, v174, v175
v_mfma_f32_16x16x32_bf16 v[176:179], a[200:203], v[104:107], v[176:179]
s_waitcnt vmcnt(4)
ds_read_b64_tr_b16 a[224:225], v24 offset:32768
ds_read_b64_tr_b16 a[226:227], v24 offset:36864
v_mfma_f32_16x16x32_bf16 v[176:179], a[204:207], v[108:111], v[176:179]
ds_read_b64_tr_b16 a[228:229], v25 offset:32768
ds_read_b64_tr_b16 a[230:231], v25 offset:36864
v_mfma_f32_16x16x32_bf16 v[180:183], a[208:211], v[96:99], v[216:219]
ds_read_b64_tr_b16 a[232:233], v26 offset:32768
ds_read_b64_tr_b16 a[234:235], v26 offset:36864
v_mfma_f32_16x16x32_bf16 v[180:183], a[212:215], v[100:103], v[180:183]
ds_read_b64_tr_b16 a[236:237], v27 offset:32768
ds_read_b64_tr_b16 a[238:239], v27 offset:36864
v_mfma_f32_16x16x32_bf16 v[180:183], a[216:219], v[104:107], v[180:183]
ds_read_b64_tr_b16 a[240:241], v28 offset:32768
ds_read_b64_tr_b16 a[242:243], v28 offset:36864
v_mfma_f32_16x16x32_bf16 v[180:183], a[220:223], v[108:111], v[180:183]
ds_read_b64_tr_b16 a[244:245], v29 offset:32768
ds_read_b64_tr_b16 a[246:247], v29 offset:36864
v_mfma_f32_16x16x32_bf16 v[184:187], a[192:195], v[112:115], v[220:223]
ds_read_b64_tr_b16 a[248:249], v30 offset:32768
ds_read_b64_tr_b16 a[250:251], v30 offset:36864
v_mfma_f32_16x16x32_bf16 v[184:187], a[196:199], v[116:119], v[184:187]
ds_read_b64_tr_b16 a[252:253], v31 offset:32768
ds_read_b64_tr_b16 a[254:255], v31 offset:36864
v_mfma_f32_16x16x32_bf16 v[184:187], a[200:203], v[120:123], v[184:187]
v_mfma_f32_16x16x32_bf16 v[184:187], a[204:207], v[124:127], v[184:187]
buffer_load_dwordx4 v17, s[12:15], s55 offen offset:1024 sc1 nt lds
v_mfma_f32_16x16x32_bf16 v[188:191], a[208:211], v[112:115], v[220:223]
v_mfma_f32_16x16x32_bf16 v[188:191], a[212:215], v[116:119], v[188:191]
v_mfma_f32_16x16x32_bf16 v[188:191], a[216:219], v[120:123], v[188:191]
v_mfma_f32_16x16x32_bf16 v[188:191], a[220:223], v[124:127], v[188:191]
s_waitcnt vmcnt(4)
s_waitcnt lgkmcnt(0)
v_mfma_f32_16x16x32_bf16 a[0:3], a[224:227], v[192:195], a[0:3]
v_exp_f32 v176, v176
v_mfma_f32_16x16x32_bf16 a[32:35], a[224:227], v[196:199], a[32:35]
v_exp_f32 v177, v177
v_mfma_f32_16x16x32_bf16 a[4:7], a[228:231], v[192:195], a[4:7]
v_exp_f32 v178, v178
v_mfma_f32_16x16x32_bf16 a[36:39], a[228:231], v[196:199], a[36:39]
v_exp_f32 v179, v179
v_mfma_f32_16x16x32_bf16 a[8:11], a[232:235], v[192:195], a[8:11]
v_exp_f32 v180, v180
v_mfma_f32_16x16x32_bf16 a[40:43], a[232:235], v[196:199], a[40:43]
v_exp_f32 v181, v181
v_mfma_f32_16x16x32_bf16 a[12:15], a[236:239], v[192:195], a[12:15]
v_exp_f32 v182, v182
v_mfma_f32_16x16x32_bf16 a[44:47], a[236:239], v[196:199], a[44:47]
v_exp_f32 v183, v183
v_mfma_f32_16x16x32_bf16 a[16:19], a[240:243], v[192:195], a[16:19]
buffer_load_dwordx4 v18, s[12:15], s55 offen offset:2048 sc1 nt lds
v_exp_f32 v184, v184
v_mfma_f32_16x16x32_bf16 a[48:51], a[240:243], v[196:199], a[48:51]
v_exp_f32 v185, v185
v_mfma_f32_16x16x32_bf16 a[20:23], a[244:247], v[192:195], a[20:23]
v_exp_f32 v186, v186
v_mfma_f32_16x16x32_bf16 a[52:55], a[244:247], v[196:199], a[52:55]
s_waitcnt vmcnt(4)
v_exp_f32 v187, v187
v_mfma_f32_16x16x32_bf16 a[24:27], a[248:251], v[192:195], a[24:27]
v_exp_f32 v188, v188
v_mfma_f32_16x16x32_bf16 a[56:59], a[248:251], v[196:199], a[56:59]
v_exp_f32 v189, v189
v_mfma_f32_16x16x32_bf16 a[28:31], a[252:255], v[192:195], a[28:31]
v_exp_f32 v190, v190
v_mfma_f32_16x16x32_bf16 a[60:63], a[252:255], v[196:199], a[60:63]
v_exp_f32 v191, v191
v_mfma_f32_16x16x32_bf16 v[232:235], v[48:51], v[192:195], v[232:235]
v_cvt_pk_bf16_f32 v200, v176, v177
v_cvt_pk_bf16_f32 v201, v178, v179
v_mfma_f32_16x16x32_bf16 v[236:239], v[48:51], v[196:199], v[236:239]
v_cvt_pk_bf16_f32 v202, v180, v181
v_cvt_pk_bf16_f32 v203, v182, v183
v_mfma_f32_16x16x32_bf16 v[160:163], a[192:195], v[128:131], v[224:227]
v_cvt_pk_bf16_f32 v204, v184, v185
v_cvt_pk_bf16_f32 v205, v186, v187
v_mfma_f32_16x16x32_bf16 v[160:163], a[196:199], v[132:135], v[160:163]
v_cvt_pk_bf16_f32 v206, v188, v189
v_cvt_pk_bf16_f32 v207, v190, v191
v_mfma_f32_16x16x32_bf16 v[160:163], a[200:203], v[136:139], v[160:163]
buffer_load_dwordx4 v19, s[12:15], s55 offen offset:3072 sc1 nt lds
v_mfma_f32_16x16x32_bf16 v[160:163], a[204:207], v[140:143], v[160:163]
v_mfma_f32_16x16x32_bf16 v[164:167], a[208:211], v[128:131], v[224:227]
v_mfma_f32_16x16x32_bf16 v[164:167], a[212:215], v[132:135], v[164:167]
s_waitcnt vmcnt(8)
v_mfma_f32_16x16x32_bf16 v[164:167], a[216:219], v[136:139], v[164:167]
s_barrier
v_mfma_f32_16x16x32_bf16 v[164:167], a[220:223], v[140:143], v[164:167]
v_mfma_f32_16x16x32_bf16 v[168:171], a[192:195], v[144:147], v[228:231]
ds_read_b128 a[192:195], v20 offset:49152
v_mfma_f32_16x16x32_bf16 v[168:171], a[196:199], v[148:151], v[168:171]
ds_read_b128 a[196:199], v21 offset:49152
s_waitcnt vmcnt(4)
v_mfma_f32_16x16x32_bf16 v[168:171], a[200:203], v[152:155], v[168:171]
ds_read_b128 a[200:203], v22 offset:49152
v_mfma_f32_16x16x32_bf16 v[168:171], a[204:207], v[156:159], v[168:171]
ds_read_b128 a[204:207], v23 offset:49152
v_mfma_f32_16x16x32_bf16 v[172:175], a[208:211], v[144:147], v[228:231]
ds_read_b128 a[208:211], v20 offset:53248
v_mfma_f32_16x16x32_bf16 v[172:175], a[212:215], v[148:151], v[172:175]
ds_read_b128 a[212:215], v21 offset:53248
v_mfma_f32_16x16x32_bf16 v[172:175], a[216:219], v[152:155], v[172:175]
ds_read_b128 a[216:219], v22 offset:53248
v_mfma_f32_16x16x32_bf16 v[172:175], a[220:223], v[156:159], v[172:175]
ds_read_b128 a[220:223], v23 offset:53248
s_add_u32 m0, s54, 16384
v_mfma_f32_16x16x32_bf16 a[64:67], a[224:227], v[200:203], a[64:67]
s_and_b32 s55, s30, 0x3ffff
v_exp_f32 v160, v160
v_mfma_f32_16x16x32_bf16 a[96:99], a[224:227], v[204:207], a[96:99]
v_exp_f32 v161, v161
v_mfma_f32_16x16x32_bf16 a[68:71], a[228:231], v[200:203], a[68:71]
buffer_load_dwordx4 v16, s[12:15], s55 offen offset:0 sc1 nt lds
v_exp_f32 v162, v162
v_mfma_f32_16x16x32_bf16 a[100:103], a[228:231], v[204:207], a[100:103]
s_add_u32 s30, s30, 4096
v_exp_f32 v163, v163
v_mfma_f32_16x16x32_bf16 a[72:75], a[232:235], v[200:203], a[72:75]
v_exp_f32 v164, v164
v_mfma_f32_16x16x32_bf16 a[104:107], a[232:235], v[204:207], a[104:107]
s_waitcnt vmcnt(4)
v_exp_f32 v165, v165
v_mfma_f32_16x16x32_bf16 a[76:79], a[236:239], v[200:203], a[76:79]
v_exp_f32 v166, v166
v_mfma_f32_16x16x32_bf16 a[108:111], a[236:239], v[204:207], a[108:111]
v_exp_f32 v167, v167
v_mfma_f32_16x16x32_bf16 a[80:83], a[240:243], v[200:203], a[80:83]
v_exp_f32 v168, v168
v_mfma_f32_16x16x32_bf16 a[112:115], a[240:243], v[204:207], a[112:115]
v_exp_f32 v169, v169
v_mfma_f32_16x16x32_bf16 a[84:87], a[244:247], v[200:203], a[84:87]
v_exp_f32 v170, v170
v_mfma_f32_16x16x32_bf16 a[116:119], a[244:247], v[204:207], a[116:119]
v_exp_f32 v171, v171
v_mfma_f32_16x16x32_bf16 a[88:91], a[248:251], v[200:203], a[88:91]
v_exp_f32 v172, v172
v_mfma_f32_16x16x32_bf16 a[120:123], a[248:251], v[204:207], a[120:123]
v_exp_f32 v173, v173
v_mfma_f32_16x16x32_bf16 a[92:95], a[252:255], v[200:203], a[92:95]
buffer_load_dwordx4 v17, s[12:15], s55 offen offset:1024 sc1 nt lds
v_exp_f32 v174, v174
v_mfma_f32_16x16x32_bf16 a[124:127], a[252:255], v[204:207], a[124:127]
v_exp_f32 v175, v175
v_mfma_f32_16x16x32_bf16 v[240:243], v[48:51], v[200:203], v[240:243]
v_cvt_pk_bf16_f32 v192, v160, v161
v_cvt_pk_bf16_f32 v193, v162, v163
v_mfma_f32_16x16x32_bf16 v[244:247], v[48:51], v[204:207], v[244:247]
s_waitcnt lgkmcnt(0)
s_waitcnt vmcnt(4)
v_cvt_pk_bf16_f32 v194, v164, v165
v_cvt_pk_bf16_f32 v195, v166, v167
v_mfma_f32_16x16x32_bf16 v[176:179], a[192:195], v[64:67], v[208:211]
v_cvt_pk_bf16_f32 v196, v168, v169
v_cvt_pk_bf16_f32 v197, v170, v171
v_mfma_f32_16x16x32_bf16 v[176:179], a[196:199], v[68:71], v[176:179]
v_cvt_pk_bf16_f32 v198, v172, v173
v_cvt_pk_bf16_f32 v199, v174, v175
v_mfma_f32_16x16x32_bf16 v[176:179], a[200:203], v[72:75], v[176:179]
v_mfma_f32_16x16x32_bf16 v[176:179], a[204:207], v[76:79], v[176:179]
v_mfma_f32_16x16x32_bf16 v[180:183], a[208:211], v[64:67], v[208:211]
v_mfma_f32_16x16x32_bf16 v[180:183], a[212:215], v[68:71], v[180:183]
v_mfma_f32_16x16x32_bf16 v[180:183], a[216:219], v[72:75], v[180:183]
v_mfma_f32_16x16x32_bf16 v[180:183], a[220:223], v[76:79], v[180:183]
v_mfma_f32_16x16x32_bf16 v[184:187], a[192:195], v[80:83], v[212:215]
buffer_load_dwordx4 v18, s[12:15], s55 offen offset:2048 sc1 nt lds
v_mfma_f32_16x16x32_bf16 v[184:187], a[196:199], v[84:87], v[184:187]
v_mfma_f32_16x16x32_bf16 v[184:187], a[200:203], v[88:91], v[184:187]
v_mfma_f32_16x16x32_bf16 v[184:187], a[204:207], v[92:95], v[184:187]
s_waitcnt vmcnt(4)
v_mfma_f32_16x16x32_bf16 v[188:191], a[208:211], v[80:83], v[212:215]
v_mfma_f32_16x16x32_bf16 v[188:191], a[212:215], v[84:87], v[188:191]
v_mfma_f32_16x16x32_bf16 v[188:191], a[216:219], v[88:91], v[188:191]
v_mfma_f32_16x16x32_bf16 v[188:191], a[220:223], v[92:95], v[188:191]
v_mfma_f32_16x16x32_bf16 a[128:131], a[224:227], v[192:195], a[128:131]
v_exp_f32 v176, v176
v_mfma_f32_16x16x32_bf16 a[160:163], a[224:227], v[196:199], a[160:163]
v_exp_f32 v177, v177
v_mfma_f32_16x16x32_bf16 a[132:135], a[228:231], v[192:195], a[132:135]
v_exp_f32 v178, v178
v_mfma_f32_16x16x32_bf16 a[164:167], a[228:231], v[196:199], a[164:167]
v_exp_f32 v179, v179
v_mfma_f32_16x16x32_bf16 a[136:139], a[232:235], v[192:195], a[136:139]
buffer_load_dwordx4 v19, s[12:15], s55 offen offset:3072 sc1 nt lds
v_exp_f32 v180, v180
v_mfma_f32_16x16x32_bf16 a[168:171], a[232:235], v[196:199], a[168:171]
v_exp_f32 v181, v181
v_mfma_f32_16x16x32_bf16 a[140:143], a[236:239], v[192:195], a[140:143]
s_waitcnt vmcnt(4)
v_exp_f32 v182, v182
v_mfma_f32_16x16x32_bf16 a[172:175], a[236:239], v[196:199], a[172:175]
v_exp_f32 v183, v183
v_mfma_f32_16x16x32_bf16 a[144:147], a[240:243], v[192:195], a[144:147]
v_exp_f32 v184, v184
v_mfma_f32_16x16x32_bf16 a[176:179], a[240:243], v[196:199], a[176:179]
v_exp_f32 v185, v185
v_mfma_f32_16x16x32_bf16 a[148:151], a[244:247], v[192:195], a[148:151]
v_exp_f32 v186, v186
v_mfma_f32_16x16x32_bf16 a[180:183], a[244:247], v[196:199], a[180:183]
v_exp_f32 v187, v187
v_mfma_f32_16x16x32_bf16 a[152:155], a[248:251], v[192:195], a[152:155]
s_add_u32 m0, s54, 20480
v_exp_f32 v188, v188
v_mfma_f32_16x16x32_bf16 a[184:187], a[248:251], v[196:199], a[184:187]
s_and_b32 s55, s30, 0x3ffff
v_exp_f32 v189, v189
v_mfma_f32_16x16x32_bf16 a[156:159], a[252:255], v[192:195], a[156:159]
v_exp_f32 v190, v190
v_mfma_f32_16x16x32_bf16 a[188:191], a[252:255], v[196:199], a[188:191]
buffer_load_dwordx4 v16, s[12:15], s55 offen offset:0 sc1 nt lds
v_exp_f32 v191, v191
v_mfma_f32_16x16x32_bf16 v[248:251], v[48:51], v[192:195], v[248:251]
s_add_u32 s30, s30, s101
v_cvt_pk_bf16_f32 v200, v176, v177
v_cvt_pk_bf16_f32 v201, v178, v179
v_mfma_f32_16x16x32_bf16 v[252:255], v[48:51], v[196:199], v[252:255]
v_cvt_pk_bf16_f32 v202, v180, v181
v_cvt_pk_bf16_f32 v203, v182, v183
v_mfma_f32_16x16x32_bf16 v[160:163], a[192:195], v[96:99], v[216:219]
v_cvt_pk_bf16_f32 v204, v184, v185
v_cvt_pk_bf16_f32 v205, v186, v187
v_mfma_f32_16x16x32_bf16 v[160:163], a[196:199], v[100:103], v[160:163]
v_cvt_pk_bf16_f32 v206, v188, v189
v_cvt_pk_bf16_f32 v207, v190, v191
v_mfma_f32_16x16x32_bf16 v[160:163], a[200:203], v[104:107], v[160:163]
s_waitcnt vmcnt(4)
ds_read_b64_tr_b16 a[224:225], v24 offset:49152
ds_read_b64_tr_b16 a[226:227], v24 offset:53248
v_mfma_f32_16x16x32_bf16 v[160:163], a[204:207], v[108:111], v[160:163]
ds_read_b64_tr_b16 a[228:229], v25 offset:49152
ds_read_b64_tr_b16 a[230:231], v25 offset:53248
v_mfma_f32_16x16x32_bf16 v[164:167], a[208:211], v[96:99], v[216:219]
ds_read_b64_tr_b16 a[232:233], v26 offset:49152
ds_read_b64_tr_b16 a[234:235], v26 offset:53248
v_mfma_f32_16x16x32_bf16 v[164:167], a[212:215], v[100:103], v[164:167]
ds_read_b64_tr_b16 a[236:237], v27 offset:49152
ds_read_b64_tr_b16 a[238:239], v27 offset:53248
v_mfma_f32_16x16x32_bf16 v[164:167], a[216:219], v[104:107], v[164:167]
ds_read_b64_tr_b16 a[240:241], v28 offset:49152
ds_read_b64_tr_b16 a[242:243], v28 offset:53248
v_mfma_f32_16x16x32_bf16 v[164:167], a[220:223], v[108:111], v[164:167]
ds_read_b64_tr_b16 a[244:245], v29 offset:49152
ds_read_b64_tr_b16 a[246:247], v29 offset:53248
v_mfma_f32_16x16x32_bf16 v[168:171], a[192:195], v[112:115], v[220:223]
ds_read_b64_tr_b16 a[248:249], v30 offset:49152
ds_read_b64_tr_b16 a[250:251], v30 offset:53248
v_mfma_f32_16x16x32_bf16 v[168:171], a[196:199], v[116:119], v[168:171]
ds_read_b64_tr_b16 a[252:253], v31 offset:49152
ds_read_b64_tr_b16 a[254:255], v31 offset:53248
v_mfma_f32_16x16x32_bf16 v[168:171], a[200:203], v[120:123], v[168:171]
v_mfma_f32_16x16x32_bf16 v[168:171], a[204:207], v[124:127], v[168:171]
buffer_load_dwordx4 v17, s[12:15], s55 offen offset:1024 sc1 nt lds
v_mfma_f32_16x16x32_bf16 v[172:175], a[208:211], v[112:115], v[220:223]
v_mfma_f32_16x16x32_bf16 v[172:175], a[212:215], v[116:119], v[172:175]
v_mfma_f32_16x16x32_bf16 v[172:175], a[216:219], v[120:123], v[172:175]
v_mfma_f32_16x16x32_bf16 v[172:175], a[220:223], v[124:127], v[172:175]
s_waitcnt vmcnt(4)
s_waitcnt lgkmcnt(0)
v_mfma_f32_16x16x32_bf16 a[0:3], a[224:227], v[200:203], a[0:3]
v_exp_f32 v160, v160
v_mfma_f32_16x16x32_bf16 a[32:35], a[224:227], v[204:207], a[32:35]
v_exp_f32 v161, v161
v_mfma_f32_16x16x32_bf16 a[4:7], a[228:231], v[200:203], a[4:7]
v_exp_f32 v162, v162
v_mfma_f32_16x16x32_bf16 a[36:39], a[228:231], v[204:207], a[36:39]
v_exp_f32 v163, v163
v_mfma_f32_16x16x32_bf16 a[8:11], a[232:235], v[200:203], a[8:11]
v_exp_f32 v164, v164
v_mfma_f32_16x16x32_bf16 a[40:43], a[232:235], v[204:207], a[40:43]
v_exp_f32 v165, v165
v_mfma_f32_16x16x32_bf16 a[12:15], a[236:239], v[200:203], a[12:15]
v_exp_f32 v166, v166
v_mfma_f32_16x16x32_bf16 a[44:47], a[236:239], v[204:207], a[44:47]
v_exp_f32 v167, v167
v_mfma_f32_16x16x32_bf16 a[16:19], a[240:243], v[200:203], a[16:19]
buffer_load_dwordx4 v18, s[12:15], s55 offen offset:2048 sc1 nt lds
v_exp_f32 v168, v168
v_mfma_f32_16x16x32_bf16 a[48:51], a[240:243], v[204:207], a[48:51]
v_exp_f32 v169, v169
v_mfma_f32_16x16x32_bf16 a[20:23], a[244:247], v[200:203], a[20:23]
v_exp_f32 v170, v170
v_mfma_f32_16x16x32_bf16 a[52:55], a[244:247], v[204:207], a[52:55]
s_waitcnt vmcnt(4)
v_exp_f32 v171, v171
v_mfma_f32_16x16x32_bf16 a[24:27], a[248:251], v[200:203], a[24:27]
v_exp_f32 v172, v172
v_mfma_f32_16x16x32_bf16 a[56:59], a[248:251], v[204:207], a[56:59]
v_exp_f32 v173, v173
v_mfma_f32_16x16x32_bf16 a[28:31], a[252:255], v[200:203], a[28:31]
v_exp_f32 v174, v174
v_mfma_f32_16x16x32_bf16 a[60:63], a[252:255], v[204:207], a[60:63]
v_exp_f32 v175, v175
v_mfma_f32_16x16x32_bf16 v[232:235], v[48:51], v[200:203], v[232:235]
v_cvt_pk_bf16_f32 v192, v160, v161
v_cvt_pk_bf16_f32 v193, v162, v163
v_mfma_f32_16x16x32_bf16 v[236:239], v[48:51], v[204:207], v[236:239]
v_cvt_pk_bf16_f32 v194, v164, v165
v_cvt_pk_bf16_f32 v195, v166, v167
v_mfma_f32_16x16x32_bf16 v[176:179], a[192:195], v[128:131], v[224:227]
v_cvt_pk_bf16_f32 v196, v168, v169
v_cvt_pk_bf16_f32 v197, v170, v171
v_mfma_f32_16x16x32_bf16 v[176:179], a[196:199], v[132:135], v[176:179]
v_cvt_pk_bf16_f32 v198, v172, v173
v_cvt_pk_bf16_f32 v199, v174, v175
v_mfma_f32_16x16x32_bf16 v[176:179], a[200:203], v[136:139], v[176:179]
buffer_load_dwordx4 v19, s[12:15], s55 offen offset:3072 sc1 nt lds
v_mfma_f32_16x16x32_bf16 v[176:179], a[204:207], v[140:143], v[176:179]
v_mfma_f32_16x16x32_bf16 v[180:183], a[208:211], v[128:131], v[224:227]
v_mfma_f32_16x16x32_bf16 v[180:183], a[212:215], v[132:135], v[180:183]
s_waitcnt vmcnt(8)
v_mfma_f32_16x16x32_bf16 v[180:183], a[216:219], v[136:139], v[180:183]
s_barrier
v_mfma_f32_16x16x32_bf16 v[180:183], a[220:223], v[140:143], v[180:183]
v_mfma_f32_16x16x32_bf16 v[184:187], a[192:195], v[144:147], v[228:231]
ds_read_b128 a[192:195], v20 offset:0
v_mfma_f32_16x16x32_bf16 v[184:187], a[196:199], v[148:151], v[184:187]
ds_read_b128 a[196:199], v21 offset:0
s_waitcnt vmcnt(4)
v_mfma_f32_16x16x32_bf16 v[184:187], a[200:203], v[152:155], v[184:187]
ds_read_b128 a[200:203], v22 offset:0
v_mfma_f32_16x16x32_bf16 v[184:187], a[204:207], v[156:159], v[184:187]
ds_read_b128 a[204:207], v23 offset:0
v_mfma_f32_16x16x32_bf16 v[188:191], a[208:211], v[144:147], v[228:231]
ds_read_b128 a[208:211], v20 offset:4096
v_mfma_f32_16x16x32_bf16 v[188:191], a[212:215], v[148:151], v[188:191]
ds_read_b128 a[212:215], v21 offset:4096
v_mfma_f32_16x16x32_bf16 v[188:191], a[216:219], v[152:155], v[188:191]
ds_read_b128 a[216:219], v22 offset:4096
v_mfma_f32_16x16x32_bf16 v[188:191], a[220:223], v[156:159], v[188:191]
ds_read_b128 a[220:223], v23 offset:4096
s_add_u32 m0, s54, 32768
v_mfma_f32_16x16x32_bf16 a[64:67], a[224:227], v[192:195], a[64:67]
s_and_b32 s55, s30, 0x3ffff
v_exp_f32 v176, v176
v_mfma_f32_16x16x32_bf16 a[96:99], a[224:227], v[196:199], a[96:99]
v_exp_f32 v177, v177
v_mfma_f32_16x16x32_bf16 a[68:71], a[228:231], v[192:195], a[68:71]
buffer_load_dwordx4 v16, s[12:15], s55 offen offset:0 sc1 nt lds
v_exp_f32 v178, v178
v_mfma_f32_16x16x32_bf16 a[100:103], a[228:231], v[196:199], a[100:103]
s_add_u32 s30, s30, 4096
v_exp_f32 v179, v179
v_mfma_f32_16x16x32_bf16 a[72:75], a[232:235], v[192:195], a[72:75]
v_exp_f32 v180, v180
v_mfma_f32_16x16x32_bf16 a[104:107], a[232:235], v[196:199], a[104:107]
s_waitcnt vmcnt(4)
v_exp_f32 v181, v181
v_mfma_f32_16x16x32_bf16 a[76:79], a[236:239], v[192:195], a[76:79]
v_exp_f32 v182, v182
v_mfma_f32_16x16x32_bf16 a[108:111], a[236:239], v[196:199], a[108:111]
v_exp_f32 v183, v183
v_mfma_f32_16x16x32_bf16 a[80:83], a[240:243], v[192:195], a[80:83]
v_exp_f32 v184, v184
v_mfma_f32_16x16x32_bf16 a[112:115], a[240:243], v[196:199], a[112:115]
v_exp_f32 v185, v185
v_mfma_f32_16x16x32_bf16 a[84:87], a[244:247], v[192:195], a[84:87]
v_exp_f32 v186, v186
v_mfma_f32_16x16x32_bf16 a[116:119], a[244:247], v[196:199], a[116:119]
v_exp_f32 v187, v187
v_mfma_f32_16x16x32_bf16 a[88:91], a[248:251], v[192:195], a[88:91]
v_exp_f32 v188, v188
v_mfma_f32_16x16x32_bf16 a[120:123], a[248:251], v[196:199], a[120:123]
v_exp_f32 v189, v189
v_mfma_f32_16x16x32_bf16 a[92:95], a[252:255], v[192:195], a[92:95]
buffer_load_dwordx4 v17, s[12:15], s55 offen offset:1024 sc1 nt lds
v_exp_f32 v190, v190
v_mfma_f32_16x16x32_bf16 a[124:127], a[252:255], v[196:199], a[124:127]
v_exp_f32 v191, v191
v_mfma_f32_16x16x32_bf16 v[240:243], v[48:51], v[192:195], v[240:243]
v_cvt_pk_bf16_f32 v200, v176, v177
v_cvt_pk_bf16_f32 v201, v178, v179
v_mfma_f32_16x16x32_bf16 v[244:247], v[48:51], v[196:199], v[244:247]
s_waitcnt lgkmcnt(0)
s_waitcnt vmcnt(4)
v_cvt_pk_bf16_f32 v202, v180, v181
v_cvt_pk_bf16_f32 v203, v182, v183
v_mfma_f32_16x16x32_bf16 v[160:163], a[192:195], v[64:67], v[208:211]
v_cvt_pk_bf16_f32 v204, v184, v185
v_cvt_pk_bf16_f32 v205, v186, v187
v_mfma_f32_16x16x32_bf16 v[160:163], a[196:199], v[68:71], v[160:163]
v_cvt_pk_bf16_f32 v206, v188, v189
v_cvt_pk_bf16_f32 v207, v190, v191
v_mfma_f32_16x16x32_bf16 v[160:163], a[200:203], v[72:75], v[160:163]
v_mfma_f32_16x16x32_bf16 v[160:163], a[204:207], v[76:79], v[160:163]
v_mfma_f32_16x16x32_bf16 v[164:167], a[208:211], v[64:67], v[208:211]
v_mfma_f32_16x16x32_bf16 v[164:167], a[212:215], v[68:71], v[164:167]
v_mfma_f32_16x16x32_bf16 v[164:167], a[216:219], v[72:75], v[164:167]
v_mfma_f32_16x16x32_bf16 v[164:167], a[220:223], v[76:79], v[164:167]
v_mfma_f32_16x16x32_bf16 v[168:171], a[192:195], v[80:83], v[212:215]
buffer_load_dwordx4 v18, s[12:15], s55 offen offset:2048 sc1 nt lds
v_mfma_f32_16x16x32_bf16 v[168:171], a[196:199], v[84:87], v[168:171]
v_mfma_f32_16x16x32_bf16 v[168:171], a[200:203], v[88:91], v[168:171]
v_mfma_f32_16x16x32_bf16 v[168:171], a[204:207], v[92:95], v[168:171]
s_waitcnt vmcnt(4)
v_mfma_f32_16x16x32_bf16 v[172:175], a[208:211], v[80:83], v[212:215]
v_mfma_f32_16x16x32_bf16 v[172:175], a[212:215], v[84:87], v[172:175]
v_mfma_f32_16x16x32_bf16 v[172:175], a[216:219], v[88:91], v[172:175]
v_mfma_f32_16x16x32_bf16 v[172:175], a[220:223], v[92:95], v[172:175]
v_mfma_f32_16x16x32_bf16 a[128:131], a[224:227], v[200:203], a[128:131]
v_exp_f32 v160, v160
v_mfma_f32_16x16x32_bf16 a[160:163], a[224:227], v[204:207], a[160:163]
v_exp_f32 v161, v161
v_mfma_f32_16x16x32_bf16 a[132:135], a[228:231], v[200:203], a[132:135]
v_exp_f32 v162, v162
v_mfma_f32_16x16x32_bf16 a[164:167], a[228:231], v[204:207], a[164:167]
v_exp_f32 v163, v163
v_mfma_f32_16x16x32_bf16 a[136:139], a[232:235], v[200:203], a[136:139]
buffer_load_dwordx4 v19, s[12:15], s55 offen offset:3072 sc1 nt lds
v_exp_f32 v164, v164
v_mfma_f32_16x16x32_bf16 a[168:171], a[232:235], v[204:207], a[168:171]
v_exp_f32 v165, v165
v_mfma_f32_16x16x32_bf16 a[140:143], a[236:239], v[200:203], a[140:143]
s_waitcnt vmcnt(4)
v_exp_f32 v166, v166
v_mfma_f32_16x16x32_bf16 a[172:175], a[236:239], v[204:207], a[172:175]
v_exp_f32 v167, v167
v_mfma_f32_16x16x32_bf16 a[144:147], a[240:243], v[200:203], a[144:147]
v_exp_f32 v168, v168
v_mfma_f32_16x16x32_bf16 a[176:179], a[240:243], v[204:207], a[176:179]
v_exp_f32 v169, v169
v_mfma_f32_16x16x32_bf16 a[148:151], a[244:247], v[200:203], a[148:151]
v_exp_f32 v170, v170
v_mfma_f32_16x16x32_bf16 a[180:183], a[244:247], v[204:207], a[180:183]
v_exp_f32 v171, v171
v_mfma_f32_16x16x32_bf16 a[152:155], a[248:251], v[200:203], a[152:155]
s_add_u32 m0, s54, 36864
v_exp_f32 v172, v172
v_mfma_f32_16x16x32_bf16 a[184:187], a[248:251], v[204:207], a[184:187]
s_and_b32 s55, s30, 0x3ffff
v_exp_f32 v173, v173
v_mfma_f32_16x16x32_bf16 a[156:159], a[252:255], v[200:203], a[156:159]
v_exp_f32 v174, v174
v_mfma_f32_16x16x32_bf16 a[188:191], a[252:255], v[204:207], a[188:191]
buffer_load_dwordx4 v16, s[12:15], s55 offen offset:0 sc1 nt lds
v_exp_f32 v175, v175
v_mfma_f32_16x16x32_bf16 v[248:251], v[48:51], v[200:203], v[248:251]
s_add_u32 s30, s30, s101
v_cvt_pk_bf16_f32 v192, v160, v161
v_cvt_pk_bf16_f32 v193, v162, v163
v_mfma_f32_16x16x32_bf16 v[252:255], v[48:51], v[204:207], v[252:255]
v_cvt_pk_bf16_f32 v194, v164, v165
v_cvt_pk_bf16_f32 v195, v166, v167
s_sub_u32 s57, s57, 1
s_cmp_lg_u32 s57, 0
s_cbranch_scc1 L_loop
L_peel:
v_mfma_f32_16x16x32_bf16 v[176:179], a[192:195], v[96:99], v[216:219]
v_cvt_pk_bf16_f32 v196, v168, v169
v_cvt_pk_bf16_f32 v197, v170, v171
v_mfma_f32_16x16x32_bf16 v[176:179], a[196:199], v[100:103], v[176:179]
v_cvt_pk_bf16_f32 v198, v172, v173
v_cvt_pk_bf16_f32 v199, v174, v175
v_mfma_f32_16x16x32_bf16 v[176:179], a[200:203], v[104:107], v[176:179]
s_waitcnt vmcnt(4)
ds_read_b64_tr_b16 a[224:225], v24 offset:0
ds_read_b64_tr_b16 a[226:227], v24 offset:4096
v_mfma_f32_16x16x32_bf16 v[176:179], a[204:207], v[108:111], v[176:179]
ds_read_b64_tr_b16 a[228:229], v25 offset:0
ds_read_b64_tr_b16 a[230:231], v25 offset:4096
v_mfma_f32_16x16x32_bf16 v[180:183], a[208:211], v[96:99], v[216:219]
ds_read_b64_tr_b16 a[232:233], v26 offset:0
ds_read_b64_tr_b16 a[234:235], v26 offset:4096
v_mfma_f32_16x16x32_bf16 v[180:183], a[212:215], v[100:103], v[180:183]
ds_read_b64_tr_b16 a[236:237], v27 offset:0
ds_read_b64_tr_b16 a[238:239], v27 offset:4096
v_mfma_f32_16x16x32_bf16 v[180:183], a[216:219], v[104:107], v[180:183]
ds_read_b64_tr_b16 a[240:241], v28 offset:0
ds_read_b64_tr_b16 a[242:243], v28 offset:4096
v_mfma_f32_16x16x32_bf16 v[180:183], a[220:223], v[108:111], v[180:183]
ds_read_b64_tr_b16 a[244:245], v29 offset:0
ds_read_b64_tr_b16 a[246:247], v29 offset:4096
v_mfma_f32_16x16x32_bf16 v[184:187], a[192:195], v[112:115], v[220:223]
ds_read_b64_tr_b16 a[248:249], v30 offset:0
ds_read_b64_tr_b16 a[250:251], v30 offset:4096
v_mfma_f32_16x16x32_bf16 v[184:187], a[196:199], v[116:119], v[184:187]
ds_read_b64_tr_b16 a[252:253], v31 offset:0
ds_read_b64_tr_b16 a[254:255], v31 offset:4096
v_mfma_f32_16x16x32_bf16 v[184:187], a[200:203], v[120:123], v[184:187]
v_mfma_f32_16x16x32_bf16 v[184:187], a[204:207], v[124:127], v[184:187]
buffer_load_dwordx4 v17, s[12:15], s55 offen offset:1024 sc1 nt lds
v_mfma_f32_16x16x32_bf16 v[188:191], a[208:211], v[112:115], v[220:223]
v_mfma_f32_16x16x32_bf16 v[188:191], a[212:215], v[116:119], v[188:191]
v_mfma_f32_16x16x32_bf16 v[188:191], a[216:219], v[120:123], v[188:191]
v_mfma_f32_16x16x32_bf16 v[188:191], a[220:223], v[124:127], v[188:191]
s_waitcnt vmcnt(4)
s_waitcnt lgkmcnt(0)
v_mfma_f32_16x16x32_bf16 a[0:3], a[224:227], v[192:195], a[0:3]
v_exp_f32 v176, v176
v_mfma_f32_16x16x32_bf16 a[32:35], a[224:227], v[196:199], a[32:35]
v_exp_f32 v177, v177
v_mfma_f32_16x16x32_bf16 a[4:7], a[228:231], v[192:195], a[4:7]
v_exp_f32 v178, v178
v_mfma_f32_16x16x32_bf16 a[36:39], a[228:231], v[196:199], a[36:39]
v_exp_f32 v179, v179
v_mfma_f32_16x16x32_bf16 a[8:11], a[232:235], v[192:195], a[8:11]
v_exp_f32 v180, v180
v_mfma_f32_16x16x32_bf16 a[40:43], a[232:235], v[196:199], a[40:43]
v_exp_f32 v181, v181
v_mfma_f32_16x16x32_bf16 a[12:15], a[236:239], v[192:195], a[12:15]
v_exp_f32 v182, v182
v_mfma_f32_16x16x32_bf16 a[44:47], a[236:239], v[196:199], a[44:47]
v_exp_f32 v183, v183
v_mfma_f32_16x16x32_bf16 a[16:19], a[240:243], v[192:195], a[16:19]
buffer_load_dwordx4 v18, s[12:15], s55 offen offset:2048 sc1 nt lds
v_exp_f32 v184, v184
v_mfma_f32_16x16x32_bf16 a[48:51], a[240:243], v[196:199], a[48:51]
v_exp_f32 v185, v185
v_mfma_f32_16x16x32_bf16 a[20:23], a[244:247], v[192:195], a[20:23]
v_exp_f32 v186, v186
v_mfma_f32_16x16x32_bf16 a[52:55], a[244:247], v[196:199], a[52:55]
s_waitcnt vmcnt(4)
v_exp_f32 v187, v187
v_mfma_f32_16x16x32_bf16 a[24:27], a[248:251], v[192:195], a[24:27]
v_exp_f32 v188, v188
v_mfma_f32_16x16x32_bf16 a[56:59], a[248:251], v[196:199], a[56:59]
v_exp_f32 v189, v189
v_mfma_f32_16x16x32_bf16 a[28:31], a[252:255], v[192:195], a[28:31]
v_exp_f32 v190, v190
v_mfma_f32_16x16x32_bf16 a[60:63], a[252:255], v[196:199], a[60:63]
v_exp_f32 v191, v191
v_mfma_f32_16x16x32_bf16 v[232:235], v[48:51], v[192:195], v[232:235]
v_cvt_pk_bf16_f32 v200, v176, v177
v_cvt_pk_bf16_f32 v201, v178, v179
v_mfma_f32_16x16x32_bf16 v[236:239], v[48:51], v[196:199], v[236:239]
v_cvt_pk_bf16_f32 v202, v180, v181
v_cvt_pk_bf16_f32 v203, v182, v183
v_mfma_f32_16x16x32_bf16 v[160:163], a[192:195], v[128:131], v[224:227]
v_cvt_pk_bf16_f32 v204, v184, v185
v_cvt_pk_bf16_f32 v205, v186, v187
v_mfma_f32_16x16x32_bf16 v[160:163], a[196:199], v[132:135], v[160:163]
v_cvt_pk_bf16_f32 v206, v188, v189
v_cvt_pk_bf16_f32 v207, v190, v191
v_mfma_f32_16x16x32_bf16 v[160:163], a[200:203], v[136:139], v[160:163]
buffer_load_dwordx4 v19, s[12:15], s55 offen offset:3072 sc1 nt lds
v_mfma_f32_16x16x32_bf16 v[160:163], a[204:207], v[140:143], v[160:163]
v_mfma_f32_16x16x32_bf16 v[164:167], a[208:211], v[128:131], v[224:227]
v_mfma_f32_16x16x32_bf16 v[164:167], a[212:215], v[132:135], v[164:167]
s_waitcnt vmcnt(8)
v_mfma_f32_16x16x32_bf16 v[164:167], a[216:219], v[136:139], v[164:167]
s_barrier
v_mfma_f32_16x16x32_bf16 v[164:167], a[220:223], v[140:143], v[164:167]
v_mfma_f32_16x16x32_bf16 v[168:171], a[192:195], v[144:147], v[228:231]
ds_read_b128 a[192:195], v20 offset:16384
v_mfma_f32_16x16x32_bf16 v[168:171], a[196:199], v[148:151], v[168:171]
ds_read_b128 a[196:199], v21 offset:16384
s_waitcnt vmcnt(4)
v_mfma_f32_16x16x32_bf16 v[168:171], a[200:203], v[152:155], v[168:171]
ds_read_b128 a[200:203], v22 offset:16384
v_mfma_f32_16x16x32_bf16 v[168:171], a[204:207], v[156:159], v[168:171]
ds_read_b128 a[204:207], v23 offset:16384
v_mfma_f32_16x16x32_bf16 v[172:175], a[208:211], v[144:147], v[228:231]
ds_read_b128 a[208:211], v20 offset:20480
v_mfma_f32_16x16x32_bf16 v[172:175], a[212:215], v[148:151], v[172:175]
ds_read_b128 a[212:215], v21 offset:20480
v_mfma_f32_16x16x32_bf16 v[172:175], a[216:219], v[152:155], v[172:175]
ds_read_b128 a[216:219], v22 offset:20480
v_mfma_f32_16x16x32_bf16 v[172:175], a[220:223], v[156:159], v[172:175]
ds_read_b128 a[220:223], v23 offset:20480
s_add_u32 m0, s54, 49152
v_mfma_f32_16x16x32_bf16 a[64:67], a[224:227], v[200:203], a[64:67]
s_and_b32 s55, s30, 0x3ffff
v_exp_f32 v160, v160
v_mfma_f32_16x16x32_bf16 a[96:99], a[224:227], v[204:207], a[96:99]
v_exp_f32 v161, v161
v_mfma_f32_16x16x32_bf16 a[68:71], a[228:231], v[200:203], a[68:71]
buffer_load_dwordx4 v16, s[12:15], s55 offen offset:0 sc1 nt lds
v_exp_f32 v162, v162
v_mfma_f32_16x16x32_bf16 a[100:103], a[228:231], v[204:207], a[100:103]
s_add_u32 s30, s30, 4096
v_exp_f32 v163, v163
v_mfma_f32_16x16x32_bf16 a[72:75], a[232:235], v[200:203], a[72:75]
v_exp_f32 v164, v164
v_mfma_f32_16x16x32_bf16 a[104:107], a[232:235], v[204:207], a[104:107]
s_waitcnt vmcnt(4)
v_exp_f32 v165, v165
v_mfma_f32_16x16x32_bf16 a[76:79], a[236:239], v[200:203], a[76:79]
v_exp_f32 v166, v166
v_mfma_f32_16x16x32_bf16 a[108:111], a[236:239], v[204:207], a[108:111]
v_exp_f32 v167, v167
v_mfma_f32_16x16x32_bf16 a[80:83], a[240:243], v[200:203], a[80:83]
v_exp_f32 v168, v168
v_mfma_f32_16x16x32_bf16 a[112:115], a[240:243], v[204:207], a[112:115]
v_exp_f32 v169, v169
v_mfma_f32_16x16x32_bf16 a[84:87], a[244:247], v[200:203], a[84:87]
v_exp_f32 v170, v170
v_mfma_f32_16x16x32_bf16 a[116:119], a[244:247], v[204:207], a[116:119]
v_exp_f32 v171, v171
v_mfma_f32_16x16x32_bf16 a[88:91], a[248:251], v[200:203], a[88:91]
v_exp_f32 v172, v172
v_mfma_f32_16x16x32_bf16 a[120:123], a[248:251], v[204:207], a[120:123]
v_exp_f32 v173, v173
v_mfma_f32_16x16x32_bf16 a[92:95], a[252:255], v[200:203], a[92:95]
buffer_load_dwordx4 v17, s[12:15], s55 offen offset:1024 sc1 nt lds
v_exp_f32 v174, v174
v_mfma_f32_16x16x32_bf16 a[124:127], a[252:255], v[204:207], a[124:127]
v_exp_f32 v175, v175
v_mfma_f32_16x16x32_bf16 v[240:243], v[48:51], v[200:203], v[240:243]
v_cvt_pk_bf16_f32 v192, v160, v161
v_cvt_pk_bf16_f32 v193, v162, v163
v_mfma_f32_16x16x32_bf16 v[244:247], v[48:51], v[204:207], v[244:247]
s_waitcnt lgkmcnt(0)
s_waitcnt vmcnt(4)
v_cvt_pk_bf16_f32 v194, v164, v165
v_cvt_pk_bf16_f32 v195, v166, v167
v_mfma_f32_16x16x32_bf16 v[176:179], a[192:195], v[64:67], v[208:211]
v_cvt_pk_bf16_f32 v196, v168, v169
v_cvt_pk_bf16_f32 v197, v170, v171
v_mfma_f32_16x16x32_bf16 v[176:179], a[196:199], v[68:71], v[176:179]
v_cvt_pk_bf16_f32 v198, v172, v173
v_cvt_pk_bf16_f32 v199, v174, v175
v_mfma_f32_16x16x32_bf16 v[176:179], a[200:203], v[72:75], v[176:179]
v_mfma_f32_16x16x32_bf16 v[176:179], a[204:207], v[76:79], v[176:179]
v_mfma_f32_16x16x32_bf16 v[180:183], a[208:211], v[64:67], v[208:211]
v_mfma_f32_16x16x32_bf16 v[180:183], a[212:215], v[68:71], v[180:183]
v_mfma_f32_16x16x32_bf16 v[180:183], a[216:219], v[72:75], v[180:183]
v_mfma_f32_16x16x32_bf16 v[180:183], a[220:223], v[76:79], v[180:183]
v_mfma_f32_16x16x32_bf16 v[184:187], a[192:195], v[80:83], v[212:215]
buffer_load_dwordx4 v18, s[12:15], s55 offen offset:2048 sc1 nt lds
v_mfma_f32_16x16x32_bf16 v[184:187], a[196:199], v[84:87], v[184:187]
v_mfma_f32_16x16x32_bf16 v[184:187], a[200:203], v[88:91], v[184:187]
v_mfma_f32_16x16x32_bf16 v[184:187], a[204:207], v[92:95], v[184:187]
s_waitcnt vmcnt(4)
v_mfma_f32_16x16x32_bf16 v[188:191], a[208:211], v[80:83], v[212:215]
v_mfma_f32_16x16x32_bf16 v[188:191], a[212:215], v[84:87], v[188:191]
v_mfma_f32_16x16x32_bf16 v[188:191], a[216:219], v[88:91], v[188:191]
v_mfma_f32_16x16x32_bf16 v[188:191], a[220:223], v[92:95], v[188:191]
v_mfma_f32_16x16x32_bf16 a[128:131], a[224:227], v[192:195], a[128:131]
v_exp_f32 v176, v176
v_mfma_f32_16x16x32_bf16 a[160:163], a[224:227], v[196:199], a[160:163]
v_exp_f32 v177, v177
v_mfma_f32_16x16x32_bf16 a[132:135], a[228:231], v[192:195], a[132:135]
v_exp_f32 v178, v178
v_mfma_f32_16x16x32_bf16 a[164:167], a[228:231], v[196:199], a[164:167]
v_exp_f32 v179, v179
v_mfma_f32_16x16x32_bf16 a[136:139], a[232:235], v[192:195], a[136:139]
buffer_load_dwordx4 v19, s[12:15], s55 offen offset:3072 sc1 nt lds
v_exp_f32 v180, v180
v_mfma_f32_16x16x32_bf16 a[168:171], a[232:235], v[196:199], a[168:171]
v_exp_f32 v181, v181
v_mfma_f32_16x16x32_bf16 a[140:143], a[236:239], v[192:195], a[140:143]
s_waitcnt vmcnt(4)
v_exp_f32 v182, v182
v_mfma_f32_16x16x32_bf16 a[172:175], a[236:239], v[196:199], a[172:175]
v_exp_f32 v183, v183
v_mfma_f32_16x16x32_bf16 a[144:147], a[240:243], v[192:195], a[144:147]
v_exp_f32 v184, v184
v_mfma_f32_16x16x32_bf16 a[176:179], a[240:243], v[196:199], a[176:179]
v_exp_f32 v185, v185
v_mfma_f32_16x16x32_bf16 a[148:151], a[244:247], v[192:195], a[148:151]
v_exp_f32 v186, v186
v_mfma_f32_16x16x32_bf16 a[180:183], a[244:247], v[196:199], a[180:183]
v_exp_f32 v187, v187
v_mfma_f32_16x16x32_bf16 a[152:155], a[248:251], v[192:195], a[152:155]
s_add_u32 m0, s54, 53248
v_exp_f32 v188, v188
v_mfma_f32_16x16x32_bf16 a[184:187], a[248:251], v[196:199], a[184:187]
s_and_b32 s55, s30, 0x3ffff
v_exp_f32 v189, v189
v_mfma_f32_16x16x32_bf16 a[156:159], a[252:255], v[192:195], a[156:159]
v_exp_f32 v190, v190
v_mfma_f32_16x16x32_bf16 a[188:191], a[252:255], v[196:199], a[188:191]
buffer_load_dwordx4 v16, s[12:15], s55 offen offset:0 sc1 nt lds
v_exp_f32 v191, v191
v_mfma_f32_16x16x32_bf16 v[248:251], v[48:51], v[192:195], v[248:251]
s_add_u32 s30, s30, s101
v_cvt_pk_bf16_f32 v200, v176, v177
v_cvt_pk_bf16_f32 v201, v178, v179
v_mfma_f32_16x16x32_bf16 v[252:255], v[48:51], v[196:199], v[252:255]
v_cvt_pk_bf16_f32 v202, v180, v181
v_cvt_pk_bf16_f32 v203, v182, v183
v_mfma_f32_16x16x32_bf16 v[160:163], a[192:195], v[96:99], v[216:219]
v_cvt_pk_bf16_f32 v204, v184, v185
v_cvt_pk_bf16_f32 v205, v186, v187
v_mfma_f32_16x16x32_bf16 v[160:163], a[196:199], v[100:103], v[160:163]
v_cvt_pk_bf16_f32 v206, v188, v189
v_cvt_pk_bf16_f32 v207, v190, v191
v_mfma_f32_16x16x32_bf16 v[160:163], a[200:203], v[104:107], v[160:163]
s_waitcnt vmcnt(4)
ds_read_b64_tr_b16 a[224:225], v24 offset:16384
ds_read_b64_tr_b16 a[226:227], v24 offset:20480
v_mfma_f32_16x16x32_bf16 v[160:163], a[204:207], v[108:111], v[160:163]
ds_read_b64_tr_b16 a[228:229], v25 offset:16384
ds_read_b64_tr_b16 a[230:231], v25 offset:20480
v_mfma_f32_16x16x32_bf16 v[164:167], a[208:211], v[96:99], v[216:219]
ds_read_b64_tr_b16 a[232:233], v26 offset:16384
ds_read_b64_tr_b16 a[234:235], v26 offset:20480
v_mfma_f32_16x16x32_bf16 v[164:167], a[212:215], v[100:103], v[164:167]
ds_read_b64_tr_b16 a[236:237], v27 offset:16384
ds_read_b64_tr_b16 a[238:239], v27 offset:20480
v_mfma_f32_16x16x32_bf16 v[164:167], a[216:219], v[104:107], v[164:167]
ds_read_b64_tr_b16 a[240:241], v28 offset:16384
ds_read_b64_tr_b16 a[242:243], v28 offset:20480
v_mfma_f32_16x16x32_bf16 v[164:167], a[220:223], v[108:111], v[164:167]
ds_read_b64_tr_b16 a[244:245], v29 offset:16384
ds_read_b64_tr_b16 a[246:247], v29 offset:20480
v_mfma_f32_16x16x32_bf16 v[168:171], a[192:195], v[112:115], v[220:223]
ds_read_b64_tr_b16 a[248:249], v30 offset:16384
ds_read_b64_tr_b16 a[250:251], v30 offset:20480
v_mfma_f32_16x16x32_bf16 v[168:171], a[196:199], v[116:119], v[168:171]
ds_read_b64_tr_b16 a[252:253], v31 offset:16384
ds_read_b64_tr_b16 a[254:255], v31 offset:20480
v_mfma_f32_16x16x32_bf16 v[168:171], a[200:203], v[120:123], v[168:171]
v_mfma_f32_16x16x32_bf16 v[168:171], a[204:207], v[124:127], v[168:171]
buffer_load_dwordx4 v17, s[12:15], s55 offen offset:1024 sc1 nt lds
v_mfma_f32_16x16x32_bf16 v[172:175], a[208:211], v[112:115], v[220:223]
v_mfma_f32_16x16x32_bf16 v[172:175], a[212:215], v[116:119], v[172:175]
v_mfma_f32_16x16x32_bf16 v[172:175], a[216:219], v[120:123], v[172:175]
v_mfma_f32_16x16x32_bf16 v[172:175], a[220:223], v[124:127], v[172:175]
s_waitcnt vmcnt(4)
s_waitcnt lgkmcnt(0)
v_mfma_f32_16x16x32_bf16 a[0:3], a[224:227], v[200:203], a[0:3]
v_exp_f32 v160, v160
v_mfma_f32_16x16x32_bf16 a[32:35], a[224:227], v[204:207], a[32:35]
v_exp_f32 v161, v161
v_mfma_f32_16x16x32_bf16 a[4:7], a[228:231], v[200:203], a[4:7]
v_exp_f32 v162, v162
v_mfma_f32_16x16x32_bf16 a[36:39], a[228:231], v[204:207], a[36:39]
v_exp_f32 v163, v163
v_mfma_f32_16x16x32_bf16 a[8:11], a[232:235], v[200:203], a[8:11]
v_exp_f32 v164, v164
v_mfma_f32_16x16x32_bf16 a[40:43], a[232:235], v[204:207], a[40:43]
v_exp_f32 v165, v165
v_mfma_f32_16x16x32_bf16 a[12:15], a[236:239], v[200:203], a[12:15]
v_exp_f32 v166, v166
v_mfma_f32_16x16x32_bf16 a[44:47], a[236:239], v[204:207], a[44:47]
v_exp_f32 v167, v167
v_mfma_f32_16x16x32_bf16 a[16:19], a[240:243], v[200:203], a[16:19]
buffer_load_dwordx4 v18, s[12:15], s55 offen offset:2048 sc1 nt lds
v_exp_f32 v168, v168
v_mfma_f32_16x16x32_bf16 a[48:51], a[240:243], v[204:207], a[48:51]
v_exp_f32 v169, v169
v_mfma_f32_16x16x32_bf16 a[20:23], a[244:247], v[200:203], a[20:23]
v_exp_f32 v170, v170
v_mfma_f32_16x16x32_bf16 a[52:55], a[244:247], v[204:207], a[52:55]
s_waitcnt vmcnt(4)
v_exp_f32 v171, v171
v_mfma_f32_16x16x32_bf16 a[24:27], a[248:251], v[200:203], a[24:27]
v_exp_f32 v172, v172
v_mfma_f32_16x16x32_bf16 a[56:59], a[248:251], v[204:207], a[56:59]
v_exp_f32 v173, v173
v_mfma_f32_16x16x32_bf16 a[28:31], a[252:255], v[200:203], a[28:31]
v_exp_f32 v174, v174
v_mfma_f32_16x16x32_bf16 a[60:63], a[252:255], v[204:207], a[60:63]
v_exp_f32 v175, v175
v_mfma_f32_16x16x32_bf16 v[232:235], v[48:51], v[200:203], v[232:235]
v_cvt_pk_bf16_f32 v192, v160, v161
v_cvt_pk_bf16_f32 v193, v162, v163
v_mfma_f32_16x16x32_bf16 v[236:239], v[48:51], v[204:207], v[236:239]
v_cvt_pk_bf16_f32 v194, v164, v165
v_cvt_pk_bf16_f32 v195, v166, v167
v_mfma_f32_16x16x32_bf16 v[176:179], a[192:195], v[128:131], v[224:227]
v_cvt_pk_bf16_f32 v196, v168, v169
v_cvt_pk_bf16_f32 v197, v170, v171
v_mfma_f32_16x16x32_bf16 v[176:179], a[196:199], v[132:135], v[176:179]
v_cvt_pk_bf16_f32 v198, v172, v173
v_cvt_pk_bf16_f32 v199, v174, v175
v_mfma_f32_16x16x32_bf16 v[176:179], a[200:203], v[136:139], v[176:179]
buffer_load_dwordx4 v19, s[12:15], s55 offen offset:3072 sc1 nt lds
v_mfma_f32_16x16x32_bf16 v[176:179], a[204:207], v[140:143], v[176:179]
v_mfma_f32_16x16x32_bf16 v[180:183], a[208:211], v[128:131], v[224:227]
v_mfma_f32_16x16x32_bf16 v[180:183], a[212:215], v[132:135], v[180:183]
s_waitcnt vmcnt(8)
v_mfma_f32_16x16x32_bf16 v[180:183], a[216:219], v[136:139], v[180:183]
s_barrier
v_mfma_f32_16x16x32_bf16 v[180:183], a[220:223], v[140:143], v[180:183]
v_mfma_f32_16x16x32_bf16 v[184:187], a[192:195], v[144:147], v[228:231]
ds_read_b128 a[192:195], v20 offset:32768
v_mfma_f32_16x16x32_bf16 v[184:187], a[196:199], v[148:151], v[184:187]
ds_read_b128 a[196:199], v21 offset:32768
v_mfma_f32_16x16x32_bf16 v[184:187], a[200:203], v[152:155], v[184:187]
ds_read_b128 a[200:203], v22 offset:32768
v_mfma_f32_16x16x32_bf16 v[184:187], a[204:207], v[156:159], v[184:187]
ds_read_b128 a[204:207], v23 offset:32768
v_mfma_f32_16x16x32_bf16 v[188:191], a[208:211], v[144:147], v[228:231]
ds_read_b128 a[208:211], v20 offset:36864
v_mfma_f32_16x16x32_bf16 v[188:191], a[212:215], v[148:151], v[188:191]
ds_read_b128 a[212:215], v21 offset:36864
v_mfma_f32_16x16x32_bf16 v[188:191], a[216:219], v[152:155], v[188:191]
ds_read_b128 a[216:219], v22 offset:36864
v_mfma_f32_16x16x32_bf16 v[188:191], a[220:223], v[156:159], v[188:191]
ds_read_b128 a[220:223], v23 offset:36864
v_mfma_f32_16x16x32_bf16 a[64:67], a[224:227], v[192:195], a[64:67]
v_exp_f32 v176, v176
v_mfma_f32_16x16x32_bf16 a[96:99], a[224:227], v[196:199], a[96:99]
v_exp_f32 v177, v177
v_mfma_f32_16x16x32_bf16 a[68:71], a[228:231], v[192:195], a[68:71]
v_exp_f32 v178, v178
v_mfma_f32_16x16x32_bf16 a[100:103], a[228:231], v[196:199], a[100:103]
v_exp_f32 v179, v179
v_mfma_f32_16x16x32_bf16 a[72:75], a[232:235], v[192:195], a[72:75]
v_exp_f32 v180, v180
v_mfma_f32_16x16x32_bf16 a[104:107], a[232:235], v[196:199], a[104:107]
v_exp_f32 v181, v181
v_mfma_f32_16x16x32_bf16 a[76:79], a[236:239], v[192:195], a[76:79]
v_exp_f32 v182, v182
v_mfma_f32_16x16x32_bf16 a[108:111], a[236:239], v[196:199], a[108:111]
v_exp_f32 v183, v183
v_mfma_f32_16x16x32_bf16 a[80:83], a[240:243], v[192:195], a[80:83]
v_exp_f32 v184, v184
v_mfma_f32_16x16x32_bf16 a[112:115], a[240:243], v[196:199], a[112:115]
v_exp_f32 v185, v185
v_mfma_f32_16x16x32_bf16 a[84:87], a[244:247], v[192:195], a[84:87]
v_exp_f32 v186, v186
v_mfma_f32_16x16x32_bf16 a[116:119], a[244:247], v[196:199], a[116:119]
v_exp_f32 v187, v187
v_mfma_f32_16x16x32_bf16 a[88:91], a[248:251], v[192:195], a[88:91]
v_exp_f32 v188, v188
v_mfma_f32_16x16x32_bf16 a[120:123], a[248:251], v[196:199], a[120:123]
v_exp_f32 v189, v189
v_mfma_f32_16x16x32_bf16 a[92:95], a[252:255], v[192:195], a[92:95]
v_exp_f32 v190, v190
v_mfma_f32_16x16x32_bf16 a[124:127], a[252:255], v[196:199], a[124:127]
v_exp_f32 v191, v191
v_mfma_f32_16x16x32_bf16 v[240:243], v[48:51], v[192:195], v[240:243]
v_cvt_pk_bf16_f32 v200, v176, v177
v_cvt_pk_bf16_f32 v201, v178, v179
v_mfma_f32_16x16x32_bf16 v[244:247], v[48:51], v[196:199], v[244:247]
s_waitcnt lgkmcnt(0)
v_cvt_pk_bf16_f32 v202, v180, v181
v_cvt_pk_bf16_f32 v203, v182, v183
v_mfma_f32_16x16x32_bf16 v[160:163], a[192:195], v[64:67], v[208:211]
s_add_u32 m0, s54, 0
v_cvt_pk_bf16_f32 v204, v184, v185
v_cvt_pk_bf16_f32 v205, v186, v187
v_mfma_f32_16x16x32_bf16 v[160:163], a[196:199], v[68:71], v[160:163]
s_add_u32 s55, s96, 0
v_cvt_pk_bf16_f32 v206, v188, v189
v_cvt_pk_bf16_f32 v207, v190, v191
v_mfma_f32_16x16x32_bf16 v[160:163], a[200:203], v[72:75], v[160:163]
buffer_load_dwordx4 v5, s[92:95], s55 offen offset:0  lds
v_mfma_f32_16x16x32_bf16 v[160:163], a[204:207], v[76:79], v[160:163]
v_mfma_f32_16x16x32_bf16 v[164:167], a[208:211], v[64:67], v[208:211]
v_mfma_f32_16x16x32_bf16 v[164:167], a[212:215], v[68:71], v[164:167]
buffer_load_dwordx4 v6, s[92:95], s55 offen offset:1024  lds
v_mfma_f32_16x16x32_bf16 v[164:167], a[216:219], v[72:75], v[164:167]
v_mfma_f32_16x16x32_bf16 v[164:167], a[220:223], v[76:79], v[164:167]
v_mfma_f32_16x16x32_bf16 v[168:171], a[192:195], v[80:83], v[212:215]
buffer_load_dwordx4 v7, s[92:95], s55 offen offset:2048  lds
v_mfma_f32_16x16x32_bf16 v[168:171], a[196:199], v[84:87], v[168:171]
v_mfma_f32_16x16x32_bf16 v[168:171], a[200:203], v[88:91], v[168:171]
v_mfma_f32_16x16x32_bf16 v[168:171], a[204:207], v[92:95], v[168:171]
buffer_load_dwordx4 v8, s[92:95], s55 offen offset:3072  lds
v_mfma_f32_16x16x32_bf16 v[172:175], a[208:211], v[80:83], v[212:215]
s_add_u32 m0, s54, 4096
v_mfma_f32_16x16x32_bf16 v[172:175], a[212:215], v[84:87], v[172:175]
s_nop 0
v_mfma_f32_16x16x32_bf16 v[172:175], a[216:219], v[88:91], v[172:175]
buffer_load_dwordx4 v9, s[92:95], s55 offen offset:0  lds
v_mfma_f32_16x16x32_bf16 v[172:175], a[220:223], v[92:95], v[172:175]
v_mfma_f32_16x16x32_bf16 a[128:131], a[224:227], v[200:203], a[128:131]
v_exp_f32 v160, v160
v_mfma_f32_16x16x32_bf16 a[160:163], a[224:227], v[204:207], a[160:163]
v_exp_f32 v161, v161
v_mfma_f32_16x16x32_bf16 a[132:135], a[228:231], v[200:203], a[132:135]
v_exp_f32 v162, v162
v_mfma_f32_16x16x32_bf16 a[164:167], a[228:231], v[204:207], a[164:167]
v_exp_f32 v163, v163
v_mfma_f32_16x16x32_bf16 a[136:139], a[232:235], v[200:203], a[136:139]
v_exp_f32 v164, v164
v_mfma_f32_16x16x32_bf16 a[168:171], a[232:235], v[204:207], a[168:171]
v_exp_f32 v165, v165
v_mfma_f32_16x16x32_bf16 a[140:143], a[236:239], v[200:203], a[140:143]
v_exp_f32 v166, v166
v_mfma_f32_16x16x32_bf16 a[172:175], a[236:239], v[204:207], a[172:175]
v_exp_f32 v167, v167
v_mfma_f32_16x16x32_bf16 a[144:147], a[240:243], v[200:203], a[144:147]
v_exp_f32 v168, v168
v_mfma_f32_16x16x32_bf16 a[176:179], a[240:243], v[204:207], a[176:179]
v_exp_f32 v169, v169
v_mfma_f32_16x16x32_bf16 a[148:151], a[244:247], v[200:203], a[148:151]
v_exp_f32 v170, v170
v_mfma_f32_16x16x32_bf16 a[180:183], a[244:247], v[204:207], a[180:183]
v_exp_f32 v171, v171
v_mfma_f32_16x16x32_bf16 a[152:155], a[248:251], v[200:203], a[152:155]
v_exp_f32 v172, v172
v_mfma_f32_16x16x32_bf16 a[184:187], a[248:251], v[204:207], a[184:187]
v_exp_f32 v173, v173
v_mfma_f32_16x16x32_bf16 a[156:159], a[252:255], v[200:203], a[156:159]
v_exp_f32 v174, v174
v_mfma_f32_16x16x32_bf16 a[188:191], a[252:255], v[204:207], a[188:191]
v_exp_f32 v175, v175
v_mfma_f32_16x16x32_bf16 v[248:251], v[48:51], v[200:203], v[248:251]
v_cvt_pk_bf16_f32 v192, v160, v161
v_cvt_pk_bf16_f32 v193, v162, v163
v_mfma_f32_16x16x32_bf16 v[252:255], v[48:51], v[204:207], v[252:255]
v_cvt_pk_bf16_f32 v194, v164, v165
v_cvt_pk_bf16_f32 v195, v166, v167
v_mfma_f32_16x16x32_bf16 v[176:179], a[192:195], v[96:99], v[216:219]
s_add_u32 m0, s54, 16384
v_cvt_pk_bf16_f32 v196, v168, v169
v_cvt_pk_bf16_f32 v197, v170, v171
v_mfma_f32_16x16x32_bf16 v[176:179], a[196:199], v[100:103], v[176:179]
s_add_u32 s55, s96, 40960
v_cvt_pk_bf16_f32 v198, v172, v173
v_cvt_pk_bf16_f32 v199, v174, v175
v_mfma_f32_16x16x32_bf16 v[176:179], a[200:203], v[104:107], v[176:179]
ds_read_b64_tr_b16 a[224:225], v24 offset:32768
ds_read_b64_tr_b16 a[226:227], v24 offset:36864
v_mfma_f32_16x16x32_bf16 v[176:179], a[204:207], v[108:111], v[176:179]
ds_read_b64_tr_b16 a[228:229], v25 offset:32768
ds_read_b64_tr_b16 a[230:231], v25 offset:36864
v_mfma_f32_16x16x32_bf16 v[180:183], a[208:211], v[96:99], v[216:219]
ds_read_b64_tr_b16 a[232:233], v26 offset:32768
ds_read_b64_tr_b16 a[234:235], v26 offset:36864
v_mfma_f32_16x16x32_bf16 v[180:183], a[212:215], v[100:103], v[180:183]
ds_read_b64_tr_b16 a[236:237], v27 offset:32768
ds_read_b64_tr_b16 a[238:239], v27 offset:36864
v_mfma_f32_16x16x32_bf16 v[180:183], a[216:219], v[104:107], v[180:183]
ds_read_b64_tr_b16 a[240:241], v28 offset:32768
ds_read_b64_tr_b16 a[242:243], v28 offset:36864
v_mfma_f32_16x16x32_bf16 v[180:183], a[220:223], v[108:111], v[180:183]
ds_read_b64_tr_b16 a[244:245], v29 offset:32768
ds_read_b64_tr_b16 a[246:247], v29 offset:36864
v_mfma_f32_16x16x32_bf16 v[184:187], a[192:195], v[112:115], v[220:223]
ds_read_b64_tr_b16 a[248:249], v30 offset:32768
ds_read_b64_tr_b16 a[250:251], v30 offset:36864
v_mfma_f32_16x16x32_bf16 v[184:187], a[196:199], v[116:119], v[184:187]
ds_read_b64_tr_b16 a[252:253], v31 offset:32768
ds_read_b64_tr_b16 a[254:255], v31 offset:36864
v_mfma_f32_16x16x32_bf16 v[184:187], a[200:203], v[120:123], v[184:187]
buffer_load_dwordx4 v5, s[92:95], s55 offen offset:0  lds
v_mfma_f32_16x16x32_bf16 v[184:187], a[204:207], v[124:127], v[184:187]
buffer_load_dwordx4 v6, s[92:95], s55 offen offset:1024  lds
v_mfma_f32_16x16x32_bf16 v[188:191], a[208:211], v[112:115], v[220:223]
buffer_load_dwordx4 v7, s[92:95], s55 offen offset:2048  lds
v_mfma_f32_16x16x32_bf16 v[188:191], a[212:215], v[116:119], v[188:191]
buffer_load_dwordx4 v8, s[92:95], s55 offen offset:3072  lds
v_mfma_f32_16x16x32_bf16 v[188:191], a[216:219], v[120:123], v[188:191]
v_mfma_f32_16x16x32_bf16 v[188:191], a[220:223], v[124:127], v[188:191]
s_waitcnt lgkmcnt(0)
v_mfma_f32_16x16x32_bf16 a[0:3], a[224:227], v[192:195], a[0:3]
s_add_u32 m0, s54, 20480
v_exp_f32 v176, v176
v_mfma_f32_16x16x32_bf16 a[32:35], a[224:227], v[196:199], a[32:35]
s_nop 0
v_exp_f32 v177, v177
v_mfma_f32_16x16x32_bf16 a[4:7], a[228:231], v[192:195], a[4:7]
buffer_load_dwordx4 v9, s[92:95], s55 offen offset:0  lds
v_exp_f32 v178, v178
v_mfma_f32_16x16x32_bf16 a[36:39], a[228:231], v[196:199], a[36:39]
v_exp_f32 v179, v179
v_mfma_f32_16x16x32_bf16 a[8:11], a[232:235], v[192:195], a[8:11]
v_exp_f32 v180, v180
v_mfma_f32_16x16x32_bf16 a[40:43], a[232:235], v[196:199], a[40:43]
v_exp_f32 v181, v181
v_mfma_f32_16x16x32_bf16 a[12:15], a[236:239], v[192:195], a[12:15]
v_exp_f32 v182, v182
v_mfma_f32_16x16x32_bf16 a[44:47], a[236:239], v[196:199], a[44:47]
v_exp_f32 v183, v183
v_mfma_f32_16x16x32_bf16 a[16:19], a[240:243], v[192:195], a[16:19]
v_exp_f32 v184, v184
v_mfma_f32_16x16x32_bf16 a[48:51], a[240:243], v[196:199], a[48:51]
v_exp_f32 v185, v185
v_mfma_f32_16x16x32_bf16 a[20:23], a[244:247], v[192:195], a[20:23]
v_exp_f32 v186, v186
v_mfma_f32_16x16x32_bf16 a[52:55], a[244:247], v[196:199], a[52:55]
v_exp_f32 v187, v187
v_mfma_f32_16x16x32_bf16 a[24:27], a[248:251], v[192:195], a[24:27]
v_exp_f32 v188, v188
v_mfma_f32_16x16x32_bf16 a[56:59], a[248:251], v[196:199], a[56:59]
v_exp_f32 v189, v189
v_mfma_f32_16x16x32_bf16 a[28:31], a[252:255], v[192:195], a[28:31]
v_exp_f32 v190, v190
v_mfma_f32_16x16x32_bf16 a[60:63], a[252:255], v[196:199], a[60:63]
v_exp_f32 v191, v191
v_mfma_f32_16x16x32_bf16 v[232:235], v[48:51], v[192:195], v[232:235]
v_cvt_pk_bf16_f32 v200, v176, v177
v_cvt_pk_bf16_f32 v201, v178, v179
v_mfma_f32_16x16x32_bf16 v[236:239], v[48:51], v[196:199], v[236:239]
v_cvt_pk_bf16_f32 v202, v180, v181
v_cvt_pk_bf16_f32 v203, v182, v183
v_mfma_f32_16x16x32_bf16 v[160:163], a[192:195], v[128:131], v[224:227]
v_cvt_pk_bf16_f32 v204, v184, v185
v_cvt_pk_bf16_f32 v205, v186, v187
v_mfma_f32_16x16x32_bf16 v[160:163], a[196:199], v[132:135], v[160:163]
v_cvt_pk_bf16_f32 v206, v188, v189
v_cvt_pk_bf16_f32 v207, v190, v191
v_mfma_f32_16x16x32_bf16 v[160:163], a[200:203], v[136:139], v[160:163]
v_mfma_f32_16x16x32_bf16 v[160:163], a[204:207], v[140:143], v[160:163]
v_mfma_f32_16x16x32_bf16 v[164:167], a[208:211], v[128:131], v[224:227]
v_mfma_f32_16x16x32_bf16 v[164:167], a[212:215], v[132:135], v[164:167]
s_waitcnt vmcnt(10)
v_mfma_f32_16x16x32_bf16 v[164:167], a[216:219], v[136:139], v[164:167]
s_barrier
v_mfma_f32_16x16x32_bf16 v[164:167], a[220:223], v[140:143], v[164:167]
v_mfma_f32_16x16x32_bf16 v[168:171], a[192:195], v[144:147], v[228:231]
ds_read_b128 a[192:195], v20 offset:49152
v_mfma_f32_16x16x32_bf16 v[168:171], a[196:199], v[148:151], v[168:171]
ds_read_b128 a[196:199], v21 offset:49152
v_mfma_f32_16x16x32_bf16 v[168:171], a[200:203], v[152:155], v[168:171]
ds_read_b128 a[200:203], v22 offset:49152
v_mfma_f32_16x16x32_bf16 v[168:171], a[204:207], v[156:159], v[168:171]
ds_read_b128 a[204:207], v23 offset:49152
v_mfma_f32_16x16x32_bf16 v[172:175], a[208:211], v[144:147], v[228:231]
ds_read_b128 a[208:211], v20 offset:53248
v_mfma_f32_16x16x32_bf16 v[172:175], a[212:215], v[148:151], v[172:175]
ds_read_b128 a[212:215], v21 offset:53248
v_mfma_f32_16x16x32_bf16 v[172:175], a[216:219], v[152:155], v[172:175]
ds_read_b128 a[216:219], v22 offset:53248
v_mfma_f32_16x16x32_bf16 v[172:175], a[220:223], v[156:159], v[172:175]
ds_read_b128 a[220:223], v23 offset:53248
v_mfma_f32_16x16x32_bf16 a[64:67], a[224:227], v[200:203], a[64:67]
v_exp_f32 v160, v160
v_mfma_f32_16x16x32_bf16 a[96:99], a[224:227], v[204:207], a[96:99]
v_exp_f32 v161, v161
v_mfma_f32_16x16x32_bf16 a[68:71], a[228:231], v[200:203], a[68:71]
v_exp_f32 v162, v162
v_mfma_f32_16x16x32_bf16 a[100:103], a[228:231], v[204:207], a[100:103]
v_exp_f32 v163, v163
v_mfma_f32_16x16x32_bf16 a[72:75], a[232:235], v[200:203], a[72:75]
v_exp_f32 v164, v164
v_mfma_f32_16x16x32_bf16 a[104:107], a[232:235], v[204:207], a[104:107]
v_exp_f32 v165, v165
v_mfma_f32_16x16x32_bf16 a[76:79], a[236:239], v[200:203], a[76:79]
v_exp_f32 v166, v166
v_mfma_f32_16x16x32_bf16 a[108:111], a[236:239], v[204:207], a[108:111]
v_exp_f32 v167, v167
v_mfma_f32_16x16x32_bf16 a[80:83], a[240:243], v[200:203], a[80:83]
v_exp_f32 v168, v168
v_mfma_f32_16x16x32_bf16 a[112:115], a[240:243], v[204:207], a[112:115]
v_exp_f32 v169, v169
v_mfma_f32_16x16x32_bf16 a[84:87], a[244:247], v[200:203], a[84:87]
v_exp_f32 v170, v170
v_mfma_f32_16x16x32_bf16 a[116:119], a[244:247], v[204:207], a[116:119]
v_exp_f32 v171, v171
v_mfma_f32_16x16x32_bf16 a[88:91], a[248:251], v[200:203], a[88:91]
v_exp_f32 v172, v172
v_mfma_f32_16x16x32_bf16 a[120:123], a[248:251], v[204:207], a[120:123]
v_exp_f32 v173, v173
v_mfma_f32_16x16x32_bf16 a[92:95], a[252:255], v[200:203], a[92:95]
v_exp_f32 v174, v174
v_mfma_f32_16x16x32_bf16 a[124:127], a[252:255], v[204:207], a[124:127]
v_exp_f32 v175, v175
v_mfma_f32_16x16x32_bf16 v[240:243], v[48:51], v[200:203], v[240:243]
v_cvt_pk_bf16_f32 v192, v160, v161
v_cvt_pk_bf16_f32 v193, v162, v163
v_mfma_f32_16x16x32_bf16 v[244:247], v[48:51], v[204:207], v[244:247]
s_waitcnt lgkmcnt(0)
v_cvt_pk_bf16_f32 v194, v164, v165
v_cvt_pk_bf16_f32 v195, v166, v167
v_mfma_f32_16x16x32_bf16 v[176:179], a[192:195], v[64:67], v[208:211]
s_add_u32 m0, s54, 32768
v_cvt_pk_bf16_f32 v196, v168, v169
v_cvt_pk_bf16_f32 v197, v170, v171
v_mfma_f32_16x16x32_bf16 v[176:179], a[196:199], v[68:71], v[176:179]
s_add_u32 s55, s96, 81920
v_cvt_pk_bf16_f32 v198, v172, v173
v_cvt_pk_bf16_f32 v199, v174, v175
v_mfma_f32_16x16x32_bf16 v[176:179], a[200:203], v[72:75], v[176:179]
buffer_load_dwordx4 v5, s[92:95], s55 offen offset:0  lds
v_mfma_f32_16x16x32_bf16 v[176:179], a[204:207], v[76:79], v[176:179]
v_mfma_f32_16x16x32_bf16 v[180:183], a[208:211], v[64:67], v[208:211]
v_mfma_f32_16x16x32_bf16 v[180:183], a[212:215], v[68:71], v[180:183]
buffer_load_dwordx4 v6, s[92:95], s55 offen offset:1024  lds
v_mfma_f32_16x16x32_bf16 v[180:183], a[216:219], v[72:75], v[180:183]
v_mfma_f32_16x16x32_bf16 v[180:183], a[220:223], v[76:79], v[180:183]
v_mfma_f32_16x16x32_bf16 v[184:187], a[192:195], v[80:83], v[212:215]
buffer_load_dwordx4 v7, s[92:95], s55 offen offset:2048  lds
v_mfma_f32_16x16x32_bf16 v[184:187], a[196:199], v[84:87], v[184:187]
v_mfma_f32_16x16x32_bf16 v[184:187], a[200:203], v[88:91], v[184:187]
v_mfma_f32_16x16x32_bf16 v[184:187], a[204:207], v[92:95], v[184:187]
buffer_load_dwordx4 v8, s[92:95], s55 offen offset:3072  lds
v_mfma_f32_16x16x32_bf16 v[188:191], a[208:211], v[80:83], v[212:215]
s_add_u32 m0, s54, 36864
v_mfma_f32_16x16x32_bf16 v[188:191], a[212:215], v[84:87], v[188:191]
s_nop 0
v_mfma_f32_16x16x32_bf16 v[188:191], a[216:219], v[88:91], v[188:191]
buffer_load_dwordx4 v9, s[92:95], s55 offen offset:0  lds
v_mfma_f32_16x16x32_bf16 v[188:191], a[220:223], v[92:95], v[188:191]
v_mfma_f32_16x16x32_bf16 a[128:131], a[224:227], v[192:195], a[128:131]
v_exp_f32 v176, v176
v_mfma_f32_16x16x32_bf16 a[160:163], a[224:227], v[196:199], a[160:163]
v_exp_f32 v177, v177
v_mfma_f32_16x16x32_bf16 a[132:135], a[228:231], v[192:195], a[132:135]
v_exp_f32 v178, v178
v_mfma_f32_16x16x32_bf16 a[164:167], a[228:231], v[196:199], a[164:167]
v_exp_f32 v179, v179
v_mfma_f32_16x16x32_bf16 a[136:139], a[232:235], v[192:195], a[136:139]
v_exp_f32 v180, v180
v_mfma_f32_16x16x32_bf16 a[168:171], a[232:235], v[196:199], a[168:171]
v_exp_f32 v181, v181
v_mfma_f32_16x16x32_bf16 a[140:143], a[236:239], v[192:195], a[140:143]
v_exp_f32 v182, v182
v_mfma_f32_16x16x32_bf16 a[172:175], a[236:239], v[196:199], a[172:175]
v_exp_f32 v183, v183
v_mfma_f32_16x16x32_bf16 a[144:147], a[240:243], v[192:195], a[144:147]
v_exp_f32 v184, v184
v_mfma_f32_16x16x32_bf16 a[176:179], a[240:243], v[196:199], a[176:179]
v_exp_f32 v185, v185
v_mfma_f32_16x16x32_bf16 a[148:151], a[244:247], v[192:195], a[148:151]
v_exp_f32 v186, v186
v_mfma_f32_16x16x32_bf16 a[180:183], a[244:247], v[196:199], a[180:183]
v_exp_f32 v187, v187
v_mfma_f32_16x16x32_bf16 a[152:155], a[248:251], v[192:195], a[152:155]
v_exp_f32 v188, v188
v_mfma_f32_16x16x32_bf16 a[184:187], a[248:251], v[196:199], a[184:187]
v_exp_f32 v189, v189
v_mfma_f32_16x16x32_bf16 a[156:159], a[252:255], v[192:195], a[156:159]
v_exp_f32 v190, v190
v_mfma_f32_16x16x32_bf16 a[188:191], a[252:255], v[196:199], a[188:191]
v_exp_f32 v191, v191
v_mfma_f32_16x16x32_bf16 v[248:251], v[48:51], v[192:195], v[248:251]
v_cvt_pk_bf16_f32 v200, v176, v177
v_cvt_pk_bf16_f32 v201, v178, v179
v_mfma_f32_16x16x32_bf16 v[252:255], v[48:51], v[196:199], v[252:255]
v_cvt_pk_bf16_f32 v202, v180, v181
v_cvt_pk_bf16_f32 v203, v182, v183
v_mfma_f32_16x16x32_bf16 v[160:163], a[192:195], v[96:99], v[216:219]
v_cvt_pk_bf16_f32 v204, v184, v185
v_cvt_pk_bf16_f32 v205, v186, v187
v_mfma_f32_16x16x32_bf16 v[160:163], a[196:199], v[100:103], v[160:163]
v_cvt_pk_bf16_f32 v206, v188, v189
v_cvt_pk_bf16_f32 v207, v190, v191
v_mfma_f32_16x16x32_bf16 v[160:163], a[200:203], v[104:107], v[160:163]
ds_read_b64_tr_b16 a[224:225], v24 offset:49152
ds_read_b64_tr_b16 a[226:227], v24 offset:53248
v_mfma_f32_16x16x32_bf16 v[160:163], a[204:207], v[108:111], v[160:163]
ds_read_b64_tr_b16 a[228:229], v25 offset:49152
ds_read_b64_tr_b16 a[230:231], v25 offset:53248
v_mfma_f32_16x16x32_bf16 v[164:167], a[208:211], v[96:99], v[216:219]
ds_read_b64_tr_b16 a[232:233], v26 offset:49152
ds_read_b64_tr_b16 a[234:235], v26 offset:53248
v_mfma_f32_16x16x32_bf16 v[164:167], a[212:215], v[100:103], v[164:167]
ds_read_b64_tr_b16 a[236:237], v27 offset:49152
ds_read_b64_tr_b16 a[238:239], v27 offset:53248
v_mfma_f32_16x16x32_bf16 v[164:167], a[216:219], v[104:107], v[164:167]
ds_read_b64_tr_b16 a[240:241], v28 offset:49152
ds_read_b64_tr_b16 a[242:243], v28 offset:53248
v_mfma_f32_16x16x32_bf16 v[164:167], a[220:223], v[108:111], v[164:167]
ds_read_b64_tr_b16 a[244:245], v29 offset:49152
ds_read_b64_tr_b16 a[246:247], v29 offset:53248
v_mfma_f32_16x16x32_bf16 v[168:171], a[192:195], v[112:115], v[220:223]
ds_read_b64_tr_b16 a[248:249], v30 offset:49152
ds_read_b64_tr_b16 a[250:251], v30 offset:53248
v_mfma_f32_16x16x32_bf16 v[168:171], a[196:199], v[116:119], v[168:171]
ds_read_b64_tr_b16 a[252:253], v31 offset:49152
ds_read_b64_tr_b16 a[254:255], v31 offset:53248
v_mfma_f32_16x16x32_bf16 v[168:171], a[200:203], v[120:123], v[168:171]
v_mfma_f32_16x16x32_bf16 v[168:171], a[204:207], v[124:127], v[168:171]
v_mfma_f32_16x16x32_bf16 v[172:175], a[208:211], v[112:115], v[220:223]
v_mfma_f32_16x16x32_bf16 v[172:175], a[212:215], v[116:119], v[172:175]
v_mfma_f32_16x16x32_bf16 v[172:175], a[216:219], v[120:123], v[172:175]
v_mfma_f32_16x16x32_bf16 v[172:175], a[220:223], v[124:127], v[172:175]
s_waitcnt lgkmcnt(0)
v_mfma_f32_16x16x32_bf16 a[0:3], a[224:227], v[200:203], a[0:3]
v_exp_f32 v160, v160
v_mfma_f32_16x16x32_bf16 a[32:35], a[224:227], v[204:207], a[32:35]
v_exp_f32 v161, v161
v_mfma_f32_16x16x32_bf16 a[4:7], a[228:231], v[200:203], a[4:7]
v_exp_f32 v162, v162
v_mfma_f32_16x16x32_bf16 a[36:39], a[228:231], v[204:207], a[36:39]
v_exp_f32 v163, v163
v_mfma_f32_16x16x32_bf16 a[8:11], a[232:235], v[200:203], a[8:11]
v_exp_f32 v164, v164
v_mfma_f32_16x16x32_bf16 a[40:43], a[232:235], v[204:207], a[40:43]
v_exp_f32 v165, v165
v_mfma_f32_16x16x32_bf16 a[12:15], a[236:239], v[200:203], a[12:15]
v_exp_f32 v166, v166
v_mfma_f32_16x16x32_bf16 a[44:47], a[236:239], v[204:207], a[44:47]
v_exp_f32 v167, v167
v_mfma_f32_16x16x32_bf16 a[16:19], a[240:243], v[200:203], a[16:19]
v_exp_f32 v168, v168
v_mfma_f32_16x16x32_bf16 a[48:51], a[240:243], v[204:207], a[48:51]
v_exp_f32 v169, v169
v_mfma_f32_16x16x32_bf16 a[20:23], a[244:247], v[200:203], a[20:23]
v_exp_f32 v170, v170
v_mfma_f32_16x16x32_bf16 a[52:55], a[244:247], v[204:207], a[52:55]
v_exp_f32 v171, v171
v_mfma_f32_16x16x32_bf16 a[24:27], a[248:251], v[200:203], a[24:27]
v_exp_f32 v172, v172
v_mfma_f32_16x16x32_bf16 a[56:59], a[248:251], v[204:207], a[56:59]
v_exp_f32 v173, v173
v_mfma_f32_16x16x32_bf16 a[28:31], a[252:255], v[200:203], a[28:31]
v_exp_f32 v174, v174
v_mfma_f32_16x16x32_bf16 a[60:63], a[252:255], v[204:207], a[60:63]
v_exp_f32 v175, v175
v_mfma_f32_16x16x32_bf16 v[232:235], v[48:51], v[200:203], v[232:235]
v_cvt_pk_bf16_f32 v192, v160, v161
v_cvt_pk_bf16_f32 v193, v162, v163
v_mfma_f32_16x16x32_bf16 v[236:239], v[48:51], v[204:207], v[236:239]
v_cvt_pk_bf16_f32 v194, v164, v165
v_cvt_pk_bf16_f32 v195, v166, v167
v_mfma_f32_16x16x32_bf16 v[176:179], a[192:195], v[128:131], v[224:227]
v_cvt_pk_bf16_f32 v196, v168, v169
v_cvt_pk_bf16_f32 v197, v170, v171
v_mfma_f32_16x16x32_bf16 v[176:179], a[196:199], v[132:135], v[176:179]
v_cvt_pk_bf16_f32 v198, v172, v173
v_cvt_pk_bf16_f32 v199, v174, v175
v_mfma_f32_16x16x32_bf16 v[176:179], a[200:203], v[136:139], v[176:179]
v_mfma_f32_16x16x32_bf16 v[176:179], a[204:207], v[140:143], v[176:179]
v_mfma_f32_16x16x32_bf16 v[180:183], a[208:211], v[128:131], v[224:227]
v_mfma_f32_16x16x32_bf16 v[180:183], a[212:215], v[132:135], v[180:183]
v_mfma_f32_16x16x32_bf16 v[180:183], a[216:219], v[136:139], v[180:183]
s_barrier
v_mfma_f32_16x16x32_bf16 v[180:183], a[220:223], v[140:143], v[180:183]
v_mfma_f32_16x16x32_bf16 v[184:187], a[192:195], v[144:147], v[228:231]
v_mfma_f32_16x16x32_bf16 v[184:187], a[196:199], v[148:151], v[184:187]
v_mfma_f32_16x16x32_bf16 v[184:187], a[200:203], v[152:155], v[184:187]
v_mfma_f32_16x16x32_bf16 v[184:187], a[204:207], v[156:159], v[184:187]
v_mfma_f32_16x16x32_bf16 v[188:191], a[208:211], v[144:147], v[228:231]
v_mfma_f32_16x16x32_bf16 v[188:191], a[212:215], v[148:151], v[188:191]
v_mfma_f32_16x16x32_bf16 v[188:191], a[216:219], v[152:155], v[188:191]
v_mfma_f32_16x16x32_bf16 v[188:191], a[220:223], v[156:159], v[188:191]
v_mfma_f32_16x16x32_bf16 a[64:67], a[224:227], v[192:195], a[64:67]
v_exp_f32 v176, v176
v_mfma_f32_16x16x32_bf16 a[96:99], a[224:227], v[196:199], a[96:99]
v_exp_f32 v177, v177
v_mfma_f32_16x16x32_bf16 a[68:71], a[228:231], v[192:195], a[68:71]
v_exp_f32 v178, v178
v_mfma_f32_16x16x32_bf16 a[100:103], a[228:231], v[196:199], a[100:103]
v_exp_f32 v179, v179
v_mfma_f32_16x16x32_bf16 a[72:75], a[232:235], v[192:195], a[72:75]
v_exp_f32 v180, v180
v_mfma_f32_16x16x32_bf16 a[104:107], a[232:235], v[196:199], a[104:107]
v_exp_f32 v181, v181
v_mfma_f32_16x16x32_bf16 a[76:79], a[236:239], v[192:195], a[76:79]
v_exp_f32 v182, v182
v_mfma_f32_16x16x32_bf16 a[108:111], a[236:239], v[196:199], a[108:111]
v_exp_f32 v183, v183
v_mfma_f32_16x16x32_bf16 a[80:83], a[240:243], v[192:195], a[80:83]
v_exp_f32 v184, v184
v_mfma_f32_16x16x32_bf16 a[112:115], a[240:243], v[196:199], a[112:115]
v_exp_f32 v185, v185
v_mfma_f32_16x16x32_bf16 a[84:87], a[244:247], v[192:195], a[84:87]
v_exp_f32 v186, v186
v_mfma_f32_16x16x32_bf16 a[116:119], a[244:247], v[196:199], a[116:119]
v_exp_f32 v187, v187
v_mfma_f32_16x16x32_bf16 a[88:91], a[248:251], v[192:195], a[88:91]
v_exp_f32 v188, v188
v_mfma_f32_16x16x32_bf16 a[120:123], a[248:251], v[196:199], a[120:123]
v_exp_f32 v189, v189
v_mfma_f32_16x16x32_bf16 a[92:95], a[252:255], v[192:195], a[92:95]
v_exp_f32 v190, v190
v_mfma_f32_16x16x32_bf16 a[124:127], a[252:255], v[196:199], a[124:127]
v_exp_f32 v191, v191
v_mfma_f32_16x16x32_bf16 v[240:243], v[48:51], v[192:195], v[240:243]
v_cvt_pk_bf16_f32 v200, v176, v177
v_cvt_pk_bf16_f32 v201, v178, v179
v_mfma_f32_16x16x32_bf16 v[244:247], v[48:51], v[196:199], v[244:247]
v_cvt_pk_bf16_f32 v202, v180, v181
v_cvt_pk_bf16_f32 v203, v182, v183
v_cvt_pk_bf16_f32 v204, v184, v185
v_cvt_pk_bf16_f32 v205, v186, v187
v_cvt_pk_bf16_f32 v206, v188, v189
v_cvt_pk_bf16_f32 v207, v190, v191
s_nop 0
v_mfma_f32_16x16x32_bf16 a[128:131], a[224:227], v[200:203], a[128:131]
s_add_u32 m0, s54, 49152
v_mfma_f32_16x16x32_bf16 a[160:163], a[224:227], v[204:207], a[160:163]
s_add_u32 s55, s96, 122880
v_mfma_f32_16x16x32_bf16 a[132:135], a[228:231], v[200:203], a[132:135]
buffer_load_dwordx4 v5, s[92:95], s55 offen offset:0  lds
v_mfma_f32_16x16x32_bf16 a[164:167], a[228:231], v[204:207], a[164:167]
v_mfma_f32_16x16x32_bf16 a[136:139], a[232:235], v[200:203], a[136:139]
buffer_load_dwordx4 v6, s[92:95], s55 offen offset:1024  lds
v_mfma_f32_16x16x32_bf16 a[168:171], a[232:235], v[204:207], a[168:171]
v_mfma_f32_16x16x32_bf16 a[140:143], a[236:239], v[200:203], a[140:143]
buffer_load_dwordx4 v7, s[92:95], s55 offen offset:2048  lds
v_mfma_f32_16x16x32_bf16 a[172:175], a[236:239], v[204:207], a[172:175]
v_mfma_f32_16x16x32_bf16 a[144:147], a[240:243], v[200:203], a[144:147]
buffer_load_dwordx4 v8, s[92:95], s55 offen offset:3072  lds
v_mfma_f32_16x16x32_bf16 a[176:179], a[240:243], v[204:207], a[176:179]
s_add_u32 m0, s54, 53248
v_mfma_f32_16x16x32_bf16 a[148:151], a[244:247], v[200:203], a[148:151]
s_nop 0
v_mfma_f32_16x16x32_bf16 a[180:183], a[244:247], v[204:207], a[180:183]
buffer_load_dwordx4 v9, s[92:95], s55 offen offset:0  lds
v_mfma_f32_16x16x32_bf16 a[152:155], a[248:251], v[200:203], a[152:155]
v_mfma_f32_16x16x32_bf16 a[184:187], a[248:251], v[204:207], a[184:187]
v_mfma_f32_16x16x32_bf16 a[156:159], a[252:255], v[200:203], a[156:159]
v_mfma_f32_16x16x32_bf16 a[188:191], a[252:255], v[204:207], a[188:191]
v_mfma_f32_16x16x32_bf16 v[248:251], v[48:51], v[200:203], v[248:251]
v_mfma_f32_16x16x32_bf16 v[252:255], v[48:51], v[204:207], v[252:255]
v_readfirstlane_b32 s56, v62
v_readfirstlane_b32 s58, v63
s_nop 5
v_cmp_nge_f32 vcc, s31, v232
v_cmp_nge_f32 s[34:35], s31, v236
s_or_b64 vcc, vcc, s[34:35]
v_cmp_nge_f32 s[34:35], s31, v240
s_or_b64 vcc, vcc, s[34:35]
v_cmp_nge_f32 s[34:35], s31, v244
s_or_b64 vcc, vcc, s[34:35]
v_cmp_nge_f32 s[34:35], s31, v248
s_or_b64 vcc, vcc, s[34:35]
v_cmp_nge_f32 s[34:35], s31, v252
s_or_b64 vcc, vcc, s[34:35]
s_cbranch_vccnz L_fallback
L_epi:
s_lshl_b32 s34, s40, 5
s_lshl_b32 s35, s28, 3
s_add_u32 s34, s34, s35
s_add_u32 s34, s34, s21
s_lshl_b32 s34, s34, 1
s_add_u32 s34, s34, s22
s_mul_i32 s34, s34, 24576
s_add_u32 s4, s44, s34
s_addc_u32 s5, s45, 0
s_mov_b32 s6, 319488
s_mov_b32 s7, 0x20000
s_add_u32 s8, s44, 31457280
s_addc_u32 s9, s45, 0
s_mov_b32 s10, 0x8000
s_mov_b32 s11, 0x20000
s_mov_b32 s36, s50
s_mov_b32 s37, s51
s_movk_i32 s38, 0x100
s_mov_b32 s39, 0x20000
s_lshl_b32 s41, s41, 2
s_lshl_b32 s97, s23, 2
s_mov_b32 s62, 0xa6d95c84
s_mov_b32 s63, 0xfb7e
s_mov_b32 s98, 0
v_mov_b32 v14, 0
v_mov_b32 v15, 1
v_mov_b32 v18, 0x100
v_mov_b32 v22, 0x10000
v_mov_b32 v23, 16
v_mov_b32 v24, 0x100000
v_rcp_f32 v232, v232
v_rcp_f32 v236, v236
v_rcp_f32 v240, v240
v_rcp_f32 v244, v244
v_rcp_f32 v248, v248
v_rcp_f32 v252, v252
v_mov_b32 v233, v232
v_mov_b32 v237, v236
v_mov_b32 v241, v240
v_mov_b32 v245, v244
v_mov_b32 v249, v248
v_mov_b32 v253, v252
v_mov_b32 v26, v232
v_mov_b32 v27, v236
v_mov_b32 v28, v240
v_mov_b32 v29, v244
v_mov_b32 v30, v248
v_mov_b32 v31, v252
s_movk_i32 s52, 0
v_accvgpr_read_b32 v136, a0
v_accvgpr_read_b32 v137, a1
v_accvgpr_read_b32 v138, a2
v_accvgpr_read_b32 v139, a3
v_accvgpr_read_b32 v140, a4
v_accvgpr_read_b32 v141, a5
v_accvgpr_read_b32 v142, a6
v_accvgpr_read_b32 v143, a7
v_pk_mul_f32 v[136:137], v[136:137], v[232:233]
v_pk_mul_f32 v[138:139], v[138:139], v[232:233]
v_pk_mul_f32 v[140:141], v[140:141], v[232:233]
v_pk_mul_f32 v[142:143], v[142:143], v[232:233]
v_cvt_pk_bf16_f32 v40, v136, v137
v_cvt_pk_bf16_f32 v41, v138, v139
v_cvt_pk_bf16_f32 v42, v140, v141
v_cvt_pk_bf16_f32 v43, v142, v143
buffer_store_dwordx4 v[40:43], v32, s[16:19], s52 offen offset:0 sc1
v_accvgpr_read_b32 v144, a32
v_accvgpr_read_b32 v145, a33
v_accvgpr_read_b32 v146, a34
v_accvgpr_read_b32 v147, a35
v_accvgpr_read_b32 v148, a36
v_accvgpr_read_b32 v149, a37
v_accvgpr_read_b32 v150, a38
v_accvgpr_read_b32 v151, a39
v_pk_mul_f32 v[144:145], v[144:145], v[236:237]
v_pk_mul_f32 v[146:147], v[146:147], v[236:237]
v_pk_mul_f32 v[148:149], v[148:149], v[236:237]
v_pk_mul_f32 v[150:151], v[150:151], v[236:237]
v_cvt_pk_bf16_f32 v44, v144, v145
v_cvt_pk_bf16_f32 v45, v146, v147
v_cvt_pk_bf16_f32 v46, v148, v149
v_cvt_pk_bf16_f32 v47, v150, v151
buffer_store_dwordx4 v[44:47], v32, s[16:19], s52 offen offset:1024 sc1
v_accvgpr_read_b32 v136, a64
v_accvgpr_read_b32 v137, a65
v_accvgpr_read_b32 v138, a66
v_accvgpr_read_b32 v139, a67
v_accvgpr_read_b32 v140, a68
v_accvgpr_read_b32 v141, a69
v_accvgpr_read_b32 v142, a70
v_accvgpr_read_b32 v143, a71
v_pk_mul_f32 v[136:137], v[136:137], v[240:241]
v_pk_mul_f32 v[138:139], v[138:139], v[240:241]
v_pk_mul_f32 v[140:141], v[140:141], v[240:241]
v_pk_mul_f32 v[142:143], v[142:143], v[240:241]
v_cvt_pk_bf16_f32 v48, v136, v137
v_cvt_pk_bf16_f32 v49, v138, v139
v_cvt_pk_bf16_f32 v50, v140, v141
v_cvt_pk_bf16_f32 v51, v142, v143
buffer_store_dwordx4 v[48:51], v32, s[16:19], s52 offen offset:2048 sc1
v_accvgpr_read_b32 v144, a96
v_accvgpr_read_b32 v145, a97
v_accvgpr_read_b32 v146, a98
v_accvgpr_read_b32 v147, a99
v_accvgpr_read_b32 v148, a100
v_accvgpr_read_b32 v149, a101
v_accvgpr_read_b32 v150, a102
v_accvgpr_read_b32 v151, a103
v_pk_mul_f32 v[144:145], v[144:145], v[244:245]
v_pk_mul_f32 v[146:147], v[146:147], v[244:245]
v_pk_mul_f32 v[148:149], v[148:149], v[244:245]
v_pk_mul_f32 v[150:151], v[150:151], v[244:245]
v_cvt_pk_bf16_f32 v52, v144, v145
v_cvt_pk_bf16_f32 v53, v146, v147
v_cvt_pk_bf16_f32 v54, v148, v149
v_cvt_pk_bf16_f32 v55, v150, v151
buffer_store_dwordx4 v[52:55], v32, s[16:19], s52 offen offset:3072 sc1
v_accvgpr_read_b32 v136, a128
v_accvgpr_read_b32 v137, a129
v_accvgpr_read_b32 v138, a130
v_accvgpr_read_b32 v139, a131
v_accvgpr_read_b32 v140, a132
v_accvgpr_read_b32 v141, a133
v_accvgpr_read_b32 v142, a134
v_accvgpr_read_b32 v143, a135
v_pk_mul_f32 v[136:137], v[136:137], v[248:249]
v_pk_mul_f32 v[138:139], v[138:139], v[248:249]
v_pk_mul_f32 v[140:141], v[140:141], v[248:249]
v_pk_mul_f32 v[142:143], v[142:143], v[248:249]
v_cvt_pk_bf16_f32 v56, v136, v137
v_cvt_pk_bf16_f32 v57, v138, v139
v_cvt_pk_bf16_f32 v58, v140, v141
v_cvt_pk_bf16_f32 v59, v142, v143
buffer_store_dwordx4 v[56:59], v33, s[16:19], s52 offen offset:0 sc1
v_accvgpr_read_b32 v144, a160
v_accvgpr_read_b32 v145, a161
v_accvgpr_read_b32 v146, a162
v_accvgpr_read_b32 v147, a163
v_accvgpr_read_b32 v148, a164
v_accvgpr_read_b32 v149, a165
v_accvgpr_read_b32 v150, a166
v_accvgpr_read_b32 v151, a167
v_pk_mul_f32 v[144:145], v[144:145], v[252:253]
v_pk_mul_f32 v[146:147], v[146:147], v[252:253]
v_pk_mul_f32 v[148:149], v[148:149], v[252:253]
v_pk_mul_f32 v[150:151], v[150:151], v[252:253]
v_cvt_pk_bf16_f32 v60, v144, v145
v_cvt_pk_bf16_f32 v61, v146, v147
v_cvt_pk_bf16_f32 v62, v148, v149
v_cvt_pk_bf16_f32 v63, v150, v151
buffer_store_dwordx4 v[60:63], v33, s[16:19], s52 offen offset:1024 sc1
s_waitcnt vmcnt(21)
s_barrier
ds_read_b64_tr_b16 a[192:193], v10 offset:0
ds_read_b64_tr_b16 a[194:195], v10 offset:8192
ds_read_b64_tr_b16 a[196:197], v11 offset:0
ds_read_b64_tr_b16 a[198:199], v11 offset:8192
ds_read_b64_tr_b16 a[200:201], v10 offset:64
ds_read_b64_tr_b16 a[202:203], v10 offset:8256
ds_read_b64_tr_b16 a[204:205], v11 offset:64
ds_read_b64_tr_b16 a[206:207], v11 offset:8256
ds_read_b64_tr_b16 a[208:209], v10 offset:128
ds_read_b64_tr_b16 a[210:211], v10 offset:8320
ds_read_b64_tr_b16 a[212:213], v12 offset:0
ds_read_b64_tr_b16 a[214:215], v12 offset:8192
ds_read_b64_tr_b16 a[216:217], v13 offset:0
ds_read_b64_tr_b16 a[218:219], v13 offset:8192
ds_read_b64_tr_b16 a[220:221], v12 offset:64
ds_read_b64_tr_b16 a[222:223], v12 offset:8256
ds_read_b64_tr_b16 a[224:225], v13 offset:64
ds_read_b64_tr_b16 a[226:227], v13 offset:8256
ds_read_b64_tr_b16 a[228:229], v12 offset:128
ds_read_b64_tr_b16 a[230:231], v12 offset:8320
v_accvgpr_read_b32 v136, a8
v_accvgpr_read_b32 v137, a9
v_accvgpr_read_b32 v138, a10
v_accvgpr_read_b32 v139, a11
v_accvgpr_read_b32 v140, a12
v_accvgpr_read_b32 v141, a13
v_accvgpr_read_b32 v142, a14
v_accvgpr_read_b32 v143, a15
v_pk_mul_f32 v[136:137], v[136:137], v[232:233]
v_pk_mul_f32 v[138:139], v[138:139], v[232:233]
v_pk_mul_f32 v[140:141], v[140:141], v[232:233]
v_pk_mul_f32 v[142:143], v[142:143], v[232:233]
v_cvt_pk_bf16_f32 v64, v136, v137
v_cvt_pk_bf16_f32 v65, v138, v139
v_cvt_pk_bf16_f32 v66, v140, v141
v_cvt_pk_bf16_f32 v67, v142, v143
v_accvgpr_read_b32 v144, a40
v_accvgpr_read_b32 v145, a41
v_accvgpr_read_b32 v146, a42
v_accvgpr_read_b32 v147, a43
v_accvgpr_read_b32 v148, a44
v_accvgpr_read_b32 v149, a45
v_accvgpr_read_b32 v150, a46
v_accvgpr_read_b32 v151, a47
v_pk_mul_f32 v[144:145], v[144:145], v[236:237]
v_pk_mul_f32 v[146:147], v[146:147], v[236:237]
v_pk_mul_f32 v[148:149], v[148:149], v[236:237]
v_pk_mul_f32 v[150:151], v[150:151], v[236:237]
v_cvt_pk_bf16_f32 v68, v144, v145
v_cvt_pk_bf16_f32 v69, v146, v147
v_cvt_pk_bf16_f32 v70, v148, v149
v_cvt_pk_bf16_f32 v71, v150, v151
v_accvgpr_read_b32 v136, a72
v_accvgpr_read_b32 v137, a73
v_accvgpr_read_b32 v138, a74
v_accvgpr_read_b32 v139, a75
v_accvgpr_read_b32 v140, a76
v_accvgpr_read_b32 v141, a77
v_accvgpr_read_b32 v142, a78
v_accvgpr_read_b32 v143, a79
v_pk_mul_f32 v[136:137], v[136:137], v[240:241]
v_pk_mul_f32 v[138:139], v[138:139], v[240:241]
v_pk_mul_f32 v[140:141], v[140:141], v[240:241]
v_pk_mul_f32 v[142:143], v[142:143], v[240:241]
v_cvt_pk_bf16_f32 v72, v136, v137
v_cvt_pk_bf16_f32 v73, v138, v139
v_cvt_pk_bf16_f32 v74, v140, v141
v_cvt_pk_bf16_f32 v75, v142, v143
v_accvgpr_read_b32 v144, a104
v_accvgpr_read_b32 v145, a105
v_accvgpr_read_b32 v146, a106
v_accvgpr_read_b32 v147, a107
v_accvgpr_read_b32 v148, a108
v_accvgpr_read_b32 v149, a109
v_accvgpr_read_b32 v150, a110
v_accvgpr_read_b32 v151, a111
v_pk_mul_f32 v[144:145], v[144:145], v[244:245]
v_pk_mul_f32 v[146:147], v[146:147], v[244:245]
v_pk_mul_f32 v[148:149], v[148:149], v[244:245]
v_pk_mul_f32 v[150:151], v[150:151], v[244:245]
v_cvt_pk_bf16_f32 v76, v144, v145
v_cvt_pk_bf16_f32 v77, v146, v147
v_cvt_pk_bf16_f32 v78, v148, v149
v_cvt_pk_bf16_f32 v79, v150, v151
v_accvgpr_read_b32 v136, a136
v_accvgpr_read_b32 v137, a137
v_accvgpr_read_b32 v138, a138
v_accvgpr_read_b32 v139, a139
v_accvgpr_read_b32 v140, a140
v_accvgpr_read_b32 v141, a141
v_accvgpr_read_b32 v142, a142
v_accvgpr_read_b32 v143, a143
v_pk_mul_f32 v[136:137], v[136:137], v[248:249]
v_pk_mul_f32 v[138:139], v[138:139], v[248:249]
v_pk_mul_f32 v[140:141], v[140:141], v[248:249]
v_pk_mul_f32 v[142:143], v[142:143], v[248:249]
v_cvt_pk_bf16_f32 v80, v136, v137
v_cvt_pk_bf16_f32 v81, v138, v139
v_cvt_pk_bf16_f32 v82, v140, v141
v_cvt_pk_bf16_f32 v83, v142, v143
v_accvgpr_read_b32 v144, a168
v_accvgpr_read_b32 v145, a169
v_accvgpr_read_b32 v146, a170
v_accvgpr_read_b32 v147, a171
v_accvgpr_read_b32 v148, a172
v_accvgpr_read_b32 v149, a173
v_accvgpr_read_b32 v150, a174
v_accvgpr_read_b32 v151, a175
v_pk_mul_f32 v[144:145], v[144:145], v[252:253]
v_pk_mul_f32 v[146:147], v[146:147], v[252:253]
v_pk_mul_f32 v[148:149], v[148:149], v[252:253]
v_pk_mul_f32 v[150:151], v[150:151], v[252:253]
v_cvt_pk_bf16_f32 v84, v144, v145
v_cvt_pk_bf16_f32 v85, v146, v147
v_cvt_pk_bf16_f32 v86, v148, v149
v_cvt_pk_bf16_f32 v87, v150, v151
s_waitcnt lgkmcnt(15)
v_mfma_f32_16x16x32_bf16 v[136:139], a[192:195], v[40:43], 0
v_accvgpr_read_b32 v16, a16
v_accvgpr_read_b32 v17, a17
v_accvgpr_read_b32 v20, a18
v_mfma_f32_16x16x32_bf16 v[140:143], a[192:195], v[44:47], 0
s_movk_i32 s52, 6144
v_accvgpr_read_b32 v21, a19
v_accvgpr_read_b32 v35, a20
v_accvgpr_read_b32 v36, a21
v_mfma_f32_16x16x32_bf16 v[144:147], a[192:195], v[48:51], 0
buffer_store_dwordx4 v[64:67], v32, s[16:19], s52 offen offset:0 sc1
v_mfma_f32_16x16x32_bf16 v[148:151], a[192:195], v[52:55], 0
v_accvgpr_read_b32 v37, a22
v_accvgpr_read_b32 v38, a23
v_mul_f32 v16, v16, v26
v_mfma_f32_16x16x32_bf16 v[152:155], a[192:195], v[56:59], 0
s_waitcnt vmcnt(1) lgkmcnt(0)
v_mfma_f32_16x16x32_bf16 v[156:159], a[192:195], v[60:63], 0
s_barrier
s_cmp_lg_u32 s20, 1
s_cbranch_scc1 L_sg0
s_mov_b64 exec, 1
buffer_atomic_add v15, v14, s[8:11], s99 offen
buffer_atomic_add v15, v14, s[36:39], s41 offen
s_mov_b64 exec, -1
L_sg0:
v_mfma_f32_16x16x32_bf16 v[160:163], a[196:199], v[40:43], 0
ds_read_b64_tr_b16 a[192:193], v10 offset:16384
ds_read_b64_tr_b16 a[194:195], v10 offset:24576
v_mfma_f32_16x16x32_bf16 v[164:167], a[196:199], v[44:47], 0
s_add_u32 s53, s62, s97
s_lshr_b64 s[62:63], s[62:63], 4
v_mfma_f32_16x16x32_bf16 v[168:171], a[196:199], v[48:51], 0
s_bfe_u32 s32, s53, 0x20002
s_and_b32 s33, s53, 3
v_mfma_f32_16x16x32_bf16 v[172:175], a[196:199], v[52:55], 0
s_lshl_b32 s34, s32, 3
s_add_u32 s34, s34, s33
v_mfma_f32_16x16x32_bf16 v[176:179], a[196:199], v[56:59], 0
s_mul_i32 s96, s34, 40960
s_lshl_b32 s32, s32, 4
v_mfma_f32_16x16x32_bf16 v[180:183], a[196:199], v[60:63], 0
ds_read_b64_tr_b16 a[196:197], v11 offset:16384
ds_read_b64_tr_b16 a[198:199], v11 offset:24576
v_mfma_f32_16x16x32_bf16 v[184:187], a[200:203], v[40:43], 0
s_add_u32 s32, s32, s33
s_mul_i32 s88, s32, 6144
v_mfma_f32_16x16x32_bf16 v[188:191], a[200:203], v[44:47], 0
s_add_u32 m0, s54, 0
v_mul_f32 v17, v17, v26
v_mul_f32 v20, v20, v26
v_mul_f32 v21, v21, v26
v_mfma_f32_16x16x32_bf16 v[192:195], a[200:203], v[48:51], 0
s_add_u32 s55, s96, 0
v_mul_f32 v35, v35, v26
v_mul_f32 v36, v36, v26
v_mul_f32 v37, v37, v26
v_mfma_f32_16x16x32_bf16 v[196:199], a[200:203], v[52:55], 0
buffer_load_dwordx4 v5, s[92:95], s55 offen offset:0  lds
v_mfma_f32_16x16x32_bf16 v[200:203], a[200:203], v[56:59], 0
v_mul_f32 v38, v38, v26
v_cvt_pk_bf16_f32 v88, v16, v17
v_cvt_pk_bf16_f32 v89, v20, v21
v_mfma_f32_16x16x32_bf16 v[204:207], a[200:203], v[60:63], 0
ds_read_b64_tr_b16 a[200:201], v10 offset:16448
ds_read_b64_tr_b16 a[202:203], v10 offset:24640
v_mfma_f32_16x16x32_bf16 v[208:211], a[204:207], v[40:43], 0
v_cvt_pk_bf16_f32 v90, v35, v36
v_cvt_pk_bf16_f32 v91, v37, v38
v_accvgpr_read_b32 v16, a48
v_mfma_f32_16x16x32_bf16 v[212:215], a[204:207], v[44:47], 0
v_accvgpr_read_b32 v17, a49
v_accvgpr_read_b32 v20, a50
v_accvgpr_read_b32 v21, a51
v_mfma_f32_16x16x32_bf16 v[216:219], a[204:207], v[48:51], 0
buffer_store_dwordx4 v[68:71], v32, s[16:19], s52 offen offset:1024 sc1
v_mfma_f32_16x16x32_bf16 v[220:223], a[204:207], v[52:55], 0
v_accvgpr_read_b32 v35, a52
v_accvgpr_read_b32 v36, a53
v_accvgpr_read_b32 v37, a54
v_mfma_f32_16x16x32_bf16 v[224:227], a[204:207], v[56:59], 0
v_accvgpr_read_b32 v38, a55
v_mul_f32 v16, v16, v27
v_mul_f32 v17, v17, v27
v_mfma_f32_16x16x32_bf16 v[228:231], a[204:207], v[60:63], 0
ds_read_b64_tr_b16 a[204:205], v11 offset:16448
ds_read_b64_tr_b16 a[206:207], v11 offset:24640
v_mfma_f32_16x16x32_bf16 v[232:235], a[208:211], v[40:43], 0
buffer_load_dwordx4 v6, s[92:95], s55 offen offset:1024  lds
v_mfma_f32_16x16x32_bf16 v[236:239], a[208:211], v[44:47], 0
v_mul_f32 v20, v20, v27
v_mul_f32 v21, v21, v27
v_mul_f32 v35, v35, v27
v_mfma_f32_16x16x32_bf16 v[240:243], a[208:211], v[48:51], 0
v_mul_f32 v36, v36, v27
v_mul_f32 v37, v37, v27
v_mul_f32 v38, v38, v27
v_mfma_f32_16x16x32_bf16 v[244:247], a[208:211], v[52:55], 0
v_cvt_pk_bf16_f32 v92, v16, v17
v_cvt_pk_bf16_f32 v93, v20, v21
v_cvt_pk_bf16_f32 v94, v35, v36
v_mfma_f32_16x16x32_bf16 v[248:251], a[208:211], v[56:59], 0
v_cvt_pk_bf16_f32 v95, v37, v38
v_accvgpr_read_b32 v16, a80
v_accvgpr_read_b32 v17, a81
v_mfma_f32_16x16x32_bf16 v[252:255], a[208:211], v[60:63], 0
ds_read_b64_tr_b16 a[208:209], v10 offset:16512
ds_read_b64_tr_b16 a[210:211], v10 offset:24704
v_mfma_f32_16x16x32_bf16 a[0:3], a[212:215], v[40:43], 0
v_accvgpr_read_b32 v20, a82
v_accvgpr_read_b32 v21, a83
v_accvgpr_read_b32 v35, a84
v_mfma_f32_16x16x32_bf16 a[4:7], a[212:215], v[44:47], 0
buffer_load_dwordx4 v7, s[92:95], s55 offen offset:2048  lds
v_mfma_f32_16x16x32_bf16 a[8:11], a[212:215], v[48:51], 0
v_accvgpr_read_b32 v36, a85
v_accvgpr_read_b32 v37, a86
v_accvgpr_read_b32 v38, a87
v_mfma_f32_16x16x32_bf16 a[12:15], a[212:215], v[52:55], 0
v_mul_f32 v16, v16, v28
v_mul_f32 v17, v17, v28
v_mfma_f32_16x16x32_bf16 a[32:35], a[212:215], v[56:59], 0
v_mul_f32 v20, v20, v28
v_mul_f32 v21, v21, v28
v_mfma_f32_16x16x32_bf16 a[36:39], a[212:215], v[60:63], 0
ds_read_b64_tr_b16 a[212:213], v12 offset:16384
ds_read_b64_tr_b16 a[214:215], v12 offset:24576
v_mfma_f32_16x16x32_bf16 a[40:43], a[216:219], v[40:43], 0
v_mul_f32 v35, v35, v28
v_mul_f32 v36, v36, v28
v_mfma_f32_16x16x32_bf16 a[44:47], a[216:219], v[44:47], 0
v_mul_f32 v37, v37, v28
v_mul_f32 v38, v38, v28
v_mfma_f32_16x16x32_bf16 a[64:67], a[216:219], v[48:51], 0
buffer_load_dwordx4 v8, s[92:95], s55 offen offset:3072  lds
v_mfma_f32_16x16x32_bf16 a[68:71], a[216:219], v[52:55], 0
buffer_store_dwordx4 v[72:75], v32, s[16:19], s52 offen offset:2048 sc1
v_mfma_f32_16x16x32_bf16 a[72:75], a[216:219], v[56:59], 0
v_cvt_pk_bf16_f32 v96, v16, v17
v_cvt_pk_bf16_f32 v97, v20, v21
v_mfma_f32_16x16x32_bf16 a[76:79], a[216:219], v[60:63], 0
ds_read_b64_tr_b16 a[216:217], v13 offset:16384
ds_read_b64_tr_b16 a[218:219], v13 offset:24576
v_mfma_f32_16x16x32_bf16 a[96:99], a[220:223], v[40:43], 0
v_cvt_pk_bf16_f32 v98, v35, v36
v_cvt_pk_bf16_f32 v99, v37, v38
v_mfma_f32_16x16x32_bf16 a[100:103], a[220:223], v[44:47], 0
v_accvgpr_read_b32 v16, a112
v_accvgpr_read_b32 v17, a113
v_mfma_f32_16x16x32_bf16 a[104:107], a[220:223], v[48:51], 0
v_accvgpr_read_b32 v20, a114
v_accvgpr_read_b32 v21, a115
v_mfma_f32_16x16x32_bf16 a[108:111], a[220:223], v[52:55], 0
v_accvgpr_read_b32 v35, a116
v_accvgpr_read_b32 v36, a117
v_mfma_f32_16x16x32_bf16 a[128:131], a[220:223], v[56:59], 0
s_add_u32 m0, s54, 4096
v_accvgpr_read_b32 v37, a118
v_accvgpr_read_b32 v38, a119
v_mfma_f32_16x16x32_bf16 a[132:135], a[220:223], v[60:63], 0
ds_read_b64_tr_b16 a[220:221], v12 offset:16448
ds_read_b64_tr_b16 a[222:223], v12 offset:24640
v_mfma_f32_16x16x32_bf16 a[136:139], a[224:227], v[40:43], 0
s_nop 0
v_mul_f32 v16, v16, v29
v_mul_f32 v17, v17, v29
v_mfma_f32_16x16x32_bf16 a[140:143], a[224:227], v[44:47], 0
buffer_load_dwordx4 v9, s[92:95], s55 offen offset:0  lds
v_mfma_f32_16x16x32_bf16 a[160:163], a[224:227], v[48:51], 0
v_mul_f32 v20, v20, v29
v_mul_f32 v21, v21, v29
v_mfma_f32_16x16x32_bf16 a[164:167], a[224:227], v[52:55], 0
v_mul_f32 v35, v35, v29
v_mul_f32 v36, v36, v29
v_mfma_f32_16x16x32_bf16 a[168:171], a[224:227], v[56:59], 0
v_mul_f32 v37, v37, v29
v_mul_f32 v38, v38, v29
v_mfma_f32_16x16x32_bf16 a[172:175], a[224:227], v[60:63], 0
ds_read_b64_tr_b16 a[224:225], v13 offset:16448
ds_read_b64_tr_b16 a[226:227], v13 offset:24640
v_mfma_f32_16x16x32_bf16 a[232:235], a[228:231], v[40:43], 0
v_cvt_pk_bf16_f32 v100, v16, v17
v_cvt_pk_bf16_f32 v101, v20, v21
v_mfma_f32_16x16x32_bf16 a[236:239], a[228:231], v[44:47], 0
v_cvt_pk_bf16_f32 v102, v35, v36
v_cvt_pk_bf16_f32 v103, v37, v38
v_mfma_f32_16x16x32_bf16 a[240:243], a[228:231], v[48:51], 0
v_accvgpr_read_b32 v16, a144
v_accvgpr_read_b32 v17, a145
v_mfma_f32_16x16x32_bf16 a[244:247], a[228:231], v[52:55], 0
v_accvgpr_read_b32 v20, a146
v_accvgpr_read_b32 v21, a147
v_mfma_f32_16x16x32_bf16 a[248:251], a[228:231], v[56:59], 0
v_mfma_f32_16x16x32_bf16 a[252:255], a[228:231], v[60:63], 0
ds_read_b64_tr_b16 a[228:229], v12 offset:16512
ds_read_b64_tr_b16 a[230:231], v12 offset:24704
s_waitcnt lgkmcnt(15)
v_mfma_f32_16x16x32_bf16 v[136:139], a[192:195], v[64:67], v[136:139]
v_accvgpr_read_b32 v35, a148
v_accvgpr_read_b32 v36, a149
v_accvgpr_read_b32 v37, a150
v_mfma_f32_16x16x32_bf16 v[140:143], a[192:195], v[68:71], v[140:143]
v_accvgpr_read_b32 v38, a151
v_mul_f32 v16, v16, v30
v_mul_f32 v17, v17, v30
v_mfma_f32_16x16x32_bf16 v[144:147], a[192:195], v[72:75], v[144:147]
buffer_store_dwordx4 v[76:79], v32, s[16:19], s52 offen offset:3072 sc1
v_mfma_f32_16x16x32_bf16 v[148:151], a[192:195], v[76:79], v[148:151]
v_mul_f32 v20, v20, v30
v_mul_f32 v21, v21, v30
v_mul_f32 v35, v35, v30
v_mfma_f32_16x16x32_bf16 v[152:155], a[192:195], v[80:83], v[152:155]
s_waitcnt vmcnt(20) lgkmcnt(0)
v_mfma_f32_16x16x32_bf16 v[156:159], a[192:195], v[84:87], v[156:159]
s_barrier
v_mfma_f32_16x16x32_bf16 v[160:163], a[196:199], v[64:67], v[160:163]
ds_read_b64_tr_b16 a[192:193], v10 offset:32768
ds_read_b64_tr_b16 a[194:195], v10 offset:40960
v_mfma_f32_16x16x32_bf16 v[164:167], a[196:199], v[68:71], v[164:167]
s_add_u32 s53, s62, s97
s_lshr_b64 s[62:63], s[62:63], 4
v_mfma_f32_16x16x32_bf16 v[168:171], a[196:199], v[72:75], v[168:171]
s_bfe_u32 s32, s53, 0x20002
s_and_b32 s33, s53, 3
v_mfma_f32_16x16x32_bf16 v[172:175], a[196:199], v[76:79], v[172:175]
s_lshl_b32 s34, s32, 3
s_add_u32 s34, s34, s33
v_mfma_f32_16x16x32_bf16 v[176:179], a[196:199], v[80:83], v[176:179]
s_mul_i32 s96, s34, 40960
s_lshl_b32 s32, s32, 4
v_mfma_f32_16x16x32_bf16 v[180:183], a[196:199], v[84:87], v[180:183]
ds_read_b64_tr_b16 a[196:197], v11 offset:32768
ds_read_b64_tr_b16 a[198:199], v11 offset:40960
v_mfma_f32_16x16x32_bf16 v[184:187], a[200:203], v[64:67], v[184:187]
s_add_u32 s32, s32, s33
s_mul_i32 s89, s32, 6144
v_mfma_f32_16x16x32_bf16 v[188:191], a[200:203], v[68:71], v[188:191]
s_add_u32 m0, s54, 16384
v_mul_f32 v36, v36, v30
v_mul_f32 v37, v37, v30
v_mul_f32 v38, v38, v30
v_mfma_f32_16x16x32_bf16 v[192:195], a[200:203], v[72:75], v[192:195]
s_add_u32 s55, s96, 0
v_cvt_pk_bf16_f32 v104, v16, v17
v_cvt_pk_bf16_f32 v105, v20, v21
v_cvt_pk_bf16_f32 v106, v35, v36
v_mfma_f32_16x16x32_bf16 v[196:199], a[200:203], v[76:79], v[196:199]
buffer_load_dwordx4 v5, s[92:95], s55 offen offset:0  lds
v_mfma_f32_16x16x32_bf16 v[200:203], a[200:203], v[80:83], v[200:203]
v_cvt_pk_bf16_f32 v107, v37, v38
v_accvgpr_read_b32 v16, a176
v_accvgpr_read_b32 v17, a177
v_mfma_f32_16x16x32_bf16 v[204:207], a[200:203], v[84:87], v[204:207]
ds_read_b64_tr_b16 a[200:201], v10 offset:32832
ds_read_b64_tr_b16 a[202:203], v10 offset:41024
v_mfma_f32_16x16x32_bf16 v[208:211], a[204:207], v[64:67], v[208:211]
v_accvgpr_read_b32 v20, a178
v_accvgpr_read_b32 v21, a179
v_accvgpr_read_b32 v35, a180
v_mfma_f32_16x16x32_bf16 v[212:215], a[204:207], v[68:71], v[212:215]
v_accvgpr_read_b32 v36, a181
v_accvgpr_read_b32 v37, a182
v_accvgpr_read_b32 v38, a183
v_mfma_f32_16x16x32_bf16 v[216:219], a[204:207], v[72:75], v[216:219]
buffer_store_dwordx4 v[80:83], v33, s[16:19], s52 offen offset:0 sc1
v_mfma_f32_16x16x32_bf16 v[220:223], a[204:207], v[76:79], v[220:223]
buffer_load_dword v19, v14, s[8:11], s99 offen sc1
v_mfma_f32_16x16x32_bf16 v[224:227], a[204:207], v[80:83], v[224:227]
v_mul_f32 v16, v16, v31
v_mul_f32 v17, v17, v31
v_mul_f32 v20, v20, v31
v_mfma_f32_16x16x32_bf16 v[228:231], a[204:207], v[84:87], v[228:231]
ds_read_b64_tr_b16 a[204:205], v11 offset:32832
ds_read_b64_tr_b16 a[206:207], v11 offset:41024
v_mfma_f32_16x16x32_bf16 v[232:235], a[208:211], v[64:67], v[232:235]
v_mul_f32 v21, v21, v31
v_mul_f32 v35, v35, v31
v_mul_f32 v36, v36, v31
v_mfma_f32_16x16x32_bf16 v[236:239], a[208:211], v[68:71], v[236:239]
buffer_load_dwordx4 v6, s[92:95], s55 offen offset:1024  lds
v_mfma_f32_16x16x32_bf16 v[240:243], a[208:211], v[72:75], v[240:243]
v_mul_f32 v37, v37, v31
v_mul_f32 v38, v38, v31
v_cvt_pk_bf16_f32 v108, v16, v17
v_mfma_f32_16x16x32_bf16 v[244:247], a[208:211], v[76:79], v[244:247]
v_cvt_pk_bf16_f32 v109, v20, v21
v_cvt_pk_bf16_f32 v110, v35, v36
v_cvt_pk_bf16_f32 v111, v37, v38
v_mfma_f32_16x16x32_bf16 v[248:251], a[208:211], v[80:83], v[248:251]
v_accvgpr_read_b32 v16, a24
v_accvgpr_read_b32 v17, a25
v_accvgpr_read_b32 v20, a26
v_mfma_f32_16x16x32_bf16 v[252:255], a[208:211], v[84:87], v[252:255]
ds_read_b64_tr_b16 a[208:209], v10 offset:32896
ds_read_b64_tr_b16 a[210:211], v10 offset:41088
v_mfma_f32_16x16x32_bf16 a[0:3], a[212:215], v[64:67], a[0:3]
v_accvgpr_read_b32 v21, a27
v_accvgpr_read_b32 v35, a28
v_accvgpr_read_b32 v36, a29
v_mfma_f32_16x16x32_bf16 a[4:7], a[212:215], v[68:71], a[4:7]
v_accvgpr_read_b32 v37, a30
v_accvgpr_read_b32 v38, a31
v_mul_f32 v16, v16, v26
v_mfma_f32_16x16x32_bf16 a[8:11], a[212:215], v[72:75], a[8:11]
buffer_load_dwordx4 v7, s[92:95], s55 offen offset:2048  lds
v_mfma_f32_16x16x32_bf16 a[12:15], a[212:215], v[76:79], a[12:15]
v_mul_f32 v17, v17, v26
v_mul_f32 v20, v20, v26
v_mul_f32 v21, v21, v26
v_mfma_f32_16x16x32_bf16 a[32:35], a[212:215], v[80:83], a[32:35]
v_mul_f32 v35, v35, v26
v_mul_f32 v36, v36, v26
v_mul_f32 v37, v37, v26
v_mfma_f32_16x16x32_bf16 a[36:39], a[212:215], v[84:87], a[36:39]
ds_read_b64_tr_b16 a[212:213], v12 offset:32768
ds_read_b64_tr_b16 a[214:215], v12 offset:40960
v_mfma_f32_16x16x32_bf16 a[40:43], a[216:219], v[64:67], a[40:43]
v_mul_f32 v38, v38, v26
v_cvt_pk_bf16_f32 v112, v16, v17
v_cvt_pk_bf16_f32 v113, v20, v21
v_mfma_f32_16x16x32_bf16 a[44:47], a[216:219], v[68:71], a[44:47]
v_cvt_pk_bf16_f32 v114, v35, v36
v_cvt_pk_bf16_f32 v115, v37, v38
v_mfma_f32_16x16x32_bf16 a[64:67], a[216:219], v[72:75], a[64:67]
v_accvgpr_read_b32 v16, a56
v_accvgpr_read_b32 v17, a57
v_mfma_f32_16x16x32_bf16 a[68:71], a[216:219], v[76:79], a[68:71]
buffer_store_dwordx4 v[84:87], v33, s[16:19], s52 offen offset:1024 sc1
v_mfma_f32_16x16x32_bf16 a[72:75], a[216:219], v[80:83], a[72:75]
buffer_load_dwordx4 v8, s[92:95], s55 offen offset:3072  lds
v_mfma_f32_16x16x32_bf16 a[76:79], a[216:219], v[84:87], a[76:79]
ds_read_b64_tr_b16 a[216:217], v13 offset:32768
ds_read_b64_tr_b16 a[218:219], v13 offset:40960
v_mfma_f32_16x16x32_bf16 a[96:99], a[220:223], v[64:67], a[96:99]
v_accvgpr_read_b32 v20, a58
v_accvgpr_read_b32 v21, a59
v_mfma_f32_16x16x32_bf16 a[100:103], a[220:223], v[68:71], a[100:103]
v_accvgpr_read_b32 v35, a60
v_accvgpr_read_b32 v36, a61
v_mfma_f32_16x16x32_bf16 a[104:107], a[220:223], v[72:75], a[104:107]
v_accvgpr_read_b32 v37, a62
v_accvgpr_read_b32 v38, a63
v_mfma_f32_16x16x32_bf16 a[108:111], a[220:223], v[76:79], a[108:111]
v_mul_f32 v16, v16, v27
v_mul_f32 v17, v17, v27
v_mfma_f32_16x16x32_bf16 a[128:131], a[220:223], v[80:83], a[128:131]
v_mul_f32 v20, v20, v27
v_mul_f32 v21, v21, v27
v_mfma_f32_16x16x32_bf16 a[132:135], a[220:223], v[84:87], a[132:135]
ds_read_b64_tr_b16 a[220:221], v12 offset:32832
ds_read_b64_tr_b16 a[222:223], v12 offset:41024
v_mfma_f32_16x16x32_bf16 a[136:139], a[224:227], v[64:67], a[136:139]
s_add_u32 m0, s54, 20480
v_mul_f32 v35, v35, v27
v_mul_f32 v36, v36, v27
v_mfma_f32_16x16x32_bf16 a[140:143], a[224:227], v[68:71], a[140:143]
s_nop 0
v_mul_f32 v37, v37, v27
v_mul_f32 v38, v38, v27
v_mfma_f32_16x16x32_bf16 a[160:163], a[224:227], v[72:75], a[160:163]
buffer_load_dwordx4 v9, s[92:95], s55 offen offset:0  lds
v_mfma_f32_16x16x32_bf16 a[164:167], a[224:227], v[76:79], a[164:167]
v_cvt_pk_bf16_f32 v116, v16, v17
v_cvt_pk_bf16_f32 v117, v20, v21
v_mfma_f32_16x16x32_bf16 a[168:171], a[224:227], v[80:83], a[168:171]
v_cvt_pk_bf16_f32 v118, v35, v36
v_cvt_pk_bf16_f32 v119, v37, v38
v_mfma_f32_16x16x32_bf16 a[172:175], a[224:227], v[84:87], a[172:175]
ds_read_b64_tr_b16 a[224:225], v13 offset:32832
ds_read_b64_tr_b16 a[226:227], v13 offset:41024
v_mfma_f32_16x16x32_bf16 a[232:235], a[228:231], v[64:67], a[232:235]
v_accvgpr_read_b32 v16, a88
v_accvgpr_read_b32 v17, a89
v_mfma_f32_16x16x32_bf16 a[236:239], a[228:231], v[68:71], a[236:239]
v_accvgpr_read_b32 v20, a90
v_accvgpr_read_b32 v21, a91
v_mfma_f32_16x16x32_bf16 a[240:243], a[228:231], v[72:75], a[240:243]
v_accvgpr_read_b32 v35, a92
v_accvgpr_read_b32 v36, a93
v_mfma_f32_16x16x32_bf16 a[244:247], a[228:231], v[76:79], a[244:247]
v_accvgpr_read_b32 v37, a94
v_accvgpr_read_b32 v38, a95
v_mfma_f32_16x16x32_bf16 a[248:251], a[228:231], v[80:83], a[248:251]
v_mfma_f32_16x16x32_bf16 a[252:255], a[228:231], v[84:87], a[252:255]
ds_read_b64_tr_b16 a[228:229], v12 offset:32896
ds_read_b64_tr_b16 a[230:231], v12 offset:41088
s_waitcnt lgkmcnt(15)
v_mfma_f32_16x16x32_bf16 v[136:139], a[192:195], v[88:91], v[136:139]
v_mul_f32 v16, v16, v28
v_mul_f32 v17, v17, v28
v_mul_f32 v20, v20, v28
v_mfma_f32_16x16x32_bf16 v[140:143], a[192:195], v[92:95], v[140:143]
s_movk_i32 s52, 12288
v_mul_f32 v21, v21, v28
v_mul_f32 v35, v35, v28
v_mul_f32 v36, v36, v28
v_mfma_f32_16x16x32_bf16 v[144:147], a[192:195], v[96:99], v[144:147]
buffer_store_dwordx4 v[88:91], v32, s[16:19], s52 offen offset:0 sc1
v_mfma_f32_16x16x32_bf16 v[148:151], a[192:195], v[100:103], v[148:151]
v_mul_f32 v37, v37, v28
v_mul_f32 v38, v38, v28
v_cvt_pk_bf16_f32 v120, v16, v17
v_mfma_f32_16x16x32_bf16 v[152:155], a[192:195], v[104:107], v[152:155]
s_waitcnt vmcnt(6) lgkmcnt(0)
v_mfma_f32_16x16x32_bf16 v[156:159], a[192:195], v[108:111], v[156:159]
v_readfirstlane_b32 s98, v19
s_nop 0
s_sub_u32 s98, s98, s56
s_cmp_lg_u32 s20, 0
s_cbranch_scc1 L_pd1
s_bfe_u32 s34, s98, 0x40000
s_cmp_eq_u32 s34, 4
s_cbranch_scc1 L_pd1
s_mov_b32 s61, 0x40000
L_pl1:
buffer_load_dword v19, v14, s[8:11], s99 offen sc1
s_waitcnt vmcnt(0)
v_readfirstlane_b32 s98, v19
s_sub_u32 s61, s61, 1
s_sub_u32 s98, s98, s56
s_bfe_u32 s34, s98, 0x40000
s_cmp_eq_u32 s34, 4
s_cbranch_scc1 L_pd1
s_sleep 2
s_and_b32 s34, s61, 63
s_cbranch_scc1 L_pl1
buffer_load_dword v19, v14, s[36:39], s41 offen sc1
s_waitcnt vmcnt(0)
v_readfirstlane_b32 s34, v19
s_cmp_eq_u32 s61, 0
s_cbranch_scc1 L_pd1
s_bfe_u32 s34, s34, 0x40000
s_cmp_lt_u32 s34, 4
s_cbranch_scc1 L_pl1
L_pd1:
s_barrier
v_mfma_f32_16x16x32_bf16 v[160:163], a[196:199], v[88:91], v[160:163]
ds_read_b64_tr_b16 a[192:193], v10 offset:49152
ds_read_b64_tr_b16 a[194:195], v10 offset:57344
v_mfma_f32_16x16x32_bf16 v[164:167], a[196:199], v[92:95], v[164:167]
buffer_load_dwordx4 v[40:43], v32, s[4:7], s88 offen offset:0 sc1
v_mfma_f32_16x16x32_bf16 v[168:171], a[196:199], v[96:99], v[168:171]
v_cvt_pk_bf16_f32 v121, v20, v21
v_cvt_pk_bf16_f32 v122, v35, v36
v_cvt_pk_bf16_f32 v123, v37, v38
v_mfma_f32_16x16x32_bf16 v[172:175], a[196:199], v[100:103], v[172:175]
buffer_load_dwordx4 v[44:47], v32, s[4:7], s88 offen offset:1024 sc1
v_mfma_f32_16x16x32_bf16 v[176:179], a[196:199], v[104:107], v[176:179]
v_accvgpr_read_b32 v16, a120
v_accvgpr_read_b32 v17, a121
v_accvgpr_read_b32 v20, a122
v_mfma_f32_16x16x32_bf16 v[180:183], a[196:199], v[108:111], v[180:183]
ds_read_b64_tr_b16 a[196:197], v11 offset:49152
ds_read_b64_tr_b16 a[198:199], v11 offset:57344
v_mfma_f32_16x16x32_bf16 v[184:187], a[200:203], v[88:91], v[184:187]
buffer_load_dwordx4 v[48:51], v32, s[4:7], s88 offen offset:2048 sc1
v_mfma_f32_16x16x32_bf16 v[188:191], a[200:203], v[92:95], v[188:191]
v_accvgpr_read_b32 v21, a123
v_accvgpr_read_b32 v35, a124
v_accvgpr_read_b32 v36, a125
v_mfma_f32_16x16x32_bf16 v[192:195], a[200:203], v[96:99], v[192:195]
buffer_load_dwordx4 v[52:55], v32, s[4:7], s88 offen offset:3072 sc1
v_mfma_f32_16x16x32_bf16 v[196:199], a[200:203], v[100:103], v[196:199]
v_accvgpr_read_b32 v37, a126
v_accvgpr_read_b32 v38, a127
v_mul_f32 v16, v16, v29
v_mfma_f32_16x16x32_bf16 v[200:203], a[200:203], v[104:107], v[200:203]
buffer_store_dwordx4 v[92:95], v32, s[16:19], s52 offen offset:1024 sc1
v_mfma_f32_16x16x32_bf16 v[204:207], a[200:203], v[108:111], v[204:207]
ds_read_b64_tr_b16 a[200:201], v10 offset:49216
ds_read_b64_tr_b16 a[202:203], v10 offset:57408
v_mfma_f32_16x16x32_bf16 v[208:211], a[204:207], v[88:91], v[208:211]
buffer_load_dwordx4 v[56:59], v33, s[4:7], s88 offen offset:0 sc1
v_mfma_f32_16x16x32_bf16 v[212:215], a[204:207], v[92:95], v[212:215]
v_mul_f32 v17, v17, v29
v_mul_f32 v20, v20, v29
v_mul_f32 v21, v21, v29
v_mfma_f32_16x16x32_bf16 v[216:219], a[204:207], v[96:99], v[216:219]
buffer_load_dwordx4 v[60:63], v33, s[4:7], s88 offen offset:1024 sc1
v_mfma_f32_16x16x32_bf16 v[220:223], a[204:207], v[100:103], v[220:223]
v_mul_f32 v35, v35, v29
v_mul_f32 v36, v36, v29
v_mul_f32 v37, v37, v29
v_mfma_f32_16x16x32_bf16 v[224:227], a[204:207], v[104:107], v[224:227]
s_add_u32 s53, s62, s97
s_lshr_b64 s[62:63], s[62:63], 4
v_mfma_f32_16x16x32_bf16 v[228:231], a[204:207], v[108:111], v[228:231]
ds_read_b64_tr_b16 a[204:205], v11 offset:49216
ds_read_b64_tr_b16 a[206:207], v11 offset:57408
v_mfma_f32_16x16x32_bf16 v[232:235], a[208:211], v[88:91], v[232:235]
s_bfe_u32 s32, s53, 0x20002
s_and_b32 s33, s53, 3
v_mfma_f32_16x16x32_bf16 v[236:239], a[208:211], v[92:95], v[236:239]
s_lshl_b32 s34, s32, 3
s_add_u32 s34, s34, s33
v_mfma_f32_16x16x32_bf16 v[240:243], a[208:211], v[96:99], v[240:243]
s_mul_i32 s96, s34, 40960
s_lshl_b32 s32, s32, 4
v_mfma_f32_16x16x32_bf16 v[244:247], a[208:211], v[100:103], v[244:247]
s_add_u32 s32, s32, s33
s_mul_i32 s90, s32, 6144
v_mfma_f32_16x16x32_bf16 v[248:251], a[208:211], v[104:107], v[248:251]
s_add_u32 m0, s54, 32768
v_mul_f32 v38, v38, v29
v_cvt_pk_bf16_f32 v124, v16, v17
v_cvt_pk_bf16_f32 v125, v20, v21
v_mfma_f32_16x16x32_bf16 v[252:255], a[208:211], v[108:111], v[252:255]
ds_read_b64_tr_b16 a[208:209], v10 offset:49280
ds_read_b64_tr_b16 a[210:211], v10 offset:57472
v_mfma_f32_16x16x32_bf16 a[0:3], a[212:215], v[88:91], a[0:3]
s_add_u32 s55, s96, 0
v_cvt_pk_bf16_f32 v126, v35, v36
v_cvt_pk_bf16_f32 v127, v37, v38
v_accvgpr_read_b32 v16, a152
v_mfma_f32_16x16x32_bf16 a[4:7], a[212:215], v[92:95], a[4:7]
buffer_store_dwordx4 v[96:99], v32, s[16:19], s52 offen offset:2048 sc1
v_mfma_f32_16x16x32_bf16 a[8:11], a[212:215], v[96:99], a[8:11]
buffer_load_dwordx4 v5, s[92:95], s55 offen offset:0  lds
v_mfma_f32_16x16x32_bf16 a[12:15], a[212:215], v[100:103], a[12:15]
v_accvgpr_read_b32 v17, a153
v_accvgpr_read_b32 v20, a154
v_accvgpr_read_b32 v21, a155
v_mfma_f32_16x16x32_bf16 a[32:35], a[212:215], v[104:107], a[32:35]
buffer_load_dwordx4 v6, s[92:95], s55 offen offset:1024  lds
v_mfma_f32_16x16x32_bf16 a[36:39], a[212:215], v[108:111], a[36:39]
ds_read_b64_tr_b16 a[212:213], v12 offset:49152
ds_read_b64_tr_b16 a[214:215], v12 offset:57344
v_mfma_f32_16x16x32_bf16 a[40:43], a[216:219], v[88:91], a[40:43]
v_accvgpr_read_b32 v35, a156
v_accvgpr_read_b32 v36, a157
v_accvgpr_read_b32 v37, a158
v_mfma_f32_16x16x32_bf16 a[44:47], a[216:219], v[92:95], a[44:47]
buffer_load_dwordx4 v7, s[92:95], s55 offen offset:2048  lds
v_mfma_f32_16x16x32_bf16 a[64:67], a[216:219], v[96:99], a[64:67]
v_accvgpr_read_b32 v38, a159
v_mul_f32 v16, v16, v30
v_mul_f32 v17, v17, v30
v_mfma_f32_16x16x32_bf16 a[68:71], a[216:219], v[100:103], a[68:71]
buffer_load_dwordx4 v8, s[92:95], s55 offen offset:3072  lds
v_mfma_f32_16x16x32_bf16 a[72:75], a[216:219], v[104:107], a[72:75]
v_mul_f32 v20, v20, v30
v_mul_f32 v21, v21, v30
v_mul_f32 v35, v35, v30
v_mfma_f32_16x16x32_bf16 a[76:79], a[216:219], v[108:111], a[76:79]
ds_read_b64_tr_b16 a[216:217], v13 offset:49152
ds_read_b64_tr_b16 a[218:219], v13 offset:57344
v_mfma_f32_16x16x32_bf16 a[96:99], a[220:223], v[88:91], a[96:99]
s_add_u32 m0, s54, 36864
v_mul_f32 v36, v36, v30
v_mul_f32 v37, v37, v30
v_mul_f32 v38, v38, v30
v_mfma_f32_16x16x32_bf16 a[100:103], a[220:223], v[92:95], a[100:103]
s_nop 0
v_cvt_pk_bf16_f32 v128, v16, v17
v_cvt_pk_bf16_f32 v129, v20, v21
v_cvt_pk_bf16_f32 v130, v35, v36
v_mfma_f32_16x16x32_bf16 a[104:107], a[220:223], v[96:99], a[104:107]
buffer_store_dwordx4 v[100:103], v32, s[16:19], s52 offen offset:3072 sc1
v_mfma_f32_16x16x32_bf16 a[108:111], a[220:223], v[100:103], a[108:111]
buffer_load_dwordx4 v9, s[92:95], s55 offen offset:0  lds
v_mfma_f32_16x16x32_bf16 a[128:131], a[220:223], v[104:107], a[128:131]
v_cvt_pk_bf16_f32 v131, v37, v38
v_accvgpr_read_b32 v16, a184
v_accvgpr_read_b32 v17, a185
v_mfma_f32_16x16x32_bf16 a[132:135], a[220:223], v[108:111], a[132:135]
ds_read_b64_tr_b16 a[220:221], v12 offset:49216
ds_read_b64_tr_b16 a[222:223], v12 offset:57408
v_mfma_f32_16x16x32_bf16 a[136:139], a[224:227], v[88:91], a[136:139]
v_accvgpr_read_b32 v20, a186
v_accvgpr_read_b32 v21, a187
v_mfma_f32_16x16x32_bf16 a[140:143], a[224:227], v[92:95], a[140:143]
v_accvgpr_read_b32 v35, a188
v_accvgpr_read_b32 v36, a189
v_mfma_f32_16x16x32_bf16 a[160:163], a[224:227], v[96:99], a[160:163]
v_accvgpr_read_b32 v37, a190
v_accvgpr_read_b32 v38, a191
v_mfma_f32_16x16x32_bf16 a[164:167], a[224:227], v[100:103], a[164:167]
v_mul_f32 v16, v16, v31
v_mul_f32 v17, v17, v31
v_mfma_f32_16x16x32_bf16 a[168:171], a[224:227], v[104:107], a[168:171]
v_mul_f32 v20, v20, v31
v_mul_f32 v21, v21, v31
v_mfma_f32_16x16x32_bf16 a[172:175], a[224:227], v[108:111], a[172:175]
ds_read_b64_tr_b16 a[224:225], v13 offset:49216
ds_read_b64_tr_b16 a[226:227], v13 offset:57408
v_mfma_f32_16x16x32_bf16 a[232:235], a[228:231], v[88:91], a[232:235]
v_mul_f32 v35, v35, v31
v_mul_f32 v36, v36, v31
v_mfma_f32_16x16x32_bf16 a[236:239], a[228:231], v[92:95], a[236:239]
v_mul_f32 v37, v37, v31
v_mul_f32 v38, v38, v31
v_mfma_f32_16x16x32_bf16 a[240:243], a[228:231], v[96:99], a[240:243]
v_cvt_pk_bf16_f32 v132, v16, v17
v_cvt_pk_bf16_f32 v133, v20, v21
v_mfma_f32_16x16x32_bf16 a[244:247], a[228:231], v[100:103], a[244:247]
v_cvt_pk_bf16_f32 v134, v35, v36
v_cvt_pk_bf16_f32 v135, v37, v38
v_mfma_f32_16x16x32_bf16 a[248:251], a[228:231], v[104:107], a[248:251]
v_mfma_f32_16x16x32_bf16 a[252:255], a[228:231], v[108:111], a[252:255]
ds_read_b64_tr_b16 a[228:229], v12 offset:49280
ds_read_b64_tr_b16 a[230:231], v12 offset:57472
s_waitcnt lgkmcnt(15)
v_mfma_f32_16x16x32_bf16 v[136:139], a[192:195], v[112:115], v[136:139]
v_mfma_f32_16x16x32_bf16 v[140:143], a[192:195], v[116:119], v[140:143]
v_mfma_f32_16x16x32_bf16 v[144:147], a[192:195], v[120:123], v[144:147]
buffer_store_dwordx4 v[104:107], v33, s[16:19], s52 offen offset:0 sc1
v_mfma_f32_16x16x32_bf16 v[148:151], a[192:195], v[124:127], v[148:151]
v_mfma_f32_16x16x32_bf16 v[152:155], a[192:195], v[128:131], v[152:155]
s_waitcnt vmcnt(18) lgkmcnt(0)
v_mfma_f32_16x16x32_bf16 v[156:159], a[192:195], v[132:135], v[156:159]
s_barrier
s_cmp_lg_u32 s20, 1
s_cbranch_scc1 L_sg2
s_mov_b64 exec, 1
buffer_atomic_add v23, v14, s[8:11], s99 offen
buffer_atomic_add v23, v14, s[36:39], s41 offen
s_mov_b64 exec, -1
L_sg2:
v_mfma_f32_16x16x32_bf16 v[160:163], a[196:199], v[112:115], v[160:163]
ds_read_b64_tr_b16 a[192:193], v10 offset:0
ds_read_b64_tr_b16 a[194:195], v10 offset:8192
v_mfma_f32_16x16x32_bf16 v[164:167], a[196:199], v[116:119], v[164:167]
buffer_load_dwordx4 v[64:67], v32, s[4:7], s89 offen offset:0 sc1
v_mfma_f32_16x16x32_bf16 v[168:171], a[196:199], v[120:123], v[168:171]
v_mfma_f32_16x16x32_bf16 v[172:175], a[196:199], v[124:127], v[172:175]
buffer_load_dwordx4 v[68:71], v32, s[4:7], s89 offen offset:1024 sc1
v_mfma_f32_16x16x32_bf16 v[176:179], a[196:199], v[128:131], v[176:179]
v_mfma_f32_16x16x32_bf16 v[180:183], a[196:199], v[132:135], v[180:183]
ds_read_b64_tr_b16 a[196:197], v11 offset:0
ds_read_b64_tr_b16 a[198:199], v11 offset:8192
v_mfma_f32_16x16x32_bf16 v[184:187], a[200:203], v[112:115], v[184:187]
buffer_load_dwordx4 v[72:75], v32, s[4:7], s89 offen offset:2048 sc1
v_mfma_f32_16x16x32_bf16 v[188:191], a[200:203], v[116:119], v[188:191]
v_mfma_f32_16x16x32_bf16 v[192:195], a[200:203], v[120:123], v[192:195]
buffer_load_dwordx4 v[76:79], v32, s[4:7], s89 offen offset:3072 sc1
v_mfma_f32_16x16x32_bf16 v[196:199], a[200:203], v[124:127], v[196:199]
v_mfma_f32_16x16x32_bf16 v[200:203], a[200:203], v[128:131], v[200:203]
buffer_store_dwordx4 v[108:111], v33, s[16:19], s52 offen offset:1024 sc1
v_mfma_f32_16x16x32_bf16 v[204:207], a[200:203], v[132:135], v[204:207]
ds_read_b64_tr_b16 a[200:201], v10 offset:64
ds_read_b64_tr_b16 a[202:203], v10 offset:8256
v_mfma_f32_16x16x32_bf16 v[208:211], a[204:207], v[112:115], v[208:211]
buffer_load_dwordx4 v[80:83], v33, s[4:7], s89 offen offset:0 sc1
v_mfma_f32_16x16x32_bf16 v[212:215], a[204:207], v[116:119], v[212:215]
v_mfma_f32_16x16x32_bf16 v[216:219], a[204:207], v[120:123], v[216:219]
buffer_load_dwordx4 v[84:87], v33, s[4:7], s89 offen offset:1024 sc1
v_mfma_f32_16x16x32_bf16 v[220:223], a[204:207], v[124:127], v[220:223]
v_mfma_f32_16x16x32_bf16 v[224:227], a[204:207], v[128:131], v[224:227]
s_add_u32 s53, s62, s97
s_lshr_b64 s[62:63], s[62:63], 4
v_mfma_f32_16x16x32_bf16 v[228:231], a[204:207], v[132:135], v[228:231]
ds_read_b64_tr_b16 a[204:205], v11 offset:64
ds_read_b64_tr_b16 a[206:207], v11 offset:8256
v_mfma_f32_16x16x32_bf16 v[232:235], a[208:211], v[112:115], v[232:235]
s_bfe_u32 s32, s53, 0x20002
s_and_b32 s33, s53, 3
v_mfma_f32_16x16x32_bf16 v[236:239], a[208:211], v[116:119], v[236:239]
s_lshl_b32 s34, s32, 3
s_add_u32 s34, s34, s33
v_mfma_f32_16x16x32_bf16 v[240:243], a[208:211], v[120:123], v[240:243]
s_mul_i32 s96, s34, 40960
s_lshl_b32 s32, s32, 4
v_mfma_f32_16x16x32_bf16 v[244:247], a[208:211], v[124:127], v[244:247]
s_add_u32 s32, s32, s33
s_mul_i32 s91, s32, 6144
v_mfma_f32_16x16x32_bf16 v[248:251], a[208:211], v[128:131], v[248:251]
s_add_u32 m0, s54, 49152
v_mfma_f32_16x16x32_bf16 v[252:255], a[208:211], v[132:135], v[252:255]
ds_read_b64_tr_b16 a[208:209], v10 offset:128
ds_read_b64_tr_b16 a[210:211], v10 offset:8320
v_mfma_f32_16x16x32_bf16 a[0:3], a[212:215], v[112:115], a[0:3]
s_movk_i32 s52, 18432
v_mfma_f32_16x16x32_bf16 a[4:7], a[212:215], v[116:119], a[4:7]
buffer_store_dwordx4 v[112:115], v32, s[16:19], s52 offen offset:0 sc1
v_mfma_f32_16x16x32_bf16 a[8:11], a[212:215], v[120:123], a[8:11]
s_add_u32 s55, s96, 0
v_mfma_f32_16x16x32_bf16 a[12:15], a[212:215], v[124:127], a[12:15]
buffer_load_dwordx4 v5, s[92:95], s55 offen offset:0  lds
v_mfma_f32_16x16x32_bf16 a[32:35], a[212:215], v[128:131], a[32:35]
v_mfma_f32_16x16x32_bf16 a[36:39], a[212:215], v[132:135], a[36:39]
ds_read_b64_tr_b16 a[212:213], v12 offset:0
ds_read_b64_tr_b16 a[214:215], v12 offset:8192
v_mfma_f32_16x16x32_bf16 a[40:43], a[216:219], v[112:115], a[40:43]
buffer_load_dwordx4 v6, s[92:95], s55 offen offset:1024  lds
v_mfma_f32_16x16x32_bf16 a[44:47], a[216:219], v[116:119], a[44:47]
v_mfma_f32_16x16x32_bf16 a[64:67], a[216:219], v[120:123], a[64:67]
buffer_load_dwordx4 v7, s[92:95], s55 offen offset:2048  lds
v_mfma_f32_16x16x32_bf16 a[68:71], a[216:219], v[124:127], a[68:71]
v_mfma_f32_16x16x32_bf16 a[72:75], a[216:219], v[128:131], a[72:75]
buffer_load_dwordx4 v8, s[92:95], s55 offen offset:3072  lds
v_mfma_f32_16x16x32_bf16 a[76:79], a[216:219], v[132:135], a[76:79]
ds_read_b64_tr_b16 a[216:217], v13 offset:0
ds_read_b64_tr_b16 a[218:219], v13 offset:8192
v_mfma_f32_16x16x32_bf16 a[96:99], a[220:223], v[112:115], a[96:99]
v_mfma_f32_16x16x32_bf16 a[100:103], a[220:223], v[116:119], a[100:103]
s_add_u32 m0, s54, 53248
v_mfma_f32_16x16x32_bf16 a[104:107], a[220:223], v[120:123], a[104:107]
buffer_store_dwordx4 v[116:119], v32, s[16:19], s52 offen offset:1024 sc1
v_mfma_f32_16x16x32_bf16 a[108:111], a[220:223], v[124:127], a[108:111]
s_nop 0
v_mfma_f32_16x16x32_bf16 a[128:131], a[220:223], v[128:131], a[128:131]
buffer_load_dwordx4 v9, s[92:95], s55 offen offset:0  lds
v_mfma_f32_16x16x32_bf16 a[132:135], a[220:223], v[132:135], a[132:135]
ds_read_b64_tr_b16 a[220:221], v12 offset:64
ds_read_b64_tr_b16 a[222:223], v12 offset:8256
v_mfma_f32_16x16x32_bf16 a[136:139], a[224:227], v[112:115], a[136:139]
v_mfma_f32_16x16x32_bf16 a[140:143], a[224:227], v[116:119], a[140:143]
v_mfma_f32_16x16x32_bf16 a[160:163], a[224:227], v[120:123], a[160:163]
v_mfma_f32_16x16x32_bf16 a[164:167], a[224:227], v[124:127], a[164:167]
v_mfma_f32_16x16x32_bf16 a[168:171], a[224:227], v[128:131], a[168:171]
v_mfma_f32_16x16x32_bf16 a[172:175], a[224:227], v[132:135], a[172:175]
ds_read_b64_tr_b16 a[224:225], v13 offset:64
ds_read_b64_tr_b16 a[226:227], v13 offset:8256
v_mfma_f32_16x16x32_bf16 a[232:235], a[228:231], v[112:115], a[232:235]
v_mfma_f32_16x16x32_bf16 a[236:239], a[228:231], v[116:119], a[236:239]
v_mfma_f32_16x16x32_bf16 a[240:243], a[228:231], v[120:123], a[240:243]
v_mfma_f32_16x16x32_bf16 a[244:247], a[228:231], v[124:127], a[244:247]
v_mfma_f32_16x16x32_bf16 a[248:251], a[228:231], v[128:131], a[248:251]
v_mfma_f32_16x16x32_bf16 a[252:255], a[228:231], v[132:135], a[252:255]
ds_read_b64_tr_b16 a[228:229], v12 offset:128
ds_read_b64_tr_b16 a[230:231], v12 offset:8320
s_waitcnt vmcnt(22) lgkmcnt(15)
v_mfma_f32_16x16x32_bf16 v[136:139], a[192:195], v[40:43], v[136:139]
v_mfma_f32_16x16x32_bf16 v[140:143], a[192:195], v[44:47], v[140:143]
v_mfma_f32_16x16x32_bf16 v[144:147], a[192:195], v[48:51], v[144:147]
buffer_store_dwordx4 v[120:123], v32, s[16:19], s52 offen offset:2048 sc1
v_mfma_f32_16x16x32_bf16 v[148:151], a[192:195], v[52:55], v[148:151]
v_mfma_f32_16x16x32_bf16 v[152:155], a[192:195], v[56:59], v[152:155]
s_waitcnt vmcnt(31) lgkmcnt(0)
v_mfma_f32_16x16x32_bf16 v[156:159], a[192:195], v[60:63], v[156:159]
s_barrier
v_mfma_f32_16x16x32_bf16 v[160:163], a[196:199], v[40:43], v[160:163]
ds_read_b64_tr_b16 a[192:193], v10 offset:16384
ds_read_b64_tr_b16 a[194:195], v10 offset:24576
v_mfma_f32_16x16x32_bf16 v[164:167], a[196:199], v[44:47], v[164:167]
buffer_load_dwordx4 v[88:91], v32, s[4:7], s90 offen offset:0 sc1
v_mfma_f32_16x16x32_bf16 v[168:171], a[196:199], v[48:51], v[168:171]
v_mfma_f32_16x16x32_bf16 v[172:175], a[196:199], v[52:55], v[172:175]
buffer_load_dwordx4 v[92:95], v32, s[4:7], s90 offen offset:1024 sc1
v_mfma_f32_16x16x32_bf16 v[176:179], a[196:199], v[56:59], v[176:179]
v_mfma_f32_16x16x32_bf16 v[180:183], a[196:199], v[60:63], v[180:183]
ds_read_b64_tr_b16 a[196:197], v11 offset:16384
ds_read_b64_tr_b16 a[198:199], v11 offset:24576
v_mfma_f32_16x16x32_bf16 v[184:187], a[200:203], v[40:43], v[184:187]
buffer_load_dwordx4 v[96:99], v32, s[4:7], s90 offen offset:2048 sc1
v_mfma_f32_16x16x32_bf16 v[188:191], a[200:203], v[44:47], v[188:191]
v_mfma_f32_16x16x32_bf16 v[192:195], a[200:203], v[48:51], v[192:195]
buffer_load_dwordx4 v[100:103], v32, s[4:7], s90 offen offset:3072 sc1
v_mfma_f32_16x16x32_bf16 v[196:199], a[200:203], v[52:55], v[196:199]
v_mfma_f32_16x16x32_bf16 v[200:203], a[200:203], v[56:59], v[200:203]
buffer_store_dwordx4 v[124:127], v32, s[16:19], s52 offen offset:3072 sc1
v_mfma_f32_16x16x32_bf16 v[204:207], a[200:203], v[60:63], v[204:207]
ds_read_b64_tr_b16 a[200:201], v10 offset:16448
ds_read_b64_tr_b16 a[202:203], v10 offset:24640
v_mfma_f32_16x16x32_bf16 v[208:211], a[204:207], v[40:43], v[208:211]
buffer_load_dwordx4 v[104:107], v33, s[4:7], s90 offen offset:0 sc1
v_mfma_f32_16x16x32_bf16 v[212:215], a[204:207], v[44:47], v[212:215]
v_mfma_f32_16x16x32_bf16 v[216:219], a[204:207], v[48:51], v[216:219]
buffer_load_dword v19, v14, s[8:11], s99 offen sc1
v_mfma_f32_16x16x32_bf16 v[220:223], a[204:207], v[52:55], v[220:223]
buffer_load_dwordx4 v[108:111], v33, s[4:7], s90 offen offset:1024 sc1
v_mfma_f32_16x16x32_bf16 v[224:227], a[204:207], v[56:59], v[224:227]
v_mfma_f32_16x16x32_bf16 v[228:231], a[204:207], v[60:63], v[228:231]
ds_read_b64_tr_b16 a[204:205], v11 offset:16448
ds_read_b64_tr_b16 a[206:207], v11 offset:24640
v_mfma_f32_16x16x32_bf16 v[232:235], a[208:211], v[40:43], v[232:235]
s_add_u32 s53, s62, s97
s_lshr_b64 s[62:63], s[62:63], 4
v_mfma_f32_16x16x32_bf16 v[236:239], a[208:211], v[44:47], v[236:239]
s_bfe_u32 s32, s53, 0x20002
s_and_b32 s33, s53, 3
v_mfma_f32_16x16x32_bf16 v[240:243], a[208:211], v[48:51], v[240:243]
s_lshl_b32 s34, s32, 3
s_add_u32 s34, s34, s33
v_mfma_f32_16x16x32_bf16 v[244:247], a[208:211], v[52:55], v[244:247]
s_mul_i32 s96, s34, 40960
s_lshl_b32 s32, s32, 4
v_mfma_f32_16x16x32_bf16 v[248:251], a[208:211], v[56:59], v[248:251]
s_add_u32 s32, s32, s33
s_mul_i32 s88, s32, 6144
v_mfma_f32_16x16x32_bf16 v[252:255], a[208:211], v[60:63], v[252:255]
ds_read_b64_tr_b16 a[208:209], v10 offset:16512
ds_read_b64_tr_b16 a[210:211], v10 offset:24704
v_mfma_f32_16x16x32_bf16 a[0:3], a[212:215], v[40:43], a[0:3]
s_add_u32 m0, s54, 0
v_mfma_f32_16x16x32_bf16 a[4:7], a[212:215], v[44:47], a[4:7]
buffer_store_dwordx4 v[128:131], v33, s[16:19], s52 offen offset:0 sc1
v_mfma_f32_16x16x32_bf16 a[8:11], a[212:215], v[48:51], a[8:11]
s_add_u32 s55, s96, 0
v_mfma_f32_16x16x32_bf16 a[12:15], a[212:215], v[52:55], a[12:15]
buffer_load_dwordx4 v5, s[92:95], s55 offen offset:0  lds
v_mfma_f32_16x16x32_bf16 a[32:35], a[212:215], v[56:59], a[32:35]
v_mfma_f32_16x16x32_bf16 a[36:39], a[212:215], v[60:63], a[36:39]
ds_read_b64_tr_b16 a[212:213], v12 offset:16384
ds_read_b64_tr_b16 a[214:215], v12 offset:24576
v_mfma_f32_16x16x32_bf16 a[40:43], a[216:219], v[40:43], a[40:43]
buffer_load_dwordx4 v6, s[92:95], s55 offen offset:1024  lds
v_mfma_f32_16x16x32_bf16 a[44:47], a[216:219], v[44:47], a[44:47]
v_mfma_f32_16x16x32_bf16 a[64:67], a[216:219], v[48:51], a[64:67]
buffer_load_dwordx4 v7, s[92:95], s55 offen offset:2048  lds
v_mfma_f32_16x16x32_bf16 a[68:71], a[216:219], v[52:55], a[68:71]
v_mfma_f32_16x16x32_bf16 a[72:75], a[216:219], v[56:59], a[72:75]
buffer_load_dwordx4 v8, s[92:95], s55 offen offset:3072  lds
v_mfma_f32_16x16x32_bf16 a[76:79], a[216:219], v[60:63], a[76:79]
ds_read_b64_tr_b16 a[216:217], v13 offset:16384
ds_read_b64_tr_b16 a[218:219], v13 offset:24576
v_mfma_f32_16x16x32_bf16 a[96:99], a[220:223], v[40:43], a[96:99]
v_mfma_f32_16x16x32_bf16 a[100:103], a[220:223], v[44:47], a[100:103]
s_add_u32 m0, s54, 4096
v_mfma_f32_16x16x32_bf16 a[104:107], a[220:223], v[48:51], a[104:107]
buffer_store_dwordx4 v[132:135], v33, s[16:19], s52 offen offset:1024 sc1
v_mfma_f32_16x16x32_bf16 a[108:111], a[220:223], v[52:55], a[108:111]
s_nop 0
v_mfma_f32_16x16x32_bf16 a[128:131], a[220:223], v[56:59], a[128:131]
buffer_load_dwordx4 v9, s[92:95], s55 offen offset:0  lds
v_mfma_f32_16x16x32_bf16 a[132:135], a[220:223], v[60:63], a[132:135]
ds_read_b64_tr_b16 a[220:221], v12 offset:16448
ds_read_b64_tr_b16 a[222:223], v12 offset:24640
v_mfma_f32_16x16x32_bf16 a[136:139], a[224:227], v[40:43], a[136:139]
v_mfma_f32_16x16x32_bf16 a[140:143], a[224:227], v[44:47], a[140:143]
v_mfma_f32_16x16x32_bf16 a[160:163], a[224:227], v[48:51], a[160:163]
v_mfma_f32_16x16x32_bf16 a[164:167], a[224:227], v[52:55], a[164:167]
v_mfma_f32_16x16x32_bf16 a[168:171], a[224:227], v[56:59], a[168:171]
v_mfma_f32_16x16x32_bf16 a[172:175], a[224:227], v[60:63], a[172:175]
ds_read_b64_tr_b16 a[224:225], v13 offset:16448
ds_read_b64_tr_b16 a[226:227], v13 offset:24640
v_mfma_f32_16x16x32_bf16 a[232:235], a[228:231], v[40:43], a[232:235]
v_mfma_f32_16x16x32_bf16 a[236:239], a[228:231], v[44:47], a[236:239]
v_mfma_f32_16x16x32_bf16 a[240:243], a[228:231], v[48:51], a[240:243]
v_mfma_f32_16x16x32_bf16 a[244:247], a[228:231], v[52:55], a[244:247]
v_mfma_f32_16x16x32_bf16 a[248:251], a[228:231], v[56:59], a[248:251]
v_mfma_f32_16x16x32_bf16 a[252:255], a[228:231], v[60:63], a[252:255]
ds_read_b64_tr_b16 a[228:229], v12 offset:16512
ds_read_b64_tr_b16 a[230:231], v12 offset:24704
s_waitcnt vmcnt(23) lgkmcnt(15)
v_mfma_f32_16x16x32_bf16 v[136:139], a[192:195], v[64:67], v[136:139]
v_mfma_f32_16x16x32_bf16 v[140:143], a[192:195], v[68:71], v[140:143]
v_mfma_f32_16x16x32_bf16 v[144:147], a[192:195], v[72:75], v[144:147]
v_mfma_f32_16x16x32_bf16 v[148:151], a[192:195], v[76:79], v[148:151]
v_mfma_f32_16x16x32_bf16 v[152:155], a[192:195], v[80:83], v[152:155]
s_waitcnt vmcnt(8) lgkmcnt(0)
v_mfma_f32_16x16x32_bf16 v[156:159], a[192:195], v[84:87], v[156:159]
v_readfirstlane_b32 s98, v19
s_nop 0
s_sub_u32 s98, s98, s56
s_cmp_lg_u32 s20, 0
s_cbranch_scc1 L_pd3
s_bfe_u32 s34, s98, 0x40004
s_cmp_eq_u32 s34, 4
s_cbranch_scc1 L_pd3
s_mov_b32 s61, 0x40000
L_pl3:
buffer_load_dword v19, v14, s[8:11], s99 offen sc1
s_waitcnt vmcnt(0)
v_readfirstlane_b32 s98, v19
s_sub_u32 s61, s61, 1
s_sub_u32 s98, s98, s56
s_bfe_u32 s34, s98, 0x40004
s_cmp_eq_u32 s34, 4
s_cbranch_scc1 L_pd3
s_sleep 2
s_and_b32 s34, s61, 63
s_cbranch_scc1 L_pl3
buffer_load_dword v19, v14, s[36:39], s41 offen sc1
s_waitcnt vmcnt(0)
v_readfirstlane_b32 s34, v19
s_cmp_eq_u32 s61, 0
s_cbranch_scc1 L_pd3
s_bfe_u32 s34, s34, 0x40004
s_cmp_lt_u32 s34, 4
s_cbranch_scc1 L_pl3
L_pd3:
s_barrier
v_mfma_f32_16x16x32_bf16 v[160:163], a[196:199], v[64:67], v[160:163]
ds_read_b64_tr_b16 a[192:193], v10 offset:32768
ds_read_b64_tr_b16 a[194:195], v10 offset:40960
v_mfma_f32_16x16x32_bf16 v[164:167], a[196:199], v[68:71], v[164:167]
buffer_load_dwordx4 v[112:115], v32, s[4:7], s91 offen offset:0 sc1
v_mfma_f32_16x16x32_bf16 v[168:171], a[196:199], v[72:75], v[168:171]
v_mfma_f32_16x16x32_bf16 v[172:175], a[196:199], v[76:79], v[172:175]
v_mfma_f32_16x16x32_bf16 v[176:179], a[196:199], v[80:83], v[176:179]
buffer_load_dwordx4 v[116:119], v32, s[4:7], s91 offen offset:1024 sc1
v_mfma_f32_16x16x32_bf16 v[180:183], a[196:199], v[84:87], v[180:183]
ds_read_b64_tr_b16 a[196:197], v11 offset:32768
ds_read_b64_tr_b16 a[198:199], v11 offset:40960
v_mfma_f32_16x16x32_bf16 v[184:187], a[200:203], v[64:67], v[184:187]
v_mfma_f32_16x16x32_bf16 v[188:191], a[200:203], v[68:71], v[188:191]
v_mfma_f32_16x16x32_bf16 v[192:195], a[200:203], v[72:75], v[192:195]
buffer_load_dwordx4 v[120:123], v32, s[4:7], s91 offen offset:2048 sc1
v_mfma_f32_16x16x32_bf16 v[196:199], a[200:203], v[76:79], v[196:199]
v_mfma_f32_16x16x32_bf16 v[200:203], a[200:203], v[80:83], v[200:203]
v_mfma_f32_16x16x32_bf16 v[204:207], a[200:203], v[84:87], v[204:207]
ds_read_b64_tr_b16 a[200:201], v10 offset:32832
ds_read_b64_tr_b16 a[202:203], v10 offset:41024
v_mfma_f32_16x16x32_bf16 v[208:211], a[204:207], v[64:67], v[208:211]
buffer_load_dwordx4 v[124:127], v32, s[4:7], s91 offen offset:3072 sc1
v_mfma_f32_16x16x32_bf16 v[212:215], a[204:207], v[68:71], v[212:215]
v_mfma_f32_16x16x32_bf16 v[216:219], a[204:207], v[72:75], v[216:219]
v_mfma_f32_16x16x32_bf16 v[220:223], a[204:207], v[76:79], v[220:223]
buffer_load_dwordx4 v[128:131], v33, s[4:7], s91 offen offset:0 sc1
v_mfma_f32_16x16x32_bf16 v[224:227], a[204:207], v[80:83], v[224:227]
v_mfma_f32_16x16x32_bf16 v[228:231], a[204:207], v[84:87], v[228:231]
ds_read_b64_tr_b16 a[204:205], v11 offset:32832
ds_read_b64_tr_b16 a[206:207], v11 offset:41024
v_mfma_f32_16x16x32_bf16 v[232:235], a[208:211], v[64:67], v[232:235]
v_mfma_f32_16x16x32_bf16 v[236:239], a[208:211], v[68:71], v[236:239]
buffer_load_dwordx4 v[132:135], v33, s[4:7], s91 offen offset:1024 sc1
v_mfma_f32_16x16x32_bf16 v[240:243], a[208:211], v[72:75], v[240:243]
v_mfma_f32_16x16x32_bf16 v[244:247], a[208:211], v[76:79], v[244:247]
v_mfma_f32_16x16x32_bf16 v[248:251], a[208:211], v[80:83], v[248:251]
s_add_u32 s53, s62, s97
s_lshr_b64 s[62:63], s[62:63], 4
v_mfma_f32_16x16x32_bf16 v[252:255], a[208:211], v[84:87], v[252:255]
ds_read_b64_tr_b16 a[208:209], v10 offset:32896
ds_read_b64_tr_b16 a[210:211], v10 offset:41088
v_mfma_f32_16x16x32_bf16 a[0:3], a[212:215], v[64:67], a[0:3]
s_bfe_u32 s32, s53, 0x20002
s_and_b32 s33, s53, 3
v_mfma_f32_16x16x32_bf16 a[4:7], a[212:215], v[68:71], a[4:7]
s_lshl_b32 s34, s32, 3
s_add_u32 s34, s34, s33
v_mfma_f32_16x16x32_bf16 a[8:11], a[212:215], v[72:75], a[8:11]
s_mul_i32 s96, s34, 40960
s_lshl_b32 s32, s32, 4
v_mfma_f32_16x16x32_bf16 a[12:15], a[212:215], v[76:79], a[12:15]
s_add_u32 s32, s32, s33
s_mul_i32 s89, s32, 6144
v_mfma_f32_16x16x32_bf16 a[32:35], a[212:215], v[80:83], a[32:35]
s_add_u32 m0, s54, 16384
v_mfma_f32_16x16x32_bf16 a[36:39], a[212:215], v[84:87], a[36:39]
ds_read_b64_tr_b16 a[212:213], v12 offset:32768
ds_read_b64_tr_b16 a[214:215], v12 offset:40960
v_mfma_f32_16x16x32_bf16 a[40:43], a[216:219], v[64:67], a[40:43]
s_add_u32 s55, s96, 0
v_mfma_f32_16x16x32_bf16 a[44:47], a[216:219], v[68:71], a[44:47]
buffer_load_dwordx4 v5, s[92:95], s55 offen offset:0  lds
v_mfma_f32_16x16x32_bf16 a[64:67], a[216:219], v[72:75], a[64:67]
v_mfma_f32_16x16x32_bf16 a[68:71], a[216:219], v[76:79], a[68:71]
v_mfma_f32_16x16x32_bf16 a[72:75], a[216:219], v[80:83], a[72:75]
buffer_load_dwordx4 v6, s[92:95], s55 offen offset:1024  lds
v_mfma_f32_16x16x32_bf16 a[76:79], a[216:219], v[84:87], a[76:79]
ds_read_b64_tr_b16 a[216:217], v13 offset:32768
ds_read_b64_tr_b16 a[218:219], v13 offset:40960
v_mfma_f32_16x16x32_bf16 a[96:99], a[220:223], v[64:67], a[96:99]
v_mfma_f32_16x16x32_bf16 a[100:103], a[220:223], v[68:71], a[100:103]
v_mfma_f32_16x16x32_bf16 a[104:107], a[220:223], v[72:75], a[104:107]
buffer_load_dwordx4 v7, s[92:95], s55 offen offset:2048  lds
v_mfma_f32_16x16x32_bf16 a[108:111], a[220:223], v[76:79], a[108:111]
v_mfma_f32_16x16x32_bf16 a[128:131], a[220:223], v[80:83], a[128:131]
v_mfma_f32_16x16x32_bf16 a[132:135], a[220:223], v[84:87], a[132:135]
ds_read_b64_tr_b16 a[220:221], v12 offset:32832
ds_read_b64_tr_b16 a[222:223], v12 offset:41024
v_mfma_f32_16x16x32_bf16 a[136:139], a[224:227], v[64:67], a[136:139]
buffer_load_dwordx4 v8, s[92:95], s55 offen offset:3072  lds
v_mfma_f32_16x16x32_bf16 a[140:143], a[224:227], v[68:71], a[140:143]
v_mfma_f32_16x16x32_bf16 a[160:163], a[224:227], v[72:75], a[160:163]
v_mfma_f32_16x16x32_bf16 a[164:167], a[224:227], v[76:79], a[164:167]
s_add_u32 m0, s54, 20480
v_mfma_f32_16x16x32_bf16 a[168:171], a[224:227], v[80:83], a[168:171]
s_nop 0
v_mfma_f32_16x16x32_bf16 a[172:175], a[224:227], v[84:87], a[172:175]
ds_read_b64_tr_b16 a[224:225], v13 offset:32832
ds_read_b64_tr_b16 a[226:227], v13 offset:41024
v_mfma_f32_16x16x32_bf16 a[232:235], a[228:231], v[64:67], a[232:235]
buffer_load_dwordx4 v9, s[92:95], s55 offen offset:0  lds
v_mfma_f32_16x16x32_bf16 a[236:239], a[228:231], v[68:71], a[236:239]
v_mfma_f32_16x16x32_bf16 a[240:243], a[228:231], v[72:75], a[240:243]
v_mfma_f32_16x16x32_bf16 a[244:247], a[228:231], v[76:79], a[244:247]
v_mfma_f32_16x16x32_bf16 a[248:251], a[228:231], v[80:83], a[248:251]
v_mfma_f32_16x16x32_bf16 a[252:255], a[228:231], v[84:87], a[252:255]
ds_read_b64_tr_b16 a[228:229], v12 offset:32896
ds_read_b64_tr_b16 a[230:231], v12 offset:41088
s_waitcnt vmcnt(18) lgkmcnt(15)
v_mfma_f32_16x16x32_bf16 v[136:139], a[192:195], v[88:91], v[136:139]
v_mfma_f32_16x16x32_bf16 v[140:143], a[192:195], v[92:95], v[140:143]
v_mfma_f32_16x16x32_bf16 v[144:147], a[192:195], v[96:99], v[144:147]
v_mfma_f32_16x16x32_bf16 v[148:151], a[192:195], v[100:103], v[148:151]
v_mfma_f32_16x16x32_bf16 v[152:155], a[192:195], v[104:107], v[152:155]
s_waitcnt vmcnt(12) lgkmcnt(0)
v_mfma_f32_16x16x32_bf16 v[156:159], a[192:195], v[108:111], v[156:159]
s_barrier
s_cmp_lg_u32 s20, 1
s_cbranch_scc1 L_sg4
s_mov_b64 exec, 1
buffer_atomic_add v18, v14, s[8:11], s99 offen
buffer_atomic_add v18, v14, s[36:39], s41 offen
s_mov_b64 exec, -1
L_sg4:
v_mfma_f32_16x16x32_bf16 v[160:163], a[196:199], v[88:91], v[160:163]
ds_read_b64_tr_b16 a[192:193], v10 offset:49152
ds_read_b64_tr_b16 a[194:195], v10 offset:57344
v_mfma_f32_16x16x32_bf16 v[164:167], a[196:199], v[92:95], v[164:167]
buffer_load_dwordx4 v[40:43], v32, s[4:7], s88 offen offset:0 sc1
v_mfma_f32_16x16x32_bf16 v[168:171], a[196:199], v[96:99], v[168:171]
v_mfma_f32_16x16x32_bf16 v[172:175], a[196:199], v[100:103], v[172:175]
v_mfma_f32_16x16x32_bf16 v[176:179], a[196:199], v[104:107], v[176:179]
buffer_load_dwordx4 v[44:47], v32, s[4:7], s88 offen offset:1024 sc1
v_mfma_f32_16x16x32_bf16 v[180:183], a[196:199], v[108:111], v[180:183]
ds_read_b64_tr_b16 a[196:197], v11 offset:49152
ds_read_b64_tr_b16 a[198:199], v11 offset:57344
v_mfma_f32_16x16x32_bf16 v[184:187], a[200:203], v[88:91], v[184:187]
v_mfma_f32_16x16x32_bf16 v[188:191], a[200:203], v[92:95], v[188:191]
v_mfma_f32_16x16x32_bf16 v[192:195], a[200:203], v[96:99], v[192:195]
buffer_load_dwordx4 v[48:51], v32, s[4:7], s88 offen offset:2048 sc1
v_mfma_f32_16x16x32_bf16 v[196:199], a[200:203], v[100:103], v[196:199]
v_mfma_f32_16x16x32_bf16 v[200:203], a[200:203], v[104:107], v[200:203]
v_mfma_f32_16x16x32_bf16 v[204:207], a[200:203], v[108:111], v[204:207]
ds_read_b64_tr_b16 a[200:201], v10 offset:49216
ds_read_b64_tr_b16 a[202:203], v10 offset:57408
v_mfma_f32_16x16x32_bf16 v[208:211], a[204:207], v[88:91], v[208:211]
buffer_load_dwordx4 v[52:55], v32, s[4:7], s88 offen offset:3072 sc1
v_mfma_f32_16x16x32_bf16 v[212:215], a[204:207], v[92:95], v[212:215]
v_mfma_f32_16x16x32_bf16 v[216:219], a[204:207], v[96:99], v[216:219]
v_mfma_f32_16x16x32_bf16 v[220:223], a[204:207], v[100:103], v[220:223]
buffer_load_dwordx4 v[56:59], v33, s[4:7], s88 offen offset:0 sc1
v_mfma_f32_16x16x32_bf16 v[224:227], a[204:207], v[104:107], v[224:227]
v_mfma_f32_16x16x32_bf16 v[228:231], a[204:207], v[108:111], v[228:231]
ds_read_b64_tr_b16 a[204:205], v11 offset:49216
ds_read_b64_tr_b16 a[206:207], v11 offset:57408
v_mfma_f32_16x16x32_bf16 v[232:235], a[208:211], v[88:91], v[232:235]
v_mfma_f32_16x16x32_bf16 v[236:239], a[208:211], v[92:95], v[236:239]
buffer_load_dwordx4 v[60:63], v33, s[4:7], s88 offen offset:1024 sc1
v_mfma_f32_16x16x32_bf16 v[240:243], a[208:211], v[96:99], v[240:243]
v_mfma_f32_16x16x32_bf16 v[244:247], a[208:211], v[100:103], v[244:247]
v_mfma_f32_16x16x32_bf16 v[248:251], a[208:211], v[104:107], v[248:251]
s_add_u32 s53, s62, s97
s_lshr_b64 s[62:63], s[62:63], 4
v_mfma_f32_16x16x32_bf16 v[252:255], a[208:211], v[108:111], v[252:255]
ds_read_b64_tr_b16 a[208:209], v10 offset:49280
ds_read_b64_tr_b16 a[210:211], v10 offset:57472
v_mfma_f32_16x16x32_bf16 a[0:3], a[212:215], v[88:91], a[0:3]
s_bfe_u32 s32, s53, 0x20002
s_and_b32 s33, s53, 3
v_mfma_f32_16x16x32_bf16 a[4:7], a[212:215], v[92:95], a[4:7]
s_lshl_b32 s34, s32, 3
s_add_u32 s34, s34, s33
v_mfma_f32_16x16x32_bf16 a[8:11], a[212:215], v[96:99], a[8:11]
s_mul_i32 s96, s34, 40960
s_lshl_b32 s32, s32, 4
v_mfma_f32_16x16x32_bf16 a[12:15], a[212:215], v[100:103], a[12:15]
s_add_u32 s32, s32, s33
s_mul_i32 s90, s32, 6144
v_mfma_f32_16x16x32_bf16 a[32:35], a[212:215], v[104:107], a[32:35]
s_add_u32 m0, s54, 32768
v_mfma_f32_16x16x32_bf16 a[36:39], a[212:215], v[108:111], a[36:39]
ds_read_b64_tr_b16 a[212:213], v12 offset:49152
ds_read_b64_tr_b16 a[214:215], v12 offset:57344
v_mfma_f32_16x16x32_bf16 a[40:43], a[216:219], v[88:91], a[40:43]
s_add_u32 s55, s96, 0
v_mfma_f32_16x16x32_bf16 a[44:47], a[216:219], v[92:95], a[44:47]
buffer_load_dwordx4 v5, s[92:95], s55 offen offset:0  lds
v_mfma_f32_16x16x32_bf16 a[64:67], a[216:219], v[96:99], a[64:67]
v_mfma_f32_16x16x32_bf16 a[68:71], a[216:219], v[100:103], a[68:71]
v_mfma_f32_16x16x32_bf16 a[72:75], a[216:219], v[104:107], a[72:75]
buffer_load_dwordx4 v6, s[92:95], s55 offen offset:1024  lds
v_mfma_f32_16x16x32_bf16 a[76:79], a[216:219], v[108:111], a[76:79]
ds_read_b64_tr_b16 a[216:217], v13 offset:49152
ds_read_b64_tr_b16 a[218:219], v13 offset:57344
v_mfma_f32_16x16x32_bf16 a[96:99], a[220:223], v[88:91], a[96:99]
v_mfma_f32_16x16x32_bf16 a[100:103], a[220:223], v[92:95], a[100:103]
v_mfma_f32_16x16x32_bf16 a[104:107], a[220:223], v[96:99], a[104:107]
buffer_load_dwordx4 v7, s[92:95], s55 offen offset:2048  lds
v_mfma_f32_16x16x32_bf16 a[108:111], a[220:223], v[100:103], a[108:111]
v_mfma_f32_16x16x32_bf16 a[128:131], a[220:223], v[104:107], a[128:131]
v_mfma_f32_16x16x32_bf16 a[132:135], a[220:223], v[108:111], a[132:135]
ds_read_b64_tr_b16 a[220:221], v12 offset:49216
ds_read_b64_tr_b16 a[222:223], v12 offset:57408
v_mfma_f32_16x16x32_bf16 a[136:139], a[224:227], v[88:91], a[136:139]
buffer_load_dwordx4 v8, s[92:95], s55 offen offset:3072  lds
v_mfma_f32_16x16x32_bf16 a[140:143], a[224:227], v[92:95], a[140:143]
v_mfma_f32_16x16x32_bf16 a[160:163], a[224:227], v[96:99], a[160:163]
v_mfma_f32_16x16x32_bf16 a[164:167], a[224:227], v[100:103], a[164:167]
s_add_u32 m0, s54, 36864
v_mfma_f32_16x16x32_bf16 a[168:171], a[224:227], v[104:107], a[168:171]
s_nop 0
v_mfma_f32_16x16x32_bf16 a[172:175], a[224:227], v[108:111], a[172:175]
ds_read_b64_tr_b16 a[224:225], v13 offset:49216
ds_read_b64_tr_b16 a[226:227], v13 offset:57408
v_mfma_f32_16x16x32_bf16 a[232:235], a[228:231], v[88:91], a[232:235]
buffer_load_dwordx4 v9, s[92:95], s55 offen offset:0  lds
v_mfma_f32_16x16x32_bf16 a[236:239], a[228:231], v[92:95], a[236:239]
v_mfma_f32_16x16x32_bf16 a[240:243], a[228:231], v[96:99], a[240:243]
v_mfma_f32_16x16x32_bf16 a[244:247], a[228:231], v[100:103], a[244:247]
v_mfma_f32_16x16x32_bf16 a[248:251], a[228:231], v[104:107], a[248:251]
v_mfma_f32_16x16x32_bf16 a[252:255], a[228:231], v[108:111], a[252:255]
ds_read_b64_tr_b16 a[228:229], v12 offset:49280
ds_read_b64_tr_b16 a[230:231], v12 offset:57472
s_waitcnt vmcnt(16) lgkmcnt(15)
v_mfma_f32_16x16x32_bf16 v[136:139], a[192:195], v[112:115], v[136:139]
v_mfma_f32_16x16x32_bf16 v[140:143], a[192:195], v[116:119], v[140:143]
v_mfma_f32_16x16x32_bf16 v[144:147], a[192:195], v[120:123], v[144:147]
v_mfma_f32_16x16x32_bf16 v[148:151], a[192:195], v[124:127], v[148:151]
v_mfma_f32_16x16x32_bf16 v[152:155], a[192:195], v[128:131], v[152:155]
s_waitcnt vmcnt(22) lgkmcnt(0)
v_mfma_f32_16x16x32_bf16 v[156:159], a[192:195], v[132:135], v[156:159]
s_barrier
v_mfma_f32_16x16x32_bf16 v[160:163], a[196:199], v[112:115], v[160:163]
ds_read_b64_tr_b16 a[192:193], v10 offset:0
ds_read_b64_tr_b16 a[194:195], v10 offset:8192
v_mfma_f32_16x16x32_bf16 v[164:167], a[196:199], v[116:119], v[164:167]
buffer_load_dwordx4 v[64:67], v32, s[4:7], s89 offen offset:0 sc1
v_mfma_f32_16x16x32_bf16 v[168:171], a[196:199], v[120:123], v[168:171]
v_mfma_f32_16x16x32_bf16 v[172:175], a[196:199], v[124:127], v[172:175]
v_mfma_f32_16x16x32_bf16 v[176:179], a[196:199], v[128:131], v[176:179]
buffer_load_dwordx4 v[68:71], v32, s[4:7], s89 offen offset:1024 sc1
v_mfma_f32_16x16x32_bf16 v[180:183], a[196:199], v[132:135], v[180:183]
ds_read_b64_tr_b16 a[196:197], v11 offset:0
ds_read_b64_tr_b16 a[198:199], v11 offset:8192
v_mfma_f32_16x16x32_bf16 v[184:187], a[200:203], v[112:115], v[184:187]
v_mfma_f32_16x16x32_bf16 v[188:191], a[200:203], v[116:119], v[188:191]
v_mfma_f32_16x16x32_bf16 v[192:195], a[200:203], v[120:123], v[192:195]
buffer_load_dwordx4 v[72:75], v32, s[4:7], s89 offen offset:2048 sc1
v_mfma_f32_16x16x32_bf16 v[196:199], a[200:203], v[124:127], v[196:199]
v_mfma_f32_16x16x32_bf16 v[200:203], a[200:203], v[128:131], v[200:203]
v_mfma_f32_16x16x32_bf16 v[204:207], a[200:203], v[132:135], v[204:207]
ds_read_b64_tr_b16 a[200:201], v10 offset:64
ds_read_b64_tr_b16 a[202:203], v10 offset:8256
v_mfma_f32_16x16x32_bf16 v[208:211], a[204:207], v[112:115], v[208:211]
buffer_load_dwordx4 v[76:79], v32, s[4:7], s89 offen offset:3072 sc1
v_mfma_f32_16x16x32_bf16 v[212:215], a[204:207], v[116:119], v[212:215]
v_mfma_f32_16x16x32_bf16 v[216:219], a[204:207], v[120:123], v[216:219]
buffer_load_dword v19, v14, s[8:11], s99 offen sc1
v_mfma_f32_16x16x32_bf16 v[220:223], a[204:207], v[124:127], v[220:223]
v_mfma_f32_16x16x32_bf16 v[224:227], a[204:207], v[128:131], v[224:227]
buffer_load_dwordx4 v[80:83], v33, s[4:7], s89 offen offset:0 sc1
v_mfma_f32_16x16x32_bf16 v[228:231], a[204:207], v[132:135], v[228:231]
ds_read_b64_tr_b16 a[204:205], v11 offset:64
ds_read_b64_tr_b16 a[206:207], v11 offset:8256
v_mfma_f32_16x16x32_bf16 v[232:235], a[208:211], v[112:115], v[232:235]
v_mfma_f32_16x16x32_bf16 v[236:239], a[208:211], v[116:119], v[236:239]
v_mfma_f32_16x16x32_bf16 v[240:243], a[208:211], v[120:123], v[240:243]
buffer_load_dwordx4 v[84:87], v33, s[4:7], s89 offen offset:1024 sc1
v_mfma_f32_16x16x32_bf16 v[244:247], a[208:211], v[124:127], v[244:247]
v_mfma_f32_16x16x32_bf16 v[248:251], a[208:211], v[128:131], v[248:251]
v_mfma_f32_16x16x32_bf16 v[252:255], a[208:211], v[132:135], v[252:255]
ds_read_b64_tr_b16 a[208:209], v10 offset:128
ds_read_b64_tr_b16 a[210:211], v10 offset:8320
v_mfma_f32_16x16x32_bf16 a[0:3], a[212:215], v[112:115], a[0:3]
s_add_u32 s53, s62, s97
s_lshr_b64 s[62:63], s[62:63], 4
v_mfma_f32_16x16x32_bf16 a[4:7], a[212:215], v[116:119], a[4:7]
s_bfe_u32 s32, s53, 0x20002
s_and_b32 s33, s53, 3
v_mfma_f32_16x16x32_bf16 a[8:11], a[212:215], v[120:123], a[8:11]
s_lshl_b32 s34, s32, 3
s_add_u32 s34, s34, s33
v_mfma_f32_16x16x32_bf16 a[12:15], a[212:215], v[124:127], a[12:15]
s_mul_i32 s96, s34, 40960
s_lshl_b32 s32, s32, 4
v_mfma_f32_16x16x32_bf16 a[32:35], a[212:215], v[128:131], a[32:35]
s_add_u32 s32, s32, s33
s_mul_i32 s91, s32, 6144
v_mfma_f32_16x16x32_bf16 a[36:39], a[212:215], v[132:135], a[36:39]
ds_read_b64_tr_b16 a[212:213], v12 offset:0
ds_read_b64_tr_b16 a[214:215], v12 offset:8192
v_mfma_f32_16x16x32_bf16 a[40:43], a[216:219], v[112:115], a[40:43]
s_add_u32 m0, s54, 49152
v_mfma_f32_16x16x32_bf16 a[44:47], a[216:219], v[116:119], a[44:47]
s_add_u32 s55, s96, 0
v_mfma_f32_16x16x32_bf16 a[64:67], a[216:219], v[120:123], a[64:67]
buffer_load_dwordx4 v5, s[92:95], s55 offen offset:0  lds
v_mfma_f32_16x16x32_bf16 a[68:71], a[216:219], v[124:127], a[68:71]
v_mfma_f32_16x16x32_bf16 a[72:75], a[216:219], v[128:131], a[72:75]
v_mfma_f32_16x16x32_bf16 a[76:79], a[216:219], v[132:135], a[76:79]
ds_read_b64_tr_b16 a[216:217], v13 offset:0
ds_read_b64_tr_b16 a[218:219], v13 offset:8192
v_mfma_f32_16x16x32_bf16 a[96:99], a[220:223], v[112:115], a[96:99]
buffer_load_dwordx4 v6, s[92:95], s55 offen offset:1024  lds
v_mfma_f32_16x16x32_bf16 a[100:103], a[220:223], v[116:119], a[100:103]
v_mfma_f32_16x16x32_bf16 a[104:107], a[220:223], v[120:123], a[104:107]
v_mfma_f32_16x16x32_bf16 a[108:111], a[220:223], v[124:127], a[108:111]
buffer_load_dwordx4 v7, s[92:95], s55 offen offset:2048  lds
v_mfma_f32_16x16x32_bf16 a[128:131], a[220:223], v[128:131], a[128:131]
v_mfma_f32_16x16x32_bf16 a[132:135], a[220:223], v[132:135], a[132:135]
ds_read_b64_tr_b16 a[220:221], v12 offset:64
ds_read_b64_tr_b16 a[222:223], v12 offset:8256
v_mfma_f32_16x16x32_bf16 a[136:139], a[224:227], v[112:115], a[136:139]
v_mfma_f32_16x16x32_bf16 a[140:143], a[224:227], v[116:119], a[140:143]
buffer_load_dwordx4 v8, s[92:95], s55 offen offset:3072  lds
v_mfma_f32_16x16x32_bf16 a[160:163], a[224:227], v[120:123], a[160:163]
v_mfma_f32_16x16x32_bf16 a[164:167], a[224:227], v[124:127], a[164:167]
v_mfma_f32_16x16x32_bf16 a[168:171], a[224:227], v[128:131], a[168:171]
s_add_u32 m0, s54, 53248
v_mfma_f32_16x16x32_bf16 a[172:175], a[224:227], v[132:135], a[172:175]
ds_read_b64_tr_b16 a[224:225], v13 offset:64
ds_read_b64_tr_b16 a[226:227], v13 offset:8256
v_mfma_f32_16x16x32_bf16 a[232:235], a[228:231], v[112:115], a[232:235]
s_nop 0
v_mfma_f32_16x16x32_bf16 a[236:239], a[228:231], v[116:119], a[236:239]
buffer_load_dwordx4 v9, s[92:95], s55 offen offset:0  lds
v_mfma_f32_16x16x32_bf16 a[240:243], a[228:231], v[120:123], a[240:243]
v_mfma_f32_16x16x32_bf16 a[244:247], a[228:231], v[124:127], a[244:247]
v_mfma_f32_16x16x32_bf16 a[248:251], a[228:231], v[128:131], a[248:251]
v_mfma_f32_16x16x32_bf16 a[252:255], a[228:231], v[132:135], a[252:255]
ds_read_b64_tr_b16 a[228:229], v12 offset:128
ds_read_b64_tr_b16 a[230:231], v12 offset:8320
s_waitcnt vmcnt(17) lgkmcnt(15)
v_mfma_f32_16x16x32_bf16 v[136:139], a[192:195], v[40:43], v[136:139]
v_mfma_f32_16x16x32_bf16 v[140:143], a[192:195], v[44:47], v[140:143]
v_mfma_f32_16x16x32_bf16 v[144:147], a[192:195], v[48:51], v[144:147]
v_mfma_f32_16x16x32_bf16 v[148:151], a[192:195], v[52:55], v[148:151]
v_mfma_f32_16x16x32_bf16 v[152:155], a[192:195], v[56:59], v[152:155]
s_waitcnt vmcnt(7) lgkmcnt(0)
v_mfma_f32_16x16x32_bf16 v[156:159], a[192:195], v[60:63], v[156:159]
v_readfirstlane_b32 s98, v19
s_nop 0
s_sub_u32 s98, s98, s56
s_cmp_lg_u32 s20, 0
s_cbranch_scc1 L_pd5
s_bfe_u32 s34, s98, 0x40008
s_cmp_eq_u32 s34, 4
s_cbranch_scc1 L_pd5
s_mov_b32 s61, 0x40000
L_pl5:
buffer_load_dword v19, v14, s[8:11], s99 offen sc1
s_waitcnt vmcnt(0)
v_readfirstlane_b32 s98, v19
s_sub_u32 s61, s61, 1
s_sub_u32 s98, s98, s56
s_bfe_u32 s34, s98, 0x40008
s_cmp_eq_u32 s34, 4
s_cbranch_scc1 L_pd5
s_sleep 2
s_and_b32 s34, s61, 63
s_cbranch_scc1 L_pl5
buffer_load_dword v19, v14, s[36:39], s41 offen sc1
s_waitcnt vmcnt(0)
v_readfirstlane_b32 s34, v19
s_cmp_eq_u32 s61, 0
s_cbranch_scc1 L_pd5
s_bfe_u32 s34, s34, 0x40008
s_cmp_lt_u32 s34, 4
s_cbranch_scc1 L_pl5
L_pd5:
s_barrier
v_mfma_f32_16x16x32_bf16 v[160:163], a[196:199], v[40:43], v[160:163]
ds_read_b64_tr_b16 a[192:193], v10 offset:16384
ds_read_b64_tr_b16 a[194:195], v10 offset:24576
v_mfma_f32_16x16x32_bf16 v[164:167], a[196:199], v[44:47], v[164:167]
buffer_load_dwordx4 v[88:91], v32, s[4:7], s90 offen offset:0 sc1
v_mfma_f32_16x16x32_bf16 v[168:171], a[196:199], v[48:51], v[168:171]
v_mfma_f32_16x16x32_bf16 v[172:175], a[196:199], v[52:55], v[172:175]
v_mfma_f32_16x16x32_bf16 v[176:179], a[196:199], v[56:59], v[176:179]
buffer_load_dwordx4 v[92:95], v32, s[4:7], s90 offen offset:1024 sc1
v_mfma_f32_16x16x32_bf16 v[180:183], a[196:199], v[60:63], v[180:183]
ds_read_b64_tr_b16 a[196:197], v11 offset:16384
ds_read_b64_tr_b16 a[198:199], v11 offset:24576
v_mfma_f32_16x16x32_bf16 v[184:187], a[200:203], v[40:43], v[184:187]
v_mfma_f32_16x16x32_bf16 v[188:191], a[200:203], v[44:47], v[188:191]
v_mfma_f32_16x16x32_bf16 v[192:195], a[200:203], v[48:51], v[192:195]
buffer_load_dwordx4 v[96:99], v32, s[4:7], s90 offen offset:2048 sc1
v_mfma_f32_16x16x32_bf16 v[196:199], a[200:203], v[52:55], v[196:199]
v_mfma_f32_16x16x32_bf16 v[200:203], a[200:203], v[56:59], v[200:203]
v_mfma_f32_16x16x32_bf16 v[204:207], a[200:203], v[60:63], v[204:207]
ds_read_b64_tr_b16 a[200:201], v10 offset:16448
ds_read_b64_tr_b16 a[202:203], v10 offset:24640
v_mfma_f32_16x16x32_bf16 v[208:211], a[204:207], v[40:43], v[208:211]
buffer_load_dwordx4 v[100:103], v32, s[4:7], s90 offen offset:3072 sc1
v_mfma_f32_16x16x32_bf16 v[212:215], a[204:207], v[44:47], v[212:215]
v_mfma_f32_16x16x32_bf16 v[216:219], a[204:207], v[48:51], v[216:219]
v_mfma_f32_16x16x32_bf16 v[220:223], a[204:207], v[52:55], v[220:223]
buffer_load_dwordx4 v[104:107], v33, s[4:7], s90 offen offset:0 sc1
v_mfma_f32_16x16x32_bf16 v[224:227], a[204:207], v[56:59], v[224:227]
v_mfma_f32_16x16x32_bf16 v[228:231], a[204:207], v[60:63], v[228:231]
ds_read_b64_tr_b16 a[204:205], v11 offset:16448
ds_read_b64_tr_b16 a[206:207], v11 offset:24640
v_mfma_f32_16x16x32_bf16 v[232:235], a[208:211], v[40:43], v[232:235]
v_mfma_f32_16x16x32_bf16 v[236:239], a[208:211], v[44:47], v[236:239]
buffer_load_dwordx4 v[108:111], v33, s[4:7], s90 offen offset:1024 sc1
v_mfma_f32_16x16x32_bf16 v[240:243], a[208:211], v[48:51], v[240:243]
v_mfma_f32_16x16x32_bf16 v[244:247], a[208:211], v[52:55], v[244:247]
v_mfma_f32_16x16x32_bf16 v[248:251], a[208:211], v[56:59], v[248:251]
s_add_u32 s53, s62, s97
s_lshr_b64 s[62:63], s[62:63], 4
v_mfma_f32_16x16x32_bf16 v[252:255], a[208:211], v[60:63], v[252:255]
ds_read_b64_tr_b16 a[208:209], v10 offset:16512
ds_read_b64_tr_b16 a[210:211], v10 offset:24704
v_mfma_f32_16x16x32_bf16 a[0:3], a[212:215], v[40:43], a[0:3]
s_bfe_u32 s32, s53, 0x20002
s_and_b32 s33, s53, 3
v_mfma_f32_16x16x32_bf16 a[4:7], a[212:215], v[44:47], a[4:7]
s_lshl_b32 s34, s32, 3
s_add_u32 s34, s34, s33
v_mfma_f32_16x16x32_bf16 a[8:11], a[212:215], v[48:51], a[8:11]
s_mul_i32 s96, s34, 40960
s_lshl_b32 s32, s32, 4
v_mfma_f32_16x16x32_bf16 a[12:15], a[212:215], v[52:55], a[12:15]
s_add_u32 s32, s32, s33
s_mul_i32 s88, s32, 6144
v_mfma_f32_16x16x32_bf16 a[32:35], a[212:215], v[56:59], a[32:35]
s_add_u32 m0, s54, 0
v_mfma_f32_16x16x32_bf16 a[36:39], a[212:215], v[60:63], a[36:39]
ds_read_b64_tr_b16 a[212:213], v12 offset:16384
ds_read_b64_tr_b16 a[214:215], v12 offset:24576
v_mfma_f32_16x16x32_bf16 a[40:43], a[216:219], v[40:43], a[40:43]
s_add_u32 s55, s96, 0
v_mfma_f32_16x16x32_bf16 a[44:47], a[216:219], v[44:47], a[44:47]
buffer_load_dwordx4 v5, s[92:95], s55 offen offset:0  lds
v_mfma_f32_16x16x32_bf16 a[64:67], a[216:219], v[48:51], a[64:67]
v_mfma_f32_16x16x32_bf16 a[68:71], a[216:219], v[52:55], a[68:71]
v_mfma_f32_16x16x32_bf16 a[72:75], a[216:219], v[56:59], a[72:75]
buffer_load_dwordx4 v6, s[92:95], s55 offen offset:1024  lds
v_mfma_f32_16x16x32_bf16 a[76:79], a[216:219], v[60:63], a[76:79]
ds_read_b64_tr_b16 a[216:217], v13 offset:16384
ds_read_b64_tr_b16 a[218:219], v13 offset:24576
v_mfma_f32_16x16x32_bf16 a[96:99], a[220:223], v[40:43], a[96:99]
v_mfma_f32_16x16x32_bf16 a[100:103], a[220:223], v[44:47], a[100:103]
v_mfma_f32_16x16x32_bf16 a[104:107], a[220:223], v[48:51], a[104:107]
buffer_load_dwordx4 v7, s[92:95], s55 offen offset:2048  lds
v_mfma_f32_16x16x32_bf16 a[108:111], a[220:223], v[52:55], a[108:111]
v_mfma_f32_16x16x32_bf16 a[128:131], a[220:223], v[56:59], a[128:131]
v_mfma_f32_16x16x32_bf16 a[132:135], a[220:223], v[60:63], a[132:135]
ds_read_b64_tr_b16 a[220:221], v12 offset:16448
ds_read_b64_tr_b16 a[222:223], v12 offset:24640
v_mfma_f32_16x16x32_bf16 a[136:139], a[224:227], v[40:43], a[136:139]
buffer_load_dwordx4 v8, s[92:95], s55 offen offset:3072  lds
v_mfma_f32_16x16x32_bf16 a[140:143], a[224:227], v[44:47], a[140:143]
v_mfma_f32_16x16x32_bf16 a[160:163], a[224:227], v[48:51], a[160:163]
v_mfma_f32_16x16x32_bf16 a[164:167], a[224:227], v[52:55], a[164:167]
s_add_u32 m0, s54, 4096
v_mfma_f32_16x16x32_bf16 a[168:171], a[224:227], v[56:59], a[168:171]
s_nop 0
v_mfma_f32_16x16x32_bf16 a[172:175], a[224:227], v[60:63], a[172:175]
ds_read_b64_tr_b16 a[224:225], v13 offset:16448
ds_read_b64_tr_b16 a[226:227], v13 offset:24640
v_mfma_f32_16x16x32_bf16 a[232:235], a[228:231], v[40:43], a[232:235]
buffer_load_dwordx4 v9, s[92:95], s55 offen offset:0  lds
v_mfma_f32_16x16x32_bf16 a[236:239], a[228:231], v[44:47], a[236:239]
v_mfma_f32_16x16x32_bf16 a[240:243], a[228:231], v[48:51], a[240:243]
v_mfma_f32_16x16x32_bf16 a[244:247], a[228:231], v[52:55], a[244:247]
v_mfma_f32_16x16x32_bf16 a[248:251], a[228:231], v[56:59], a[248:251]
v_mfma_f32_16x16x32_bf16 a[252:255], a[228:231], v[60:63], a[252:255]
ds_read_b64_tr_b16 a[228:229], v12 offset:16512
ds_read_b64_tr_b16 a[230:231], v12 offset:24704
s_waitcnt vmcnt(16) lgkmcnt(15)
v_mfma_f32_16x16x32_bf16 v[136:139], a[192:195], v[64:67], v[136:139]
v_mfma_f32_16x16x32_bf16 v[140:143], a[192:195], v[68:71], v[140:143]
v_mfma_f32_16x16x32_bf16 v[144:147], a[192:195], v[72:75], v[144:147]
v_mfma_f32_16x16x32_bf16 v[148:151], a[192:195], v[76:79], v[148:151]
v_mfma_f32_16x16x32_bf16 v[152:155], a[192:195], v[80:83], v[152:155]
s_waitcnt vmcnt(23) lgkmcnt(0)
v_mfma_f32_16x16x32_bf16 v[156:159], a[192:195], v[84:87], v[156:159]
s_barrier
v_mfma_f32_16x16x32_bf16 v[160:163], a[196:199], v[64:67], v[160:163]
ds_read_b64_tr_b16 a[192:193], v10 offset:32768
ds_read_b64_tr_b16 a[194:195], v10 offset:40960
v_mfma_f32_16x16x32_bf16 v[164:167], a[196:199], v[68:71], v[164:167]
buffer_load_dwordx4 v[112:115], v32, s[4:7], s91 offen offset:0 sc1
v_mfma_f32_16x16x32_bf16 v[168:171], a[196:199], v[72:75], v[168:171]
v_mfma_f32_16x16x32_bf16 v[172:175], a[196:199], v[76:79], v[172:175]
v_mfma_f32_16x16x32_bf16 v[176:179], a[196:199], v[80:83], v[176:179]
buffer_load_dwordx4 v[116:119], v32, s[4:7], s91 offen offset:1024 sc1
v_mfma_f32_16x16x32_bf16 v[180:183], a[196:199], v[84:87], v[180:183]
ds_read_b64_tr_b16 a[196:197], v11 offset:32768
ds_read_b64_tr_b16 a[198:199], v11 offset:40960
v_mfma_f32_16x16x32_bf16 v[184:187], a[200:203], v[64:67], v[184:187]
v_mfma_f32_16x16x32_bf16 v[188:191], a[200:203], v[68:71], v[188:191]
v_mfma_f32_16x16x32_bf16 v[192:195], a[200:203], v[72:75], v[192:195]
buffer_load_dwordx4 v[120:123], v32, s[4:7], s91 offen offset:2048 sc1
v_mfma_f32_16x16x32_bf16 v[196:199], a[200:203], v[76:79], v[196:199]
v_mfma_f32_16x16x32_bf16 v[200:203], a[200:203], v[80:83], v[200:203]
v_mfma_f32_16x16x32_bf16 v[204:207], a[200:203], v[84:87], v[204:207]
ds_read_b64_tr_b16 a[200:201], v10 offset:32832
ds_read_b64_tr_b16 a[202:203], v10 offset:41024
v_mfma_f32_16x16x32_bf16 v[208:211], a[204:207], v[64:67], v[208:211]
buffer_load_dwordx4 v[124:127], v32, s[4:7], s91 offen offset:3072 sc1
v_mfma_f32_16x16x32_bf16 v[212:215], a[204:207], v[68:71], v[212:215]
v_mfma_f32_16x16x32_bf16 v[216:219], a[204:207], v[72:75], v[216:219]
v_mfma_f32_16x16x32_bf16 v[220:223], a[204:207], v[76:79], v[220:223]
buffer_load_dwordx4 v[128:131], v33, s[4:7], s91 offen offset:0 sc1
v_mfma_f32_16x16x32_bf16 v[224:227], a[204:207], v[80:83], v[224:227]
v_mfma_f32_16x16x32_bf16 v[228:231], a[204:207], v[84:87], v[228:231]
ds_read_b64_tr_b16 a[204:205], v11 offset:32832
ds_read_b64_tr_b16 a[206:207], v11 offset:41024
v_mfma_f32_16x16x32_bf16 v[232:235], a[208:211], v[64:67], v[232:235]
v_mfma_f32_16x16x32_bf16 v[236:239], a[208:211], v[68:71], v[236:239]
buffer_load_dwordx4 v[132:135], v33, s[4:7], s91 offen offset:1024 sc1
v_mfma_f32_16x16x32_bf16 v[240:243], a[208:211], v[72:75], v[240:243]
v_mfma_f32_16x16x32_bf16 v[244:247], a[208:211], v[76:79], v[244:247]
v_mfma_f32_16x16x32_bf16 v[248:251], a[208:211], v[80:83], v[248:251]
s_add_u32 s53, s62, s97
s_lshr_b64 s[62:63], s[62:63], 4
v_mfma_f32_16x16x32_bf16 v[252:255], a[208:211], v[84:87], v[252:255]
ds_read_b64_tr_b16 a[208:209], v10 offset:32896
ds_read_b64_tr_b16 a[210:211], v10 offset:41088
v_mfma_f32_16x16x32_bf16 a[0:3], a[212:215], v[64:67], a[0:3]
s_bfe_u32 s32, s53, 0x20002
s_and_b32 s33, s53, 3
v_mfma_f32_16x16x32_bf16 a[4:7], a[212:215], v[68:71], a[4:7]
s_lshl_b32 s34, s32, 3
s_add_u32 s34, s34, s33
v_mfma_f32_16x16x32_bf16 a[8:11], a[212:215], v[72:75], a[8:11]
s_mul_i32 s96, s34, 40960
s_lshl_b32 s32, s32, 4
v_mfma_f32_16x16x32_bf16 a[12:15], a[212:215], v[76:79], a[12:15]
s_add_u32 s32, s32, s33
s_mul_i32 s89, s32, 6144
v_mfma_f32_16x16x32_bf16 a[32:35], a[212:215], v[80:83], a[32:35]
s_add_u32 m0, s54, 16384
v_mfma_f32_16x16x32_bf16 a[36:39], a[212:215], v[84:87], a[36:39]
ds_read_b64_tr_b16 a[212:213], v12 offset:32768
ds_read_b64_tr_b16 a[214:215], v12 offset:40960
v_mfma_f32_16x16x32_bf16 a[40:43], a[216:219], v[64:67], a[40:43]
s_add_u32 s55, s96, 0
v_mfma_f32_16x16x32_bf16 a[44:47], a[216:219], v[68:71], a[44:47]
buffer_load_dwordx4 v5, s[92:95], s55 offen offset:0  lds
v_mfma_f32_16x16x32_bf16 a[64:67], a[216:219], v[72:75], a[64:67]
v_mfma_f32_16x16x32_bf16 a[68:71], a[216:219], v[76:79], a[68:71]
v_mfma_f32_16x16x32_bf16 a[72:75], a[216:219], v[80:83], a[72:75]
buffer_load_dwordx4 v6, s[92:95], s55 offen offset:1024  lds
v_mfma_f32_16x16x32_bf16 a[76:79], a[216:219], v[84:87], a[76:79]
ds_read_b64_tr_b16 a[216:217], v13 offset:32768
ds_read_b64_tr_b16 a[218:219], v13 offset:40960
v_mfma_f32_16x16x32_bf16 a[96:99], a[220:223], v[64:67], a[96:99]
v_mfma_f32_16x16x32_bf16 a[100:103], a[220:223], v[68:71], a[100:103]
v_mfma_f32_16x16x32_bf16 a[104:107], a[220:223], v[72:75], a[104:107]
buffer_load_dwordx4 v7, s[92:95], s55 offen offset:2048  lds
v_mfma_f32_16x16x32_bf16 a[108:111], a[220:223], v[76:79], a[108:111]
v_mfma_f32_16x16x32_bf16 a[128:131], a[220:223], v[80:83], a[128:131]
v_mfma_f32_16x16x32_bf16 a[132:135], a[220:223], v[84:87], a[132:135]
ds_read_b64_tr_b16 a[220:221], v12 offset:32832
ds_read_b64_tr_b16 a[222:223], v12 offset:41024
v_mfma_f32_16x16x32_bf16 a[136:139], a[224:227], v[64:67], a[136:139]
buffer_load_dwordx4 v8, s[92:95], s55 offen offset:3072  lds
v_mfma_f32_16x16x32_bf16 a[140:143], a[224:227], v[68:71], a[140:143]
v_mfma_f32_16x16x32_bf16 a[160:163], a[224:227], v[72:75], a[160:163]
v_mfma_f32_16x16x32_bf16 a[164:167], a[224:227], v[76:79], a[164:167]
s_add_u32 m0, s54, 20480
v_mfma_f32_16x16x32_bf16 a[168:171], a[224:227], v[80:83], a[168:171]
s_nop 0
v_mfma_f32_16x16x32_bf16 a[172:175], a[224:227], v[84:87], a[172:175]
ds_read_b64_tr_b16 a[224:225], v13 offset:32832
ds_read_b64_tr_b16 a[226:227], v13 offset:41024
v_mfma_f32_16x16x32_bf16 a[232:235], a[228:231], v[64:67], a[232:235]
buffer_load_dwordx4 v9, s[92:95], s55 offen offset:0  lds
v_mfma_f32_16x16x32_bf16 a[236:239], a[228:231], v[68:71], a[236:239]
v_mfma_f32_16x16x32_bf16 a[240:243], a[228:231], v[72:75], a[240:243]
v_mfma_f32_16x16x32_bf16 a[244:247], a[228:231], v[76:79], a[244:247]
v_mfma_f32_16x16x32_bf16 a[248:251], a[228:231], v[80:83], a[248:251]
v_mfma_f32_16x16x32_bf16 a[252:255], a[228:231], v[84:87], a[252:255]
ds_read_b64_tr_b16 a[228:229], v12 offset:32896
ds_read_b64_tr_b16 a[230:231], v12 offset:41088
s_waitcnt vmcnt(16) lgkmcnt(15)
v_mfma_f32_16x16x32_bf16 v[136:139], a[192:195], v[88:91], v[136:139]
v_mfma_f32_16x16x32_bf16 v[140:143], a[192:195], v[92:95], v[140:143]
v_mfma_f32_16x16x32_bf16 v[144:147], a[192:195], v[96:99], v[144:147]
v_mfma_f32_16x16x32_bf16 v[148:151], a[192:195], v[100:103], v[148:151]
v_mfma_f32_16x16x32_bf16 v[152:155], a[192:195], v[104:107], v[152:155]
s_waitcnt vmcnt(22) lgkmcnt(0)
v_mfma_f32_16x16x32_bf16 v[156:159], a[192:195], v[108:111], v[156:159]
s_barrier
v_mfma_f32_16x16x32_bf16 v[160:163], a[196:199], v[88:91], v[160:163]
ds_read_b64_tr_b16 a[192:193], v10 offset:49152
ds_read_b64_tr_b16 a[194:195], v10 offset:57344
v_mfma_f32_16x16x32_bf16 v[164:167], a[196:199], v[92:95], v[164:167]
buffer_load_dwordx4 v[40:43], v32, s[4:7], s88 offen offset:0 sc1
v_mfma_f32_16x16x32_bf16 v[168:171], a[196:199], v[96:99], v[168:171]
v_mfma_f32_16x16x32_bf16 v[172:175], a[196:199], v[100:103], v[172:175]
buffer_load_dwordx4 v[44:47], v32, s[4:7], s88 offen offset:1024 sc1
v_mfma_f32_16x16x32_bf16 v[176:179], a[196:199], v[104:107], v[176:179]
v_mfma_f32_16x16x32_bf16 v[180:183], a[196:199], v[108:111], v[180:183]
ds_read_b64_tr_b16 a[196:197], v11 offset:49152
ds_read_b64_tr_b16 a[198:199], v11 offset:57344
v_mfma_f32_16x16x32_bf16 v[184:187], a[200:203], v[88:91], v[184:187]
buffer_load_dwordx4 v[48:51], v32, s[4:7], s88 offen offset:2048 sc1
v_mfma_f32_16x16x32_bf16 v[188:191], a[200:203], v[92:95], v[188:191]
v_mfma_f32_16x16x32_bf16 v[192:195], a[200:203], v[96:99], v[192:195]
buffer_load_dwordx4 v[52:55], v32, s[4:7], s88 offen offset:3072 sc1
v_mfma_f32_16x16x32_bf16 v[196:199], a[200:203], v[100:103], v[196:199]
v_mfma_f32_16x16x32_bf16 v[200:203], a[200:203], v[104:107], v[200:203]
buffer_load_dwordx4 v[56:59], v33, s[4:7], s88 offen offset:0 sc1
v_mfma_f32_16x16x32_bf16 v[204:207], a[200:203], v[108:111], v[204:207]
ds_read_b64_tr_b16 a[200:201], v10 offset:49216
ds_read_b64_tr_b16 a[202:203], v10 offset:57408
v_mfma_f32_16x16x32_bf16 v[208:211], a[204:207], v[88:91], v[208:211]
v_mfma_f32_16x16x32_bf16 v[212:215], a[204:207], v[92:95], v[212:215]
buffer_load_dwordx4 v[60:63], v33, s[4:7], s88 offen offset:1024 sc1
v_mfma_f32_16x16x32_bf16 v[216:219], a[204:207], v[96:99], v[216:219]
v_mfma_f32_16x16x32_bf16 v[220:223], a[204:207], v[100:103], v[220:223]
s_add_u32 s53, s62, s97
s_lshr_b64 s[62:63], s[62:63], 4
v_mfma_f32_16x16x32_bf16 v[224:227], a[204:207], v[104:107], v[224:227]
s_bfe_u32 s32, s53, 0x20002
s_and_b32 s33, s53, 3
v_mfma_f32_16x16x32_bf16 v[228:231], a[204:207], v[108:111], v[228:231]
ds_read_b64_tr_b16 a[204:205], v11 offset:49216
ds_read_b64_tr_b16 a[206:207], v11 offset:57408
v_mfma_f32_16x16x32_bf16 v[232:235], a[208:211], v[88:91], v[232:235]
s_lshl_b32 s34, s32, 3
s_add_u32 s34, s34, s33
v_mfma_f32_16x16x32_bf16 v[236:239], a[208:211], v[92:95], v[236:239]
s_mul_i32 s96, s34, 40960
s_lshl_b32 s32, s32, 4
v_mfma_f32_16x16x32_bf16 v[240:243], a[208:211], v[96:99], v[240:243]
s_add_u32 s32, s32, s33
s_mul_i32 s90, s32, 6144
v_mfma_f32_16x16x32_bf16 v[244:247], a[208:211], v[100:103], v[244:247]
s_add_u32 m0, s54, 32768
v_mfma_f32_16x16x32_bf16 v[248:251], a[208:211], v[104:107], v[248:251]
s_add_u32 s55, s96, 0
v_mfma_f32_16x16x32_bf16 v[252:255], a[208:211], v[108:111], v[252:255]
ds_read_b64_tr_b16 a[208:209], v10 offset:49280
ds_read_b64_tr_b16 a[210:211], v10 offset:57472
v_mfma_f32_16x16x32_bf16 a[0:3], a[212:215], v[88:91], a[0:3]
buffer_load_dwordx4 v5, s[92:95], s55 offen offset:0  lds
v_mfma_f32_16x16x32_bf16 a[4:7], a[212:215], v[92:95], a[4:7]
v_mfma_f32_16x16x32_bf16 a[8:11], a[212:215], v[96:99], a[8:11]
buffer_load_dwordx4 v6, s[92:95], s55 offen offset:1024  lds
v_mfma_f32_16x16x32_bf16 a[12:15], a[212:215], v[100:103], a[12:15]
v_mfma_f32_16x16x32_bf16 a[32:35], a[212:215], v[104:107], a[32:35]
buffer_load_dwordx4 v7, s[92:95], s55 offen offset:2048  lds
v_mfma_f32_16x16x32_bf16 a[36:39], a[212:215], v[108:111], a[36:39]
ds_read_b64_tr_b16 a[212:213], v12 offset:49152
ds_read_b64_tr_b16 a[214:215], v12 offset:57344
v_mfma_f32_16x16x32_bf16 a[40:43], a[216:219], v[88:91], a[40:43]
v_mfma_f32_16x16x32_bf16 a[44:47], a[216:219], v[92:95], a[44:47]
buffer_load_dwordx4 v8, s[92:95], s55 offen offset:3072  lds
v_mfma_f32_16x16x32_bf16 a[64:67], a[216:219], v[96:99], a[64:67]
v_mfma_f32_16x16x32_bf16 a[68:71], a[216:219], v[100:103], a[68:71]
s_add_u32 m0, s54, 36864
v_mfma_f32_16x16x32_bf16 a[72:75], a[216:219], v[104:107], a[72:75]
s_nop 0
v_mfma_f32_16x16x32_bf16 a[76:79], a[216:219], v[108:111], a[76:79]
ds_read_b64_tr_b16 a[216:217], v13 offset:49152
ds_read_b64_tr_b16 a[218:219], v13 offset:57344
v_mfma_f32_16x16x32_bf16 a[96:99], a[220:223], v[88:91], a[96:99]
buffer_load_dwordx4 v9, s[92:95], s55 offen offset:0  lds
v_mfma_f32_16x16x32_bf16 a[100:103], a[220:223], v[92:95], a[100:103]
v_mfma_f32_16x16x32_bf16 a[104:107], a[220:223], v[96:99], a[104:107]
buffer_load_dwordx4 a[48:51], v32, s[4:7], s90 offen offset:0 sc1
v_mfma_f32_16x16x32_bf16 a[108:111], a[220:223], v[100:103], a[108:111]
v_mfma_f32_16x16x32_bf16 a[128:131], a[220:223], v[104:107], a[128:131]
buffer_load_dwordx4 a[52:55], v32, s[4:7], s90 offen offset:1024 sc1
v_mfma_f32_16x16x32_bf16 a[132:135], a[220:223], v[108:111], a[132:135]
ds_read_b64_tr_b16 a[220:221], v12 offset:49216
ds_read_b64_tr_b16 a[222:223], v12 offset:57408
v_mfma_f32_16x16x32_bf16 a[136:139], a[224:227], v[88:91], a[136:139]
v_mfma_f32_16x16x32_bf16 a[140:143], a[224:227], v[92:95], a[140:143]
buffer_load_dwordx4 a[56:59], v32, s[4:7], s90 offen offset:2048 sc1
v_mfma_f32_16x16x32_bf16 a[160:163], a[224:227], v[96:99], a[160:163]
v_mfma_f32_16x16x32_bf16 a[164:167], a[224:227], v[100:103], a[164:167]
buffer_load_dwordx4 a[60:63], v32, s[4:7], s90 offen offset:3072 sc1
v_mfma_f32_16x16x32_bf16 a[168:171], a[224:227], v[104:107], a[168:171]
v_mfma_f32_16x16x32_bf16 a[172:175], a[224:227], v[108:111], a[172:175]
ds_read_b64_tr_b16 a[224:225], v13 offset:49216
ds_read_b64_tr_b16 a[226:227], v13 offset:57408
v_mfma_f32_16x16x32_bf16 a[232:235], a[228:231], v[88:91], a[232:235]
buffer_load_dwordx4 a[80:83], v33, s[4:7], s90 offen offset:0 sc1
v_mfma_f32_16x16x32_bf16 a[236:239], a[228:231], v[92:95], a[236:239]
v_mfma_f32_16x16x32_bf16 a[240:243], a[228:231], v[96:99], a[240:243]
buffer_load_dwordx4 a[84:87], v33, s[4:7], s90 offen offset:1024 sc1
v_mfma_f32_16x16x32_bf16 a[244:247], a[228:231], v[100:103], a[244:247]
v_mfma_f32_16x16x32_bf16 a[248:251], a[228:231], v[104:107], a[248:251]
v_mfma_f32_16x16x32_bf16 a[252:255], a[228:231], v[108:111], a[252:255]
ds_read_b64_tr_b16 a[228:229], v12 offset:49280
ds_read_b64_tr_b16 a[230:231], v12 offset:57472
s_waitcnt vmcnt(22) lgkmcnt(15)
v_mfma_f32_16x16x32_bf16 v[136:139], a[192:195], v[112:115], v[136:139]
v_mfma_f32_16x16x32_bf16 v[140:143], a[192:195], v[116:119], v[140:143]
v_mfma_f32_16x16x32_bf16 v[144:147], a[192:195], v[120:123], v[144:147]
v_mfma_f32_16x16x32_bf16 v[148:151], a[192:195], v[124:127], v[148:151]
v_mfma_f32_16x16x32_bf16 v[152:155], a[192:195], v[128:131], v[152:155]
s_waitcnt vmcnt(28) lgkmcnt(0)
v_mfma_f32_16x16x32_bf16 v[156:159], a[192:195], v[132:135], v[156:159]
s_barrier
v_mfma_f32_16x16x32_bf16 v[160:163], a[196:199], v[112:115], v[160:163]
ds_read_b64_tr_b16 a[192:193], v10 offset:0
ds_read_b64_tr_b16 a[194:195], v10 offset:8192
v_mfma_f32_16x16x32_bf16 v[164:167], a[196:199], v[116:119], v[164:167]
buffer_load_dwordx4 v[64:67], v32, s[4:7], s89 offen offset:0 sc1
v_mfma_f32_16x16x32_bf16 v[168:171], a[196:199], v[120:123], v[168:171]
v_mfma_f32_16x16x32_bf16 v[172:175], a[196:199], v[124:127], v[172:175]
buffer_load_dwordx4 v[68:71], v32, s[4:7], s89 offen offset:1024 sc1
v_mfma_f32_16x16x32_bf16 v[176:179], a[196:199], v[128:131], v[176:179]
v_mfma_f32_16x16x32_bf16 v[180:183], a[196:199], v[132:135], v[180:183]
ds_read_b64_tr_b16 a[196:197], v11 offset:0
ds_read_b64_tr_b16 a[198:199], v11 offset:8192
v_mfma_f32_16x16x32_bf16 v[184:187], a[200:203], v[112:115], v[184:187]
buffer_load_dwordx4 v[72:75], v32, s[4:7], s89 offen offset:2048 sc1
v_mfma_f32_16x16x32_bf16 v[188:191], a[200:203], v[116:119], v[188:191]
v_mfma_f32_16x16x32_bf16 v[192:195], a[200:203], v[120:123], v[192:195]
buffer_load_dwordx4 v[76:79], v32, s[4:7], s89 offen offset:3072 sc1
v_mfma_f32_16x16x32_bf16 v[196:199], a[200:203], v[124:127], v[196:199]
v_mfma_f32_16x16x32_bf16 v[200:203], a[200:203], v[128:131], v[200:203]
buffer_load_dwordx4 v[80:83], v33, s[4:7], s89 offen offset:0 sc1
v_mfma_f32_16x16x32_bf16 v[204:207], a[200:203], v[132:135], v[204:207]
ds_read_b64_tr_b16 a[200:201], v10 offset:64
ds_read_b64_tr_b16 a[202:203], v10 offset:8256
v_mfma_f32_16x16x32_bf16 v[208:211], a[204:207], v[112:115], v[208:211]
v_mfma_f32_16x16x32_bf16 v[212:215], a[204:207], v[116:119], v[212:215]
buffer_load_dwordx4 v[84:87], v33, s[4:7], s89 offen offset:1024 sc1
v_mfma_f32_16x16x32_bf16 v[216:219], a[204:207], v[120:123], v[216:219]
v_mfma_f32_16x16x32_bf16 v[220:223], a[204:207], v[124:127], v[220:223]
s_add_u32 s53, s62, s97
s_lshr_b64 s[62:63], s[62:63], 4
v_mfma_f32_16x16x32_bf16 v[224:227], a[204:207], v[128:131], v[224:227]
s_bfe_u32 s32, s53, 0x20002
s_and_b32 s33, s53, 3
v_mfma_f32_16x16x32_bf16 v[228:231], a[204:207], v[132:135], v[228:231]
ds_read_b64_tr_b16 a[204:205], v11 offset:64
ds_read_b64_tr_b16 a[206:207], v11 offset:8256
v_mfma_f32_16x16x32_bf16 v[232:235], a[208:211], v[112:115], v[232:235]
s_lshl_b32 s34, s32, 3
s_add_u32 s34, s34, s33
v_mfma_f32_16x16x32_bf16 v[236:239], a[208:211], v[116:119], v[236:239]
s_mul_i32 s96, s34, 40960
s_lshl_b32 s32, s32, 4
v_mfma_f32_16x16x32_bf16 v[240:243], a[208:211], v[120:123], v[240:243]
s_add_u32 s32, s32, s33
s_mul_i32 s91, s32, 6144
v_mfma_f32_16x16x32_bf16 v[244:247], a[208:211], v[124:127], v[244:247]
s_add_u32 m0, s54, 49152
v_mfma_f32_16x16x32_bf16 v[248:251], a[208:211], v[128:131], v[248:251]
s_add_u32 s55, s96, 0
v_mfma_f32_16x16x32_bf16 v[252:255], a[208:211], v[132:135], v[252:255]
ds_read_b64_tr_b16 a[208:209], v10 offset:128
ds_read_b64_tr_b16 a[210:211], v10 offset:8320
v_mfma_f32_16x16x32_bf16 a[0:3], a[212:215], v[112:115], a[0:3]
buffer_load_dwordx4 v5, s[92:95], s55 offen offset:0  lds
v_mfma_f32_16x16x32_bf16 a[4:7], a[212:215], v[116:119], a[4:7]
v_mfma_f32_16x16x32_bf16 a[8:11], a[212:215], v[120:123], a[8:11]
buffer_load_dwordx4 v6, s[92:95], s55 offen offset:1024  lds
v_mfma_f32_16x16x32_bf16 a[12:15], a[212:215], v[124:127], a[12:15]
v_mfma_f32_16x16x32_bf16 a[32:35], a[212:215], v[128:131], a[32:35]
buffer_load_dwordx4 v7, s[92:95], s55 offen offset:2048  lds
v_mfma_f32_16x16x32_bf16 a[36:39], a[212:215], v[132:135], a[36:39]
ds_read_b64_tr_b16 a[212:213], v12 offset:0
ds_read_b64_tr_b16 a[214:215], v12 offset:8192
v_mfma_f32_16x16x32_bf16 a[40:43], a[216:219], v[112:115], a[40:43]
v_mfma_f32_16x16x32_bf16 a[44:47], a[216:219], v[116:119], a[44:47]
buffer_load_dwordx4 v8, s[92:95], s55 offen offset:3072  lds
v_mfma_f32_16x16x32_bf16 a[64:67], a[216:219], v[120:123], a[64:67]
v_mfma_f32_16x16x32_bf16 a[68:71], a[216:219], v[124:127], a[68:71]
s_add_u32 m0, s54, 53248
v_mfma_f32_16x16x32_bf16 a[72:75], a[216:219], v[128:131], a[72:75]
s_nop 0
v_mfma_f32_16x16x32_bf16 a[76:79], a[216:219], v[132:135], a[76:79]
ds_read_b64_tr_b16 a[216:217], v13 offset:0
ds_read_b64_tr_b16 a[218:219], v13 offset:8192
v_mfma_f32_16x16x32_bf16 a[96:99], a[220:223], v[112:115], a[96:99]
buffer_load_dwordx4 v9, s[92:95], s55 offen offset:0  lds
v_mfma_f32_16x16x32_bf16 a[100:103], a[220:223], v[116:119], a[100:103]
v_mfma_f32_16x16x32_bf16 a[104:107], a[220:223], v[120:123], a[104:107]
buffer_load_dwordx4 a[88:91], v32, s[4:7], s91 offen offset:0 sc1
v_mfma_f32_16x16x32_bf16 a[108:111], a[220:223], v[124:127], a[108:111]
v_mfma_f32_16x16x32_bf16 a[128:131], a[220:223], v[128:131], a[128:131]
buffer_load_dwordx4 a[92:95], v32, s[4:7], s91 offen offset:1024 sc1
v_mfma_f32_16x16x32_bf16 a[132:135], a[220:223], v[132:135], a[132:135]
ds_read_b64_tr_b16 a[220:221], v12 offset:64
ds_read_b64_tr_b16 a[222:223], v12 offset:8256
v_mfma_f32_16x16x32_bf16 a[136:139], a[224:227], v[112:115], a[136:139]
v_mfma_f32_16x16x32_bf16 a[140:143], a[224:227], v[116:119], a[140:143]
buffer_load_dwordx4 a[112:115], v32, s[4:7], s91 offen offset:2048 sc1
v_mfma_f32_16x16x32_bf16 a[160:163], a[224:227], v[120:123], a[160:163]
v_mfma_f32_16x16x32_bf16 a[164:167], a[224:227], v[124:127], a[164:167]
buffer_load_dwordx4 a[116:119], v32, s[4:7], s91 offen offset:3072 sc1
v_mfma_f32_16x16x32_bf16 a[168:171], a[224:227], v[128:131], a[168:171]
v_mfma_f32_16x16x32_bf16 a[172:175], a[224:227], v[132:135], a[172:175]
ds_read_b64_tr_b16 a[224:225], v13 offset:64
ds_read_b64_tr_b16 a[226:227], v13 offset:8256
v_mfma_f32_16x16x32_bf16 a[232:235], a[228:231], v[112:115], a[232:235]
buffer_load_dwordx4 a[120:123], v33, s[4:7], s91 offen offset:0 sc1
v_mfma_f32_16x16x32_bf16 a[236:239], a[228:231], v[116:119], a[236:239]
v_mfma_f32_16x16x32_bf16 a[240:243], a[228:231], v[120:123], a[240:243]
buffer_load_dwordx4 a[124:127], v33, s[4:7], s91 offen offset:1024 sc1
v_mfma_f32_16x16x32_bf16 a[244:247], a[228:231], v[124:127], a[244:247]
v_mfma_f32_16x16x32_bf16 a[248:251], a[228:231], v[128:131], a[248:251]
v_mfma_f32_16x16x32_bf16 a[252:255], a[228:231], v[132:135], a[252:255]
ds_read_b64_tr_b16 a[228:229], v12 offset:128
ds_read_b64_tr_b16 a[230:231], v12 offset:8320
s_waitcnt vmcnt(28) lgkmcnt(15)
v_mfma_f32_16x16x32_bf16 v[136:139], a[192:195], v[40:43], v[136:139]
v_mfma_f32_16x16x32_bf16 v[140:143], a[192:195], v[44:47], v[140:143]
v_mfma_f32_16x16x32_bf16 v[144:147], a[192:195], v[48:51], v[144:147]
v_mfma_f32_16x16x32_bf16 v[148:151], a[192:195], v[52:55], v[148:151]
v_mfma_f32_16x16x32_bf16 v[152:155], a[192:195], v[56:59], v[152:155]
s_waitcnt vmcnt(34) lgkmcnt(0)
v_mfma_f32_16x16x32_bf16 v[156:159], a[192:195], v[60:63], v[156:159]
s_barrier
v_mfma_f32_16x16x32_bf16 v[160:163], a[196:199], v[40:43], v[160:163]
ds_read_b64_tr_b16 a[192:193], v10 offset:16384
ds_read_b64_tr_b16 a[194:195], v10 offset:24576
v_mfma_f32_16x16x32_bf16 v[164:167], a[196:199], v[44:47], v[164:167]
s_lshl_b32 s34, s42, 18
s_add_u32 s34, s34, 33554432
v_mfma_f32_16x16x32_bf16 v[168:171], a[196:199], v[48:51], v[168:171]
s_add_u32 s12, s44, s34
s_addc_u32 s13, s45, 0
v_mfma_f32_16x16x32_bf16 v[172:175], a[196:199], v[52:55], v[172:175]
s_cmp_eq_u32 s20, s28
s_cselect_b32 s14, 0, 0x40000
v_mfma_f32_16x16x32_bf16 v[176:179], a[196:199], v[56:59], v[176:179]
s_mov_b32 s15, 0x20000
v_mfma_f32_16x16x32_bf16 v[180:183], a[196:199], v[60:63], v[180:183]
ds_read_b64_tr_b16 a[196:197], v11 offset:16384
ds_read_b64_tr_b16 a[198:199], v11 offset:24576
v_mfma_f32_16x16x32_bf16 v[184:187], a[200:203], v[40:43], v[184:187]
s_lshl_b32 s52, s20, 2
s_add_u32 s52, s52, s28
v_mfma_f32_16x16x32_bf16 v[188:191], a[200:203], v[44:47], v[188:191]
s_lshl_b32 s52, s52, 14
s_lshl_b32 s42, s42, 2
v_mfma_f32_16x16x32_bf16 v[192:195], a[200:203], v[48:51], v[192:195]
s_xor_b32 s34, s54, 0x10000
v_add_u32 v16, s54, v32
v_mfma_f32_16x16x32_bf16 v[196:199], a[200:203], v[52:55], v[196:199]
v_add_u32 v20, s34, v32
s_lshl_b32 s34, s20, 13
v_mfma_f32_16x16x32_bf16 v[200:203], a[200:203], v[56:59], v[200:203]
s_add_u32 s34, s34, 131072
s_xor_b32 s35, s34, 0x4000
v_mfma_f32_16x16x32_bf16 v[204:207], a[200:203], v[60:63], v[204:207]
ds_read_b64_tr_b16 a[200:201], v10 offset:16448
ds_read_b64_tr_b16 a[202:203], v10 offset:24640
v_mfma_f32_16x16x32_bf16 v[208:211], a[204:207], v[40:43], v[208:211]
v_add_u32 v17, s34, v32
v_add_u32 v21, s35, v32
v_mfma_f32_16x16x32_bf16 v[212:215], a[204:207], v[44:47], v[212:215]
v_mfma_f32_16x16x32_bf16 v[216:219], a[204:207], v[48:51], v[216:219]
v_mfma_f32_16x16x32_bf16 v[220:223], a[204:207], v[52:55], v[220:223]
v_mfma_f32_16x16x32_bf16 v[224:227], a[204:207], v[56:59], v[224:227]
v_mfma_f32_16x16x32_bf16 v[228:231], a[204:207], v[60:63], v[228:231]
ds_read_b64_tr_b16 a[204:205], v11 offset:16448
ds_read_b64_tr_b16 a[206:207], v11 offset:24640
v_mfma_f32_16x16x32_bf16 v[232:235], a[208:211], v[40:43], v[232:235]
v_mfma_f32_16x16x32_bf16 v[236:239], a[208:211], v[44:47], v[236:239]
v_mfma_f32_16x16x32_bf16 v[240:243], a[208:211], v[48:51], v[240:243]
v_mfma_f32_16x16x32_bf16 v[244:247], a[208:211], v[52:55], v[244:247]
v_mfma_f32_16x16x32_bf16 v[248:251], a[208:211], v[56:59], v[248:251]
v_mfma_f32_16x16x32_bf16 v[252:255], a[208:211], v[60:63], v[252:255]
ds_read_b64_tr_b16 a[208:209], v10 offset:16512
ds_read_b64_tr_b16 a[210:211], v10 offset:24704
v_mfma_f32_16x16x32_bf16 a[0:3], a[212:215], v[40:43], a[0:3]
v_mfma_f32_16x16x32_bf16 a[4:7], a[212:215], v[44:47], a[4:7]
v_mfma_f32_16x16x32_bf16 a[8:11], a[212:215], v[48:51], a[8:11]
v_mfma_f32_16x16x32_bf16 a[12:15], a[212:215], v[52:55], a[12:15]
v_mfma_f32_16x16x32_bf16 a[32:35], a[212:215], v[56:59], a[32:35]
v_mfma_f32_16x16x32_bf16 a[36:39], a[212:215], v[60:63], a[36:39]
ds_read_b64_tr_b16 a[212:213], v12 offset:16384
ds_read_b64_tr_b16 a[214:215], v12 offset:24576
v_mfma_f32_16x16x32_bf16 a[40:43], a[216:219], v[40:43], a[40:43]
v_mfma_f32_16x16x32_bf16 a[44:47], a[216:219], v[44:47], a[44:47]
v_mfma_f32_16x16x32_bf16 a[64:67], a[216:219], v[48:51], a[64:67]
v_mfma_f32_16x16x32_bf16 a[68:71], a[216:219], v[52:55], a[68:71]
v_mfma_f32_16x16x32_bf16 a[72:75], a[216:219], v[56:59], a[72:75]
v_mfma_f32_16x16x32_bf16 a[76:79], a[216:219], v[60:63], a[76:79]
ds_read_b64_tr_b16 a[216:217], v13 offset:16384
ds_read_b64_tr_b16 a[218:219], v13 offset:24576
v_mfma_f32_16x16x32_bf16 a[96:99], a[220:223], v[40:43], a[96:99]
v_mfma_f32_16x16x32_bf16 a[100:103], a[220:223], v[44:47], a[100:103]
v_mfma_f32_16x16x32_bf16 a[104:107], a[220:223], v[48:51], a[104:107]
v_mfma_f32_16x16x32_bf16 a[108:111], a[220:223], v[52:55], a[108:111]
v_mfma_f32_16x16x32_bf16 a[128:131], a[220:223], v[56:59], a[128:131]
v_mfma_f32_16x16x32_bf16 a[132:135], a[220:223], v[60:63], a[132:135]
ds_read_b64_tr_b16 a[220:221], v12 offset:16448
ds_read_b64_tr_b16 a[222:223], v12 offset:24640
v_mfma_f32_16x16x32_bf16 a[136:139], a[224:227], v[40:43], a[136:139]
s_waitcnt vmcnt(0)
v_mfma_f32_16x16x32_bf16 a[140:143], a[224:227], v[44:47], a[140:143]
s_barrier
v_mfma_f32_16x16x32_bf16 a[160:163], a[224:227], v[48:51], a[160:163]
ds_read_b64_tr_b16 a[16:17], v12 offset:32768
ds_read_b64_tr_b16 a[18:19], v12 offset:40960
v_mfma_f32_16x16x32_bf16 a[164:167], a[224:227], v[52:55], a[164:167]
ds_read_b64_tr_b16 a[20:21], v12 offset:49152
ds_read_b64_tr_b16 a[22:23], v12 offset:57344
v_mfma_f32_16x16x32_bf16 a[168:171], a[224:227], v[56:59], a[168:171]
v_mfma_f32_16x16x32_bf16 a[172:175], a[224:227], v[60:63], a[172:175]
ds_read_b64_tr_b16 a[224:225], v13 offset:16448
ds_read_b64_tr_b16 a[226:227], v13 offset:24640
v_mfma_f32_16x16x32_bf16 a[232:235], a[228:231], v[40:43], a[232:235]
v_mfma_f32_16x16x32_bf16 a[236:239], a[228:231], v[44:47], a[236:239]
v_mfma_f32_16x16x32_bf16 a[240:243], a[228:231], v[48:51], a[240:243]
v_mfma_f32_16x16x32_bf16 a[244:247], a[228:231], v[52:55], a[244:247]
v_mfma_f32_16x16x32_bf16 a[248:251], a[228:231], v[56:59], a[248:251]
v_mfma_f32_16x16x32_bf16 a[252:255], a[228:231], v[60:63], a[252:255]
ds_read_b64_tr_b16 a[228:229], v12 offset:16512
ds_read_b64_tr_b16 a[230:231], v12 offset:24704
s_waitcnt lgkmcnt(0)
v_mfma_f32_16x16x32_bf16 a[0:3], a[212:215], v[64:67], a[0:3]
ds_read_b64_tr_b16 a[24:25], v10 offset:32768
ds_read_b64_tr_b16 a[26:27], v10 offset:40960
v_mfma_f32_16x16x32_bf16 a[0:3], a[16:19], a[48:51], a[0:3]
ds_read_b64_tr_b16 a[28:29], v10 offset:49152
ds_read_b64_tr_b16 a[30:31], v10 offset:57344
v_mfma_f32_16x16x32_bf16 a[0:3], a[20:23], a[88:91], a[0:3]
v_mfma_f32_16x16x32_bf16 a[4:7], a[212:215], v[68:71], a[4:7]
v_mfma_f32_16x16x32_bf16 a[4:7], a[16:19], a[52:55], a[4:7]
v_mfma_f32_16x16x32_bf16 a[4:7], a[20:23], a[92:95], a[4:7]
v_mfma_f32_16x16x32_bf16 a[8:11], a[212:215], v[72:75], a[8:11]
v_mfma_f32_16x16x32_bf16 a[8:11], a[16:19], a[56:59], a[8:11]
v_mfma_f32_16x16x32_bf16 a[8:11], a[20:23], a[112:115], a[8:11]
s_waitcnt lgkmcnt(0)
v_mfma_f32_16x16x32_bf16 a[12:15], a[212:215], v[76:79], a[12:15]
ds_write_b128 v16, a[0:3] offset:0
v_mfma_f32_16x16x32_bf16 a[12:15], a[16:19], a[60:63], a[12:15]
v_mfma_f32_16x16x32_bf16 a[12:15], a[20:23], a[116:119], a[12:15]
v_mfma_f32_16x16x32_bf16 a[32:35], a[212:215], v[80:83], a[32:35]
v_mfma_f32_16x16x32_bf16 a[32:35], a[16:19], a[80:83], a[32:35]
ds_write_b128 v16, a[4:7] offset:1024
v_mfma_f32_16x16x32_bf16 a[32:35], a[20:23], a[120:123], a[32:35]
v_mfma_f32_16x16x32_bf16 a[36:39], a[212:215], v[84:87], a[36:39]
v_mfma_f32_16x16x32_bf16 a[36:39], a[16:19], a[84:87], a[36:39]
v_mfma_f32_16x16x32_bf16 a[36:39], a[20:23], a[124:127], a[36:39]
ds_write_b128 v16, a[8:11] offset:2048
v_mfma_f32_16x16x32_bf16 v[136:139], a[192:195], v[64:67], v[136:139]
ds_read_b64_tr_b16 a[16:17], v13 offset:32768
ds_read_b64_tr_b16 a[18:19], v13 offset:40960
v_mfma_f32_16x16x32_bf16 v[136:139], a[24:27], a[48:51], v[136:139]
ds_read_b64_tr_b16 a[20:21], v13 offset:49152
ds_read_b64_tr_b16 a[22:23], v13 offset:57344
v_mfma_f32_16x16x32_bf16 v[136:139], a[28:31], a[88:91], v[136:139]
v_mfma_f32_16x16x32_bf16 v[140:143], a[192:195], v[68:71], v[140:143]
ds_write_b128 v16, a[12:15] offset:3072
v_mfma_f32_16x16x32_bf16 v[140:143], a[24:27], a[52:55], v[140:143]
v_mfma_f32_16x16x32_bf16 v[140:143], a[28:31], a[92:95], v[140:143]
v_mfma_f32_16x16x32_bf16 v[144:147], a[192:195], v[72:75], v[144:147]
v_mfma_f32_16x16x32_bf16 v[144:147], a[24:27], a[56:59], v[144:147]
ds_write_b128 v16, a[32:35] offset:4096
v_mfma_f32_16x16x32_bf16 v[144:147], a[28:31], a[112:115], v[144:147]
v_mfma_f32_16x16x32_bf16 v[148:151], a[192:195], v[76:79], v[148:151]
v_mfma_f32_16x16x32_bf16 v[148:151], a[24:27], a[60:63], v[148:151]
v_mfma_f32_16x16x32_bf16 v[148:151], a[28:31], a[116:119], v[148:151]
ds_write_b128 v16, a[36:39] offset:5120
v_mfma_f32_16x16x32_bf16 v[152:155], a[192:195], v[80:83], v[152:155]
v_mfma_f32_16x16x32_bf16 v[152:155], a[24:27], a[80:83], v[152:155]
v_mfma_f32_16x16x32_bf16 v[152:155], a[28:31], a[120:123], v[152:155]
v_mfma_f32_16x16x32_bf16 v[156:159], a[192:195], v[84:87], v[156:159]
v_mfma_f32_16x16x32_bf16 v[156:159], a[24:27], a[84:87], v[156:159]
v_mfma_f32_16x16x32_bf16 v[156:159], a[28:31], a[124:127], v[156:159]
s_waitcnt lgkmcnt(0)
s_barrier
v_mfma_f32_16x16x32_bf16 a[40:43], a[216:219], v[64:67], a[40:43]
ds_read_b64_tr_b16 a[24:25], v11 offset:32768
ds_read_b64_tr_b16 a[26:27], v11 offset:40960
v_mfma_f32_16x16x32_bf16 a[40:43], a[16:19], a[48:51], a[40:43]
ds_read_b64_tr_b16 a[28:29], v11 offset:49152
ds_read_b64_tr_b16 a[30:31], v11 offset:57344
v_mfma_f32_16x16x32_bf16 a[40:43], a[20:23], a[88:91], a[40:43]
ds_read_b128 v[40:43], v20 offset:0
ds_read_b128 v[44:47], v20 offset:1024
v_mfma_f32_16x16x32_bf16 a[44:47], a[216:219], v[68:71], a[44:47]
ds_read_b128 v[48:51], v20 offset:2048
ds_read_b128 v[52:55], v20 offset:3072
v_mfma_f32_16x16x32_bf16 a[44:47], a[16:19], a[52:55], a[44:47]
ds_read_b128 v[56:59], v20 offset:4096
ds_read_b128 v[60:63], v20 offset:5120
v_mfma_f32_16x16x32_bf16 a[44:47], a[20:23], a[92:95], a[44:47]
v_mfma_f32_16x16x32_bf16 a[64:67], a[216:219], v[72:75], a[64:67]
v_mfma_f32_16x16x32_bf16 a[64:67], a[16:19], a[56:59], a[64:67]
v_mfma_f32_16x16x32_bf16 a[64:67], a[20:23], a[112:115], a[64:67]
s_waitcnt lgkmcnt(0)
v_add_f32 v136, v136, v40
v_add_f32 v137, v137, v41
v_add_f32 v138, v138, v42
v_mfma_f32_16x16x32_bf16 a[68:71], a[216:219], v[76:79], a[68:71]
ds_write_b128 v17, a[40:43] offset:0
v_mfma_f32_16x16x32_bf16 a[68:71], a[16:19], a[60:63], a[68:71]
v_add_f32 v139, v139, v43
v_add_f32 v140, v140, v44
v_add_f32 v141, v141, v45
v_mfma_f32_16x16x32_bf16 a[68:71], a[20:23], a[116:119], a[68:71]
v_add_f32 v142, v142, v46
v_add_f32 v143, v143, v47
v_cvt_pk_bf16_f32 v136, v136, v137
v_mfma_f32_16x16x32_bf16 a[72:75], a[216:219], v[80:83], a[72:75]
v_cvt_pk_bf16_f32 v137, v138, v139
v_cvt_pk_bf16_f32 v138, v140, v141
v_cvt_pk_bf16_f32 v139, v142, v143
v_mfma_f32_16x16x32_bf16 a[72:75], a[16:19], a[80:83], a[72:75]
ds_write_b128 v17, a[44:47] offset:1024
v_mfma_f32_16x16x32_bf16 a[72:75], a[20:23], a[120:123], a[72:75]
buffer_store_dwordx4 v[136:139], v32, s[12:15], s52 offen offset:0 sc1
v_mfma_f32_16x16x32_bf16 a[76:79], a[216:219], v[84:87], a[76:79]
v_add_f32 v144, v144, v48
v_add_f32 v145, v145, v49
v_mfma_f32_16x16x32_bf16 a[76:79], a[16:19], a[84:87], a[76:79]
v_add_f32 v146, v146, v50
v_add_f32 v147, v147, v51
v_mfma_f32_16x16x32_bf16 a[76:79], a[20:23], a[124:127], a[76:79]
ds_write_b128 v17, a[64:67] offset:2048
v_mfma_f32_16x16x32_bf16 v[160:163], a[196:199], v[64:67], v[160:163]
ds_read_b64_tr_b16 a[16:17], v12 offset:32832
ds_read_b64_tr_b16 a[18:19], v12 offset:41024
v_mfma_f32_16x16x32_bf16 v[160:163], a[24:27], a[48:51], v[160:163]
ds_read_b64_tr_b16 a[20:21], v12 offset:49216
ds_read_b64_tr_b16 a[22:23], v12 offset:57408
v_mfma_f32_16x16x32_bf16 v[160:163], a[28:31], a[88:91], v[160:163]
v_add_f32 v148, v148, v52
v_add_f32 v149, v149, v53
v_mfma_f32_16x16x32_bf16 v[164:167], a[196:199], v[68:71], v[164:167]
ds_write_b128 v17, a[68:71] offset:3072
v_mfma_f32_16x16x32_bf16 v[164:167], a[24:27], a[52:55], v[164:167]
v_add_f32 v150, v150, v54
v_add_f32 v151, v151, v55
v_mfma_f32_16x16x32_bf16 v[164:167], a[28:31], a[92:95], v[164:167]
v_cvt_pk_bf16_f32 v144, v144, v145
v_cvt_pk_bf16_f32 v145, v146, v147
v_mfma_f32_16x16x32_bf16 v[168:171], a[196:199], v[72:75], v[168:171]
v_cvt_pk_bf16_f32 v146, v148, v149
v_cvt_pk_bf16_f32 v147, v150, v151
v_mfma_f32_16x16x32_bf16 v[168:171], a[24:27], a[56:59], v[168:171]
ds_write_b128 v17, a[72:75] offset:4096
v_mfma_f32_16x16x32_bf16 v[168:171], a[28:31], a[112:115], v[168:171]
buffer_store_dwordx4 v[144:147], v32, s[12:15], s52 offen offset:1024 sc1
v_mfma_f32_16x16x32_bf16 v[172:175], a[196:199], v[76:79], v[172:175]
v_add_f32 v152, v152, v56
v_add_f32 v153, v153, v57
v_mfma_f32_16x16x32_bf16 v[172:175], a[24:27], a[60:63], v[172:175]
v_add_f32 v154, v154, v58
v_add_f32 v155, v155, v59
v_mfma_f32_16x16x32_bf16 v[172:175], a[28:31], a[116:119], v[172:175]
ds_write_b128 v17, a[76:79] offset:5120
v_mfma_f32_16x16x32_bf16 v[176:179], a[196:199], v[80:83], v[176:179]
v_add_f32 v156, v156, v60
v_add_f32 v157, v157, v61
v_mfma_f32_16x16x32_bf16 v[176:179], a[24:27], a[80:83], v[176:179]
v_add_f32 v158, v158, v62
v_add_f32 v159, v159, v63
v_mfma_f32_16x16x32_bf16 v[176:179], a[28:31], a[120:123], v[176:179]
v_cvt_pk_bf16_f32 v152, v152, v153
v_cvt_pk_bf16_f32 v153, v154, v155
v_mfma_f32_16x16x32_bf16 v[180:183], a[196:199], v[84:87], v[180:183]
v_cvt_pk_bf16_f32 v154, v156, v157
v_cvt_pk_bf16_f32 v155, v158, v159
v_mfma_f32_16x16x32_bf16 v[180:183], a[24:27], a[84:87], v[180:183]
buffer_store_dwordx4 v[152:155], v32, s[12:15], s52 offen offset:2048 sc1
s_add_u32 s52, s52, 3072
v_mfma_f32_16x16x32_bf16 v[180:183], a[28:31], a[124:127], v[180:183]
s_waitcnt lgkmcnt(0)
s_barrier
v_mfma_f32_16x16x32_bf16 a[96:99], a[220:223], v[64:67], a[96:99]
ds_read_b64_tr_b16 a[24:25], v10 offset:32832
ds_read_b64_tr_b16 a[26:27], v10 offset:41024
v_mfma_f32_16x16x32_bf16 a[96:99], a[16:19], a[48:51], a[96:99]
ds_read_b64_tr_b16 a[28:29], v10 offset:49216
ds_read_b64_tr_b16 a[30:31], v10 offset:57408
v_mfma_f32_16x16x32_bf16 a[96:99], a[20:23], a[88:91], a[96:99]
ds_read_b128 v[40:43], v21 offset:0
ds_read_b128 v[44:47], v21 offset:1024
v_mfma_f32_16x16x32_bf16 a[100:103], a[220:223], v[68:71], a[100:103]
ds_read_b128 v[48:51], v21 offset:2048
ds_read_b128 v[52:55], v21 offset:3072
v_mfma_f32_16x16x32_bf16 a[100:103], a[16:19], a[52:55], a[100:103]
ds_read_b128 v[56:59], v21 offset:4096
ds_read_b128 v[60:63], v21 offset:5120
v_mfma_f32_16x16x32_bf16 a[100:103], a[20:23], a[92:95], a[100:103]
v_mfma_f32_16x16x32_bf16 a[104:107], a[220:223], v[72:75], a[104:107]
v_mfma_f32_16x16x32_bf16 a[104:107], a[16:19], a[56:59], a[104:107]
v_mfma_f32_16x16x32_bf16 a[104:107], a[20:23], a[112:115], a[104:107]
s_waitcnt lgkmcnt(0)
v_add_f32 v160, v160, v40
v_add_f32 v161, v161, v41
v_add_f32 v162, v162, v42
v_mfma_f32_16x16x32_bf16 a[108:111], a[220:223], v[76:79], a[108:111]
ds_write_b128 v16, a[96:99] offset:0
v_mfma_f32_16x16x32_bf16 a[108:111], a[16:19], a[60:63], a[108:111]
v_add_f32 v163, v163, v43
v_add_f32 v164, v164, v44
v_add_f32 v165, v165, v45
v_mfma_f32_16x16x32_bf16 a[108:111], a[20:23], a[116:119], a[108:111]
v_add_f32 v166, v166, v46
v_add_f32 v167, v167, v47
v_cvt_pk_bf16_f32 v160, v160, v161
v_mfma_f32_16x16x32_bf16 a[128:131], a[220:223], v[80:83], a[128:131]
v_cvt_pk_bf16_f32 v161, v162, v163
v_cvt_pk_bf16_f32 v162, v164, v165
v_cvt_pk_bf16_f32 v163, v166, v167
v_mfma_f32_16x16x32_bf16 a[128:131], a[16:19], a[80:83], a[128:131]
ds_write_b128 v16, a[100:103] offset:1024
v_mfma_f32_16x16x32_bf16 a[128:131], a[20:23], a[120:123], a[128:131]
buffer_store_dwordx4 v[160:163], v32, s[12:15], s52 offen offset:0 sc1
v_mfma_f32_16x16x32_bf16 a[132:135], a[220:223], v[84:87], a[132:135]
v_add_f32 v168, v168, v48
v_add_f32 v169, v169, v49
v_mfma_f32_16x16x32_bf16 a[132:135], a[16:19], a[84:87], a[132:135]
v_add_f32 v170, v170, v50
v_add_f32 v171, v171, v51
v_mfma_f32_16x16x32_bf16 a[132:135], a[20:23], a[124:127], a[132:135]
ds_write_b128 v16, a[104:107] offset:2048
v_mfma_f32_16x16x32_bf16 v[184:187], a[200:203], v[64:67], v[184:187]
ds_read_b64_tr_b16 a[16:17], v13 offset:32832
ds_read_b64_tr_b16 a[18:19], v13 offset:41024
v_mfma_f32_16x16x32_bf16 v[184:187], a[24:27], a[48:51], v[184:187]
ds_read_b64_tr_b16 a[20:21], v13 offset:49216
ds_read_b64_tr_b16 a[22:23], v13 offset:57408
v_mfma_f32_16x16x32_bf16 v[184:187], a[28:31], a[88:91], v[184:187]
v_add_f32 v172, v172, v52
v_add_f32 v173, v173, v53
v_mfma_f32_16x16x32_bf16 v[188:191], a[200:203], v[68:71], v[188:191]
ds_write_b128 v16, a[108:111] offset:3072
v_mfma_f32_16x16x32_bf16 v[188:191], a[24:27], a[52:55], v[188:191]
v_add_f32 v174, v174, v54
v_add_f32 v175, v175, v55
v_mfma_f32_16x16x32_bf16 v[188:191], a[28:31], a[92:95], v[188:191]
v_cvt_pk_bf16_f32 v168, v168, v169
v_cvt_pk_bf16_f32 v169, v170, v171
v_mfma_f32_16x16x32_bf16 v[192:195], a[200:203], v[72:75], v[192:195]
v_cvt_pk_bf16_f32 v170, v172, v173
v_cvt_pk_bf16_f32 v171, v174, v175
v_mfma_f32_16x16x32_bf16 v[192:195], a[24:27], a[56:59], v[192:195]
ds_write_b128 v16, a[128:131] offset:4096
v_mfma_f32_16x16x32_bf16 v[192:195], a[28:31], a[112:115], v[192:195]
buffer_store_dwordx4 v[168:171], v32, s[12:15], s52 offen offset:1024 sc1
v_mfma_f32_16x16x32_bf16 v[196:199], a[200:203], v[76:79], v[196:199]
v_add_f32 v176, v176, v56
v_add_f32 v177, v177, v57
v_mfma_f32_16x16x32_bf16 v[196:199], a[24:27], a[60:63], v[196:199]
v_add_f32 v178, v178, v58
v_add_f32 v179, v179, v59
v_mfma_f32_16x16x32_bf16 v[196:199], a[28:31], a[116:119], v[196:199]
ds_write_b128 v16, a[132:135] offset:5120
v_mfma_f32_16x16x32_bf16 v[200:203], a[200:203], v[80:83], v[200:203]
v_add_f32 v180, v180, v60
v_add_f32 v181, v181, v61
v_mfma_f32_16x16x32_bf16 v[200:203], a[24:27], a[80:83], v[200:203]
v_add_f32 v182, v182, v62
v_add_f32 v183, v183, v63
v_mfma_f32_16x16x32_bf16 v[200:203], a[28:31], a[120:123], v[200:203]
v_cvt_pk_bf16_f32 v176, v176, v177
v_cvt_pk_bf16_f32 v177, v178, v179
v_mfma_f32_16x16x32_bf16 v[204:207], a[200:203], v[84:87], v[204:207]
v_cvt_pk_bf16_f32 v178, v180, v181
v_cvt_pk_bf16_f32 v179, v182, v183
v_mfma_f32_16x16x32_bf16 v[204:207], a[24:27], a[84:87], v[204:207]
buffer_store_dwordx4 v[176:179], v32, s[12:15], s52 offen offset:2048 sc1
s_add_u32 s52, s52, 3072
v_mfma_f32_16x16x32_bf16 v[204:207], a[28:31], a[124:127], v[204:207]
s_waitcnt lgkmcnt(0)
s_barrier
v_mfma_f32_16x16x32_bf16 a[136:139], a[224:227], v[64:67], a[136:139]
ds_read_b64_tr_b16 a[24:25], v11 offset:32832
ds_read_b64_tr_b16 a[26:27], v11 offset:41024
v_mfma_f32_16x16x32_bf16 a[136:139], a[16:19], a[48:51], a[136:139]
ds_read_b64_tr_b16 a[28:29], v11 offset:49216
ds_read_b64_tr_b16 a[30:31], v11 offset:57408
v_mfma_f32_16x16x32_bf16 a[136:139], a[20:23], a[88:91], a[136:139]
ds_read_b128 v[40:43], v20 offset:0
ds_read_b128 v[44:47], v20 offset:1024
v_mfma_f32_16x16x32_bf16 a[140:143], a[224:227], v[68:71], a[140:143]
ds_read_b128 v[48:51], v20 offset:2048
ds_read_b128 v[52:55], v20 offset:3072
v_mfma_f32_16x16x32_bf16 a[140:143], a[16:19], a[52:55], a[140:143]
ds_read_b128 v[56:59], v20 offset:4096
ds_read_b128 v[60:63], v20 offset:5120
v_mfma_f32_16x16x32_bf16 a[140:143], a[20:23], a[92:95], a[140:143]
v_mfma_f32_16x16x32_bf16 a[160:163], a[224:227], v[72:75], a[160:163]
v_mfma_f32_16x16x32_bf16 a[160:163], a[16:19], a[56:59], a[160:163]
v_mfma_f32_16x16x32_bf16 a[160:163], a[20:23], a[112:115], a[160:163]
s_waitcnt lgkmcnt(0)
v_add_f32 v184, v184, v40
v_add_f32 v185, v185, v41
v_add_f32 v186, v186, v42
v_mfma_f32_16x16x32_bf16 a[164:167], a[224:227], v[76:79], a[164:167]
ds_write_b128 v17, a[136:139] offset:0
v_mfma_f32_16x16x32_bf16 a[164:167], a[16:19], a[60:63], a[164:167]
v_add_f32 v187, v187, v43
v_add_f32 v188, v188, v44
v_add_f32 v189, v189, v45
v_mfma_f32_16x16x32_bf16 a[164:167], a[20:23], a[116:119], a[164:167]
v_add_f32 v190, v190, v46
v_add_f32 v191, v191, v47
v_cvt_pk_bf16_f32 v184, v184, v185
v_mfma_f32_16x16x32_bf16 a[168:171], a[224:227], v[80:83], a[168:171]
v_cvt_pk_bf16_f32 v185, v186, v187
v_cvt_pk_bf16_f32 v186, v188, v189
v_cvt_pk_bf16_f32 v187, v190, v191
v_mfma_f32_16x16x32_bf16 a[168:171], a[16:19], a[80:83], a[168:171]
ds_write_b128 v17, a[140:143] offset:1024
v_mfma_f32_16x16x32_bf16 a[168:171], a[20:23], a[120:123], a[168:171]
buffer_store_dwordx4 v[184:187], v32, s[12:15], s52 offen offset:0 sc1
v_mfma_f32_16x16x32_bf16 a[172:175], a[224:227], v[84:87], a[172:175]
v_add_f32 v192, v192, v48
v_add_f32 v193, v193, v49
v_mfma_f32_16x16x32_bf16 a[172:175], a[16:19], a[84:87], a[172:175]
v_add_f32 v194, v194, v50
v_add_f32 v195, v195, v51
v_mfma_f32_16x16x32_bf16 a[172:175], a[20:23], a[124:127], a[172:175]
ds_write_b128 v17, a[160:163] offset:2048
v_mfma_f32_16x16x32_bf16 v[208:211], a[204:207], v[64:67], v[208:211]
ds_read_b64_tr_b16 a[16:17], v12 offset:32896
ds_read_b64_tr_b16 a[18:19], v12 offset:41088
v_mfma_f32_16x16x32_bf16 v[208:211], a[24:27], a[48:51], v[208:211]
ds_read_b64_tr_b16 a[20:21], v12 offset:49280
ds_read_b64_tr_b16 a[22:23], v12 offset:57472
v_mfma_f32_16x16x32_bf16 v[208:211], a[28:31], a[88:91], v[208:211]
v_add_f32 v196, v196, v52
v_add_f32 v197, v197, v53
v_mfma_f32_16x16x32_bf16 v[212:215], a[204:207], v[68:71], v[212:215]
ds_write_b128 v17, a[164:167] offset:3072
v_mfma_f32_16x16x32_bf16 v[212:215], a[24:27], a[52:55], v[212:215]
v_add_f32 v198, v198, v54
v_add_f32 v199, v199, v55
v_mfma_f32_16x16x32_bf16 v[212:215], a[28:31], a[92:95], v[212:215]
v_cvt_pk_bf16_f32 v192, v192, v193
v_cvt_pk_bf16_f32 v193, v194, v195
v_mfma_f32_16x16x32_bf16 v[216:219], a[204:207], v[72:75], v[216:219]
v_cvt_pk_bf16_f32 v194, v196, v197
v_cvt_pk_bf16_f32 v195, v198, v199
v_mfma_f32_16x16x32_bf16 v[216:219], a[24:27], a[56:59], v[216:219]
ds_write_b128 v17, a[168:171] offset:4096
v_mfma_f32_16x16x32_bf16 v[216:219], a[28:31], a[112:115], v[216:219]
buffer_store_dwordx4 v[192:195], v32, s[12:15], s52 offen offset:1024 sc1
v_mfma_f32_16x16x32_bf16 v[220:223], a[204:207], v[76:79], v[220:223]
v_add_f32 v200, v200, v56
v_add_f32 v201, v201, v57
v_mfma_f32_16x16x32_bf16 v[220:223], a[24:27], a[60:63], v[220:223]
v_add_f32 v202, v202, v58
v_add_f32 v203, v203, v59
v_mfma_f32_16x16x32_bf16 v[220:223], a[28:31], a[116:119], v[220:223]
ds_write_b128 v17, a[172:175] offset:5120
v_mfma_f32_16x16x32_bf16 v[224:227], a[204:207], v[80:83], v[224:227]
v_add_f32 v204, v204, v60
v_add_f32 v205, v205, v61
v_mfma_f32_16x16x32_bf16 v[224:227], a[24:27], a[80:83], v[224:227]
v_add_f32 v206, v206, v62
v_add_f32 v207, v207, v63
v_mfma_f32_16x16x32_bf16 v[224:227], a[28:31], a[120:123], v[224:227]
v_cvt_pk_bf16_f32 v200, v200, v201
v_cvt_pk_bf16_f32 v201, v202, v203
v_mfma_f32_16x16x32_bf16 v[228:231], a[204:207], v[84:87], v[228:231]
v_cvt_pk_bf16_f32 v202, v204, v205
v_cvt_pk_bf16_f32 v203, v206, v207
v_mfma_f32_16x16x32_bf16 v[228:231], a[24:27], a[84:87], v[228:231]
buffer_store_dwordx4 v[200:203], v32, s[12:15], s52 offen offset:2048 sc1
s_add_u32 s52, s52, 3072
v_mfma_f32_16x16x32_bf16 v[228:231], a[28:31], a[124:127], v[228:231]
s_waitcnt vmcnt(3) lgkmcnt(0)
s_barrier
s_cmp_lg_u32 s20, 3
s_cbranch_scc1 L_sg6
s_mov_b64 exec, 1
buffer_atomic_add v23, v14, s[8:11], s100 offen
buffer_atomic_add v24, v14, s[36:39], s42 offen
s_mov_b64 exec, -1
L_sg6:
v_mfma_f32_16x16x32_bf16 a[232:235], a[228:231], v[64:67], a[232:235]
ds_read_b64_tr_b16 a[24:25], v10 offset:32896
ds_read_b64_tr_b16 a[26:27], v10 offset:41088
v_mfma_f32_16x16x32_bf16 a[232:235], a[16:19], a[48:51], a[232:235]
ds_read_b64_tr_b16 a[28:29], v10 offset:49280
ds_read_b64_tr_b16 a[30:31], v10 offset:57472
v_mfma_f32_16x16x32_bf16 a[232:235], a[20:23], a[88:91], a[232:235]
ds_read_b128 v[40:43], v21 offset:0
ds_read_b128 v[44:47], v21 offset:1024
v_mfma_f32_16x16x32_bf16 a[236:239], a[228:231], v[68:71], a[236:239]
ds_read_b128 v[48:51], v21 offset:2048
ds_read_b128 v[52:55], v21 offset:3072
v_mfma_f32_16x16x32_bf16 a[236:239], a[16:19], a[52:55], a[236:239]
ds_read_b128 v[56:59], v21 offset:4096
ds_read_b128 v[60:63], v21 offset:5120
v_mfma_f32_16x16x32_bf16 a[236:239], a[20:23], a[92:95], a[236:239]
v_mfma_f32_16x16x32_bf16 a[240:243], a[228:231], v[72:75], a[240:243]
v_mfma_f32_16x16x32_bf16 a[240:243], a[16:19], a[56:59], a[240:243]
v_mfma_f32_16x16x32_bf16 a[240:243], a[20:23], a[112:115], a[240:243]
s_waitcnt lgkmcnt(0)
v_add_f32 v208, v208, v40
v_add_f32 v209, v209, v41
v_add_f32 v210, v210, v42
v_mfma_f32_16x16x32_bf16 a[244:247], a[228:231], v[76:79], a[244:247]
ds_write_b128 v16, a[232:235] offset:0
v_mfma_f32_16x16x32_bf16 a[244:247], a[16:19], a[60:63], a[244:247]
v_add_f32 v211, v211, v43
v_add_f32 v212, v212, v44
v_add_f32 v213, v213, v45
v_mfma_f32_16x16x32_bf16 a[244:247], a[20:23], a[116:119], a[244:247]
v_add_f32 v214, v214, v46
v_add_f32 v215, v215, v47
v_mfma_f32_16x16x32_bf16 a[248:251], a[228:231], v[80:83], a[248:251]
v_cvt_pk_bf16_f32 v208, v208, v209
v_cvt_pk_bf16_f32 v209, v210, v211
v_mfma_f32_16x16x32_bf16 a[248:251], a[16:19], a[80:83], a[248:251]
ds_write_b128 v16, a[236:239] offset:1024
v_mfma_f32_16x16x32_bf16 a[248:251], a[20:23], a[120:123], a[248:251]
v_cvt_pk_bf16_f32 v210, v212, v213
v_cvt_pk_bf16_f32 v211, v214, v215
v_mfma_f32_16x16x32_bf16 a[252:255], a[228:231], v[84:87], a[252:255]
buffer_store_dwordx4 v[208:211], v32, s[12:15], s52 offen offset:0 sc1
v_mfma_f32_16x16x32_bf16 a[252:255], a[16:19], a[84:87], a[252:255]
v_add_f32 v216, v216, v48
v_add_f32 v217, v217, v49
v_mfma_f32_16x16x32_bf16 a[252:255], a[20:23], a[124:127], a[252:255]
ds_write_b128 v16, a[240:243] offset:2048
v_mfma_f32_16x16x32_bf16 v[232:235], a[208:211], v[64:67], v[232:235]
v_add_f32 v218, v218, v50
v_add_f32 v219, v219, v51
v_mfma_f32_16x16x32_bf16 v[232:235], a[24:27], a[48:51], v[232:235]
v_add_f32 v220, v220, v52
v_add_f32 v221, v221, v53
v_mfma_f32_16x16x32_bf16 v[232:235], a[28:31], a[88:91], v[232:235]
v_add_f32 v222, v222, v54
v_add_f32 v223, v223, v55
v_mfma_f32_16x16x32_bf16 v[236:239], a[208:211], v[68:71], v[236:239]
ds_write_b128 v16, a[244:247] offset:3072
v_mfma_f32_16x16x32_bf16 v[236:239], a[24:27], a[52:55], v[236:239]
v_cvt_pk_bf16_f32 v216, v216, v217
v_cvt_pk_bf16_f32 v217, v218, v219
v_mfma_f32_16x16x32_bf16 v[236:239], a[28:31], a[92:95], v[236:239]
v_cvt_pk_bf16_f32 v218, v220, v221
v_cvt_pk_bf16_f32 v219, v222, v223
v_mfma_f32_16x16x32_bf16 v[240:243], a[208:211], v[72:75], v[240:243]
buffer_store_dwordx4 v[216:219], v32, s[12:15], s52 offen offset:1024 sc1
v_mfma_f32_16x16x32_bf16 v[240:243], a[24:27], a[56:59], v[240:243]
ds_write_b128 v16, a[248:251] offset:4096
v_mfma_f32_16x16x32_bf16 v[240:243], a[28:31], a[112:115], v[240:243]
v_add_f32 v224, v224, v56
v_add_f32 v225, v225, v57
v_mfma_f32_16x16x32_bf16 v[244:247], a[208:211], v[76:79], v[244:247]
v_add_f32 v226, v226, v58
v_add_f32 v227, v227, v59
v_mfma_f32_16x16x32_bf16 v[244:247], a[24:27], a[60:63], v[244:247]
v_add_f32 v228, v228, v60
v_add_f32 v229, v229, v61
v_mfma_f32_16x16x32_bf16 v[244:247], a[28:31], a[116:119], v[244:247]
ds_write_b128 v16, a[252:255] offset:5120
v_mfma_f32_16x16x32_bf16 v[248:251], a[208:211], v[80:83], v[248:251]
v_add_f32 v230, v230, v62
v_add_f32 v231, v231, v63
v_mfma_f32_16x16x32_bf16 v[248:251], a[24:27], a[80:83], v[248:251]
v_cvt_pk_bf16_f32 v224, v224, v225
v_cvt_pk_bf16_f32 v225, v226, v227
v_mfma_f32_16x16x32_bf16 v[248:251], a[28:31], a[120:123], v[248:251]
v_cvt_pk_bf16_f32 v226, v228, v229
v_cvt_pk_bf16_f32 v227, v230, v231
v_mfma_f32_16x16x32_bf16 v[252:255], a[208:211], v[84:87], v[252:255]
buffer_load_dword v19, v14, s[8:11], s100 offen sc1
v_mfma_f32_16x16x32_bf16 v[252:255], a[24:27], a[84:87], v[252:255]
buffer_store_dwordx4 v[224:227], v32, s[12:15], s52 offen offset:2048 sc1
s_add_u32 s52, s52, 3072
v_mfma_f32_16x16x32_bf16 v[252:255], a[28:31], a[124:127], v[252:255]
s_waitcnt lgkmcnt(0)
s_barrier
ds_read_b128 v[40:43], v20 offset:0
ds_read_b128 v[44:47], v20 offset:1024
ds_read_b128 v[48:51], v20 offset:2048
ds_read_b128 v[52:55], v20 offset:3072
ds_read_b128 v[56:59], v20 offset:4096
ds_read_b128 v[60:63], v20 offset:5120
s_waitcnt lgkmcnt(0)
v_pk_add_f32 v[232:233], v[232:233], v[40:41]
v_pk_add_f32 v[234:235], v[234:235], v[42:43]
v_pk_add_f32 v[236:237], v[236:237], v[44:45]
v_pk_add_f32 v[238:239], v[238:239], v[46:47]
v_cvt_pk_bf16_f32 v232, v232, v233
v_cvt_pk_bf16_f32 v233, v234, v235
v_cvt_pk_bf16_f32 v234, v236, v237
v_cvt_pk_bf16_f32 v235, v238, v239
buffer_store_dwordx4 v[232:235], v32, s[12:15], s52 offen offset:0 sc1
v_pk_add_f32 v[240:241], v[240:241], v[48:49]
v_pk_add_f32 v[242:243], v[242:243], v[50:51]
v_pk_add_f32 v[244:245], v[244:245], v[52:53]
v_pk_add_f32 v[246:247], v[246:247], v[54:55]
v_cvt_pk_bf16_f32 v240, v240, v241
v_cvt_pk_bf16_f32 v241, v242, v243
v_cvt_pk_bf16_f32 v242, v244, v245
v_cvt_pk_bf16_f32 v243, v246, v247
buffer_store_dwordx4 v[240:243], v32, s[12:15], s52 offen offset:1024 sc1
v_pk_add_f32 v[248:249], v[248:249], v[56:57]
v_pk_add_f32 v[250:251], v[250:251], v[58:59]
v_pk_add_f32 v[252:253], v[252:253], v[60:61]
v_pk_add_f32 v[254:255], v[254:255], v[62:63]
v_cvt_pk_bf16_f32 v248, v248, v249
v_cvt_pk_bf16_f32 v249, v250, v251
v_cvt_pk_bf16_f32 v250, v252, v253
v_cvt_pk_bf16_f32 v251, v254, v255
buffer_store_dwordx4 v[248:251], v32, s[12:15], s52 offen offset:2048 sc1
s_add_u32 s52, s52, 3072
s_cmp_lg_u32 s20, s28
s_cbranch_scc1 L_nokeep
ds_write_b128 v32, v[136:139] offset:32768
ds_write_b128 v32, v[144:147] offset:33792
ds_write_b128 v32, v[152:155] offset:34816
ds_write_b128 v32, v[160:163] offset:35840
ds_write_b128 v32, v[168:171] offset:36864
ds_write_b128 v32, v[176:179] offset:37888
ds_write_b128 v32, v[184:187] offset:38912
ds_write_b128 v32, v[192:195] offset:39936
ds_write_b128 v32, v[200:203] offset:40960
ds_write_b128 v32, v[208:211] offset:41984
ds_write_b128 v32, v[216:219] offset:43008
ds_write_b128 v32, v[224:227] offset:44032
ds_write_b128 v32, v[232:235] offset:45056
ds_write_b128 v32, v[240:243] offset:46080
ds_write_b128 v32, v[248:251] offset:47104
L_nokeep:
s_mov_b32 s14, 0x40000
s_mul_i32 s34, s27, 192
s_and_b32 s35, s28, 1
s_mul_i32 s35, s35, 96
s_add_u32 s34, s34, s35
s_lshl_b32 s35, s20, 5
s_add_u32 s34, s34, s35
s_mul_i32 s34, s34, 2560
s_mul_i32 s35, s25, 1280
s_add_u32 s34, s34, s35
s_mul_i32 s35, s23, 320
s_add_u32 s34, s34, s35
s_lshr_b32 s35, s28, 1
s_mul_i32 s35, s35, 160
s_add_u32 s34, s34, s35
s_add_u32 s16, s48, s34
s_addc_u32 s17, s49, 0
s_sub_u32 s18, 3932160, s34
s_mov_b32 s19, 0x20000
s_lshl_b32 s52, s28, 16
s_lshl_b32 s35, s20, 10
s_add_u32 s52, s52, s35
s_add_u32 s34, s28, 1
s_and_b32 s34, s34, 3
s_lshl_b32 s34, s34, 14
s_add_u32 s89, s52, s34
s_add_u32 s34, s28, 2
s_and_b32 s34, s34, 3
s_lshl_b32 s34, s34, 14
s_add_u32 s90, s52, s34
s_add_u32 s34, s28, 3
s_and_b32 s34, s34, 3
s_lshl_b32 s34, s34, 14
s_add_u32 s91, s52, s34
v_add_u32 v16, s35, v32
v_add_u32 v17, 6144, v32
v_add_u32 v20, 12288, v32
s_waitcnt vmcnt(0) lgkmcnt(0)
s_barrier
v_readfirstlane_b32 s98, v19
s_nop 0
s_sub_u32 s98, s98, s58
s_cmp_lg_u32 s20, 3
s_cbranch_scc1 L_fw
s_cmp_lg_u32 s20, 3
s_cbranch_scc1 L_sg7
s_mov_b64 exec, 1
buffer_atomic_add v15, v14, s[8:11], s100 offen
buffer_atomic_add v22, v14, s[36:39], s42 offen
s_mov_b64 exec, -1
L_sg7:
s_bfe_u32 s34, s98, 0x40000
s_cmp_eq_u32 s34, 4
s_cbranch_scc1 L_pd8
s_mov_b32 s61, 0x40000
L_pl8:
buffer_load_dword v19, v14, s[8:11], s100 offen sc1
s_waitcnt vmcnt(0)
v_readfirstlane_b32 s98, v19
s_sub_u32 s61, s61, 1
s_sub_u32 s98, s98, s58
s_bfe_u32 s34, s98, 0x40000
s_cmp_eq_u32 s34, 4
s_cbranch_scc1 L_pd8
s_sleep 2
s_and_b32 s34, s61, 63
s_cbranch_scc1 L_pl8
buffer_load_dword v19, v14, s[36:39], s42 offen sc1
s_waitcnt vmcnt(0)
v_readfirstlane_b32 s34, v19
s_cmp_eq_u32 s61, 0
s_cbranch_scc1 L_pd8
s_bfe_u32 s34, s34, 0x40010
s_cmp_lt_u32 s34, 4
s_cbranch_scc1 L_pl8
L_pd8:
s_barrier
s_endpgm
L_fw:
ds_read_b128 v[40:43], v16 offset:32768
ds_read_b128 v[56:59], v16 offset:35840
ds_read_b128 v[72:75], v16 offset:38912
ds_read_b128 v[88:91], v16 offset:41984
ds_read_b128 v[104:107], v16 offset:45056
s_mov_b32 s55, 40960
s_mov_b32 s33, 0xffff0000
s_bfe_u32 s34, s98, 0x40004
s_cmp_eq_u32 s34, 4
s_cbranch_scc1 L_pd9
s_mov_b32 s61, 0x40000
L_pl9:
buffer_load_dword v19, v14, s[8:11], s100 offen sc1
s_waitcnt vmcnt(0)
v_readfirstlane_b32 s98, v19
s_sub_u32 s61, s61, 1
s_sub_u32 s98, s98, s58
s_bfe_u32 s34, s98, 0x40004
s_cmp_eq_u32 s34, 4
s_cbranch_scc1 L_pd9
s_sleep 2
s_and_b32 s34, s61, 63
s_cbranch_scc1 L_pl9
buffer_load_dword v19, v14, s[36:39], s42 offen sc1
s_waitcnt vmcnt(0)
v_readfirstlane_b32 s34, v19
s_cmp_eq_u32 s61, 0
s_cbranch_scc1 L_pd9
s_bfe_u32 s34, s34, 0x40014
s_cmp_lt_u32 s34, 4
s_cbranch_scc1 L_pl9
L_pd9:
buffer_load_dwordx4 v[44:47], v32, s[12:15], s89 offen offset:0 sc1
buffer_load_dwordx4 v[48:51], v32, s[12:15], s90 offen offset:0 sc1
buffer_load_dwordx4 v[52:55], v32, s[12:15], s91 offen offset:0 sc1
buffer_load_dwordx4 v[60:63], v32, s[12:15], s89 offen offset:3072 sc1
buffer_load_dwordx4 v[64:67], v32, s[12:15], s90 offen offset:3072 sc1
buffer_load_dwordx4 v[68:71], v32, s[12:15], s91 offen offset:3072 sc1
s_waitcnt vmcnt(3) lgkmcnt(0)
v_lshlrev_b32 v128, 16, v40
v_lshlrev_b32 v129, 16, v41
v_lshlrev_b32 v130, 16, v42
v_lshlrev_b32 v131, 16, v43
v_lshlrev_b32 v132, 16, v44
v_lshlrev_b32 v133, 16, v45
v_lshlrev_b32 v134, 16, v46
v_lshlrev_b32 v135, 16, v47
v_lshlrev_b32 v136, 16, v48
v_lshlrev_b32 v137, 16, v49
v_lshlrev_b32 v138, 16, v50
v_lshlrev_b32 v139, 16, v51
v_lshlrev_b32 v140, 16, v52
v_lshlrev_b32 v141, 16, v53
v_lshlrev_b32 v142, 16, v54
v_lshlrev_b32 v143, 16, v55
v_and_b32 v40, s33, v40
v_and_b32 v41, s33, v41
v_and_b32 v42, s33, v42
v_and_b32 v43, s33, v43
v_and_b32 v44, s33, v44
v_and_b32 v45, s33, v45
v_and_b32 v46, s33, v46
v_and_b32 v47, s33, v47
v_and_b32 v48, s33, v48
v_and_b32 v49, s33, v49
v_and_b32 v50, s33, v50
v_and_b32 v51, s33, v51
v_and_b32 v52, s33, v52
v_and_b32 v53, s33, v53
v_and_b32 v54, s33, v54
v_and_b32 v55, s33, v55
v_pk_add_f32 v[128:129], v[128:129], v[132:133]
v_pk_add_f32 v[136:137], v[136:137], v[140:141]
v_pk_add_f32 v[130:131], v[130:131], v[134:135]
v_pk_add_f32 v[138:139], v[138:139], v[142:143]
v_pk_add_f32 v[40:41], v[40:41], v[44:45]
v_pk_add_f32 v[48:49], v[48:49], v[52:53]
v_pk_add_f32 v[42:43], v[42:43], v[46:47]
v_pk_add_f32 v[50:51], v[50:51], v[54:55]
v_pk_add_f32 v[128:129], v[128:129], v[136:137]
v_pk_add_f32 v[130:131], v[130:131], v[138:139]
v_pk_add_f32 v[40:41], v[40:41], v[48:49]
v_pk_add_f32 v[42:43], v[42:43], v[50:51]
v_cvt_pk_bf16_f32 v44, v128, v40
v_cvt_pk_bf16_f32 v45, v129, v41
v_cvt_pk_bf16_f32 v46, v130, v42
v_cvt_pk_bf16_f32 v47, v131, v43
buffer_store_dwordx2 v[44:45], v34, s[16:19], 0 offen offset:0
buffer_store_dwordx2 v[46:47], v34, s[16:19], s55 offen offset:0
s_waitcnt vmcnt(2) lgkmcnt(0)
v_lshlrev_b32 v128, 16, v56
v_lshlrev_b32 v129, 16, v57
v_lshlrev_b32 v130, 16, v58
v_lshlrev_b32 v131, 16, v59
v_lshlrev_b32 v132, 16, v60
v_lshlrev_b32 v133, 16, v61
v_lshlrev_b32 v134, 16, v62
v_lshlrev_b32 v135, 16, v63
v_lshlrev_b32 v136, 16, v64
v_lshlrev_b32 v137, 16, v65
v_lshlrev_b32 v138, 16, v66
v_lshlrev_b32 v139, 16, v67
v_lshlrev_b32 v140, 16, v68
v_lshlrev_b32 v141, 16, v69
v_lshlrev_b32 v142, 16, v70
v_lshlrev_b32 v143, 16, v71
v_and_b32 v56, s33, v56
v_and_b32 v57, s33, v57
v_and_b32 v58, s33, v58
v_and_b32 v59, s33, v59
v_and_b32 v60, s33, v60
v_and_b32 v61, s33, v61
v_and_b32 v62, s33, v62
v_and_b32 v63, s33, v63
v_and_b32 v64, s33, v64
v_and_b32 v65, s33, v65
v_and_b32 v66, s33, v66
v_and_b32 v67, s33, v67
v_and_b32 v68, s33, v68
v_and_b32 v69, s33, v69
v_and_b32 v70, s33, v70
v_and_b32 v71, s33, v71
v_pk_add_f32 v[128:129], v[128:129], v[132:133]
v_pk_add_f32 v[136:137], v[136:137], v[140:141]
v_pk_add_f32 v[130:131], v[130:131], v[134:135]
v_pk_add_f32 v[138:139], v[138:139], v[142:143]
v_pk_add_f32 v[56:57], v[56:57], v[60:61]
v_pk_add_f32 v[64:65], v[64:65], v[68:69]
v_pk_add_f32 v[58:59], v[58:59], v[62:63]
v_pk_add_f32 v[66:67], v[66:67], v[70:71]
v_pk_add_f32 v[128:129], v[128:129], v[136:137]
v_pk_add_f32 v[130:131], v[130:131], v[138:139]
v_pk_add_f32 v[56:57], v[56:57], v[64:65]
v_pk_add_f32 v[58:59], v[58:59], v[66:67]
v_cvt_pk_bf16_f32 v60, v128, v56
v_cvt_pk_bf16_f32 v61, v129, v57
v_cvt_pk_bf16_f32 v62, v130, v58
v_cvt_pk_bf16_f32 v63, v131, v59
buffer_store_dwordx2 v[60:61], v34, s[16:19], 0 offen offset:32
buffer_store_dwordx2 v[62:63], v34, s[16:19], s55 offen offset:32
s_barrier
buffer_load_dwordx4 v[76:79], v17, s[12:15], s89 offen offset:0 sc1
buffer_load_dwordx4 v[80:83], v17, s[12:15], s90 offen offset:0 sc1
buffer_load_dwordx4 v[84:87], v17, s[12:15], s91 offen offset:0 sc1
buffer_load_dwordx4 v[92:95], v17, s[12:15], s89 offen offset:3072 sc1
buffer_load_dwordx4 v[96:99], v17, s[12:15], s90 offen offset:3072 sc1
buffer_load_dwordx4 v[100:103], v17, s[12:15], s91 offen offset:3072 sc1
buffer_load_dwordx4 v[108:111], v20, s[12:15], s89 offen offset:0 sc1
buffer_load_dwordx4 v[112:115], v20, s[12:15], s90 offen offset:0 sc1
buffer_load_dwordx4 v[116:119], v20, s[12:15], s91 offen offset:0 sc1
s_waitcnt vmcnt(6) lgkmcnt(0)
v_lshlrev_b32 v128, 16, v72
v_lshlrev_b32 v129, 16, v73
v_lshlrev_b32 v130, 16, v74
v_lshlrev_b32 v131, 16, v75
v_lshlrev_b32 v132, 16, v76
v_lshlrev_b32 v133, 16, v77
v_lshlrev_b32 v134, 16, v78
v_lshlrev_b32 v135, 16, v79
v_lshlrev_b32 v136, 16, v80
v_lshlrev_b32 v137, 16, v81
v_lshlrev_b32 v138, 16, v82
v_lshlrev_b32 v139, 16, v83
v_lshlrev_b32 v140, 16, v84
v_lshlrev_b32 v141, 16, v85
v_lshlrev_b32 v142, 16, v86
v_lshlrev_b32 v143, 16, v87
v_and_b32 v72, s33, v72
v_and_b32 v73, s33, v73
v_and_b32 v74, s33, v74
v_and_b32 v75, s33, v75
v_and_b32 v76, s33, v76
v_and_b32 v77, s33, v77
v_and_b32 v78, s33, v78
v_and_b32 v79, s33, v79
v_and_b32 v80, s33, v80
v_and_b32 v81, s33, v81
v_and_b32 v82, s33, v82
v_and_b32 v83, s33, v83
v_and_b32 v84, s33, v84
v_and_b32 v85, s33, v85
v_and_b32 v86, s33, v86
v_and_b32 v87, s33, v87
v_pk_add_f32 v[128:129], v[128:129], v[132:133]
v_pk_add_f32 v[136:137], v[136:137], v[140:141]
v_pk_add_f32 v[130:131], v[130:131], v[134:135]
v_pk_add_f32 v[138:139], v[138:139], v[142:143]
v_pk_add_f32 v[72:73], v[72:73], v[76:77]
v_pk_add_f32 v[80:81], v[80:81], v[84:85]
v_pk_add_f32 v[74:75], v[74:75], v[78:79]
v_pk_add_f32 v[82:83], v[82:83], v[86:87]
v_pk_add_f32 v[128:129], v[128:129], v[136:137]
v_pk_add_f32 v[130:131], v[130:131], v[138:139]
v_pk_add_f32 v[72:73], v[72:73], v[80:81]
v_pk_add_f32 v[74:75], v[74:75], v[82:83]
v_cvt_pk_bf16_f32 v76, v128, v72
v_cvt_pk_bf16_f32 v77, v129, v73
v_cvt_pk_bf16_f32 v78, v130, v74
v_cvt_pk_bf16_f32 v79, v131, v75
buffer_store_dwordx2 v[76:77], v34, s[16:19], 0 offen offset:64
buffer_store_dwordx2 v[78:79], v34, s[16:19], s55 offen offset:64
s_waitcnt vmcnt(5) lgkmcnt(0)
v_lshlrev_b32 v128, 16, v88
v_lshlrev_b32 v129, 16, v89
v_lshlrev_b32 v130, 16, v90
v_lshlrev_b32 v131, 16, v91
v_lshlrev_b32 v132, 16, v92
v_lshlrev_b32 v133, 16, v93
v_lshlrev_b32 v134, 16, v94
v_lshlrev_b32 v135, 16, v95
v_lshlrev_b32 v136, 16, v96
v_lshlrev_b32 v137, 16, v97
v_lshlrev_b32 v138, 16, v98
v_lshlrev_b32 v139, 16, v99
v_lshlrev_b32 v140, 16, v100
v_lshlrev_b32 v141, 16, v101
v_lshlrev_b32 v142, 16, v102
v_lshlrev_b32 v143, 16, v103
v_and_b32 v88, s33, v88
v_and_b32 v89, s33, v89
v_and_b32 v90, s33, v90
v_and_b32 v91, s33, v91
v_and_b32 v92, s33, v92
v_and_b32 v93, s33, v93
v_and_b32 v94, s33, v94
v_and_b32 v95, s33, v95
v_and_b32 v96, s33, v96
v_and_b32 v97, s33, v97
v_and_b32 v98, s33, v98
v_and_b32 v99, s33, v99
v_and_b32 v100, s33, v100
v_and_b32 v101, s33, v101
v_and_b32 v102, s33, v102
v_and_b32 v103, s33, v103
v_pk_add_f32 v[128:129], v[128:129], v[132:133]
v_pk_add_f32 v[136:137], v[136:137], v[140:141]
v_pk_add_f32 v[130:131], v[130:131], v[134:135]
v_pk_add_f32 v[138:139], v[138:139], v[142:143]
v_pk_add_f32 v[88:89], v[88:89], v[92:93]
v_pk_add_f32 v[96:97], v[96:97], v[100:101]
v_pk_add_f32 v[90:91], v[90:91], v[94:95]
v_pk_add_f32 v[98:99], v[98:99], v[102:103]
v_pk_add_f32 v[128:129], v[128:129], v[136:137]
v_pk_add_f32 v[130:131], v[130:131], v[138:139]
v_pk_add_f32 v[88:89], v[88:89], v[96:97]
v_pk_add_f32 v[90:91], v[90:91], v[98:99]
v_cvt_pk_bf16_f32 v92, v128, v88
v_cvt_pk_bf16_f32 v93, v129, v89
v_cvt_pk_bf16_f32 v94, v130, v90
v_cvt_pk_bf16_f32 v95, v131, v91
buffer_store_dwordx2 v[92:93], v34, s[16:19], 0 offen offset:96
buffer_store_dwordx2 v[94:95], v34, s[16:19], s55 offen offset:96
s_waitcnt vmcnt(4) lgkmcnt(0)
v_lshlrev_b32 v128, 16, v104
v_lshlrev_b32 v129, 16, v105
v_lshlrev_b32 v130, 16, v106
v_lshlrev_b32 v131, 16, v107
v_lshlrev_b32 v132, 16, v108
v_lshlrev_b32 v133, 16, v109
v_lshlrev_b32 v134, 16, v110
v_lshlrev_b32 v135, 16, v111
v_lshlrev_b32 v136, 16, v112
v_lshlrev_b32 v137, 16, v113
v_lshlrev_b32 v138, 16, v114
v_lshlrev_b32 v139, 16, v115
v_lshlrev_b32 v140, 16, v116
v_lshlrev_b32 v141, 16, v117
v_lshlrev_b32 v142, 16, v118
v_lshlrev_b32 v143, 16, v119
v_and_b32 v104, s33, v104
v_and_b32 v105, s33, v105
v_and_b32 v106, s33, v106
v_and_b32 v107, s33, v107
v_and_b32 v108, s33, v108
v_and_b32 v109, s33, v109
v_and_b32 v110, s33, v110
v_and_b32 v111, s33, v111
v_and_b32 v112, s33, v112
v_and_b32 v113, s33, v113
v_and_b32 v114, s33, v114
v_and_b32 v115, s33, v115
v_and_b32 v116, s33, v116
v_and_b32 v117, s33, v117
v_and_b32 v118, s33, v118
v_and_b32 v119, s33, v119
v_pk_add_f32 v[128:129], v[128:129], v[132:133]
v_pk_add_f32 v[136:137], v[136:137], v[140:141]
v_pk_add_f32 v[130:131], v[130:131], v[134:135]
v_pk_add_f32 v[138:139], v[138:139], v[142:143]
v_pk_add_f32 v[104:105], v[104:105], v[108:109]
v_pk_add_f32 v[112:113], v[112:113], v[116:117]
v_pk_add_f32 v[106:107], v[106:107], v[110:111]
v_pk_add_f32 v[114:115], v[114:115], v[118:119]
v_pk_add_f32 v[128:129], v[128:129], v[136:137]
v_pk_add_f32 v[130:131], v[130:131], v[138:139]
v_pk_add_f32 v[104:105], v[104:105], v[112:113]
v_pk_add_f32 v[106:107], v[106:107], v[114:115]
v_cvt_pk_bf16_f32 v108, v128, v104
v_cvt_pk_bf16_f32 v109, v129, v105
v_cvt_pk_bf16_f32 v110, v130, v106
v_cvt_pk_bf16_f32 v111, v131, v107
buffer_store_dwordx2 v[108:109], v34, s[16:19], 0 offen offset:128
buffer_store_dwordx2 v[110:111], v34, s[16:19], s55 offen offset:128
L_end:
s_endpgm
L_fallback:
s_waitcnt vmcnt(0) lgkmcnt(0)
s_mov_b32 s4, s36
s_mov_b32 s5, s37
s_mov_b32 s6, 0x40000
s_mov_b32 s7, 0x20000
s_mov_b32 s8, s38
s_mov_b32 s9, s39
s_mov_b32 s10, 0x40000
s_mov_b32 s11, 0x20000
s_lshl_b32 s52, s20, 13
s_add_u32 s52, s52, 131072
v_xor_b32 v58, v3, v4
v_lshlrev_b32 v59, 1, v4
v_xor_b32 v59, v3, v59
v_lshlrev_b32 v60, 8, v4
v_xor_b32 v61, 0, v58
v_lshl_add_u32 v40, v61, 4, v60
v_xor_b32 v61, 4, v58
v_lshl_add_u32 v41, v61, 4, v60
v_xor_b32 v61, 8, v58
v_lshl_add_u32 v42, v61, 4, v60
v_xor_b32 v61, 12, v58
v_lshl_add_u32 v43, v61, 4, v60
v_xor_b32 v61, 0, v59
v_lshl_add_u32 v44, v61, 4, v60
v_xor_b32 v61, 8, v59
v_lshl_add_u32 v45, v61, 4, v60
s_sub_u32 s34, s52, s46
v_add_u32 v20, s34, v20
v_add_u32 v21, s34, v21
v_add_u32 v22, s34, v22
v_add_u32 v23, s34, v23
s_sub_u32 s34, s52, s47
v_add_u32 v24, s34, v24
v_add_u32 v25, s34, v25
v_add_u32 v26, s34, v26
v_add_u32 v27, s34, v27
v_add_u32 v28, s34, v28
v_add_u32 v29, s34, v29
v_add_u32 v30, s34, v30
v_add_u32 v31, s34, v31
v_accvgpr_write_b32 a0, 0
v_accvgpr_write_b32 a1, 0
v_accvgpr_write_b32 a2, 0
v_accvgpr_write_b32 a3, 0
v_accvgpr_write_b32 a4, 0
v_accvgpr_write_b32 a5, 0
v_accvgpr_write_b32 a6, 0
v_accvgpr_write_b32 a7, 0
v_accvgpr_write_b32 a8, 0
v_accvgpr_write_b32 a9, 0
v_accvgpr_write_b32 a10, 0
v_accvgpr_write_b32 a11, 0
v_accvgpr_write_b32 a12, 0
v_accvgpr_write_b32 a13, 0
v_accvgpr_write_b32 a14, 0
v_accvgpr_write_b32 a15, 0
v_accvgpr_write_b32 a16, 0
v_accvgpr_write_b32 a17, 0
v_accvgpr_write_b32 a18, 0
v_accvgpr_write_b32 a19, 0
v_accvgpr_write_b32 a20, 0
v_accvgpr_write_b32 a21, 0
v_accvgpr_write_b32 a22, 0
v_accvgpr_write_b32 a23, 0
v_accvgpr_write_b32 a24, 0
v_accvgpr_write_b32 a25, 0
v_accvgpr_write_b32 a26, 0
v_accvgpr_write_b32 a27, 0
v_accvgpr_write_b32 a28, 0
v_accvgpr_write_b32 a29, 0
v_accvgpr_write_b32 a30, 0
v_accvgpr_write_b32 a31, 0
v_accvgpr_write_b32 a32, 0
v_accvgpr_write_b32 a33, 0
v_accvgpr_write_b32 a34, 0
v_accvgpr_write_b32 a35, 0
v_accvgpr_write_b32 a36, 0
v_accvgpr_write_b32 a37, 0
v_accvgpr_write_b32 a38, 0
v_accvgpr_write_b32 a39, 0
v_accvgpr_write_b32 a40, 0
v_accvgpr_write_b32 a41, 0
v_accvgpr_write_b32 a42, 0
v_accvgpr_write_b32 a43, 0
v_accvgpr_write_b32 a44, 0
v_accvgpr_write_b32 a45, 0
v_accvgpr_write_b32 a46, 0
v_accvgpr_write_b32 a47, 0
v_accvgpr_write_b32 a48, 0
v_accvgpr_write_b32 a49, 0
v_accvgpr_write_b32 a50, 0
v_accvgpr_write_b32 a51, 0
v_accvgpr_write_b32 a52, 0
v_accvgpr_write_b32 a53, 0
v_accvgpr_write_b32 a54, 0
v_accvgpr_write_b32 a55, 0
v_accvgpr_write_b32 a56, 0
v_accvgpr_write_b32 a57, 0
v_accvgpr_write_b32 a58, 0
v_accvgpr_write_b32 a59, 0
v_accvgpr_write_b32 a60, 0
v_accvgpr_write_b32 a61, 0
v_accvgpr_write_b32 a62, 0
v_accvgpr_write_b32 a63, 0
v_accvgpr_write_b32 a64, 0
v_accvgpr_write_b32 a65, 0
v_accvgpr_write_b32 a66, 0
v_accvgpr_write_b32 a67, 0
v_accvgpr_write_b32 a68, 0
v_accvgpr_write_b32 a69, 0
v_accvgpr_write_b32 a70, 0
v_accvgpr_write_b32 a71, 0
v_accvgpr_write_b32 a72, 0
v_accvgpr_write_b32 a73, 0
v_accvgpr_write_b32 a74, 0
v_accvgpr_write_b32 a75, 0
v_accvgpr_write_b32 a76, 0
v_accvgpr_write_b32 a77, 0
v_accvgpr_write_b32 a78, 0
v_accvgpr_write_b32 a79, 0
v_accvgpr_write_b32 a80, 0
v_accvgpr_write_b32 a81, 0
v_accvgpr_write_b32 a82, 0
v_accvgpr_write_b32 a83, 0
v_accvgpr_write_b32 a84, 0
v_accvgpr_write_b32 a85, 0
v_accvgpr_write_b32 a86, 0
v_accvgpr_write_b32 a87, 0
v_accvgpr_write_b32 a88, 0
v_accvgpr_write_b32 a89, 0
v_accvgpr_write_b32 a90, 0
v_accvgpr_write_b32 a91, 0
v_accvgpr_write_b32 a92, 0
v_accvgpr_write_b32 a93, 0
v_accvgpr_write_b32 a94, 0
v_accvgpr_write_b32 a95, 0
v_accvgpr_write_b32 a96, 0
v_accvgpr_write_b32 a97, 0
v_accvgpr_write_b32 a98, 0
v_accvgpr_write_b32 a99, 0
v_accvgpr_write_b32 a100, 0
v_accvgpr_write_b32 a101, 0
v_accvgpr_write_b32 a102, 0
v_accvgpr_write_b32 a103, 0
v_accvgpr_write_b32 a104, 0
v_accvgpr_write_b32 a105, 0
v_accvgpr_write_b32 a106, 0
v_accvgpr_write_b32 a107, 0
v_accvgpr_write_b32 a108, 0
v_accvgpr_write_b32 a109, 0
v_accvgpr_write_b32 a110, 0
v_accvgpr_write_b32 a111, 0
v_accvgpr_write_b32 a112, 0
v_accvgpr_write_b32 a113, 0
v_accvgpr_write_b32 a114, 0
v_accvgpr_write_b32 a115, 0
v_accvgpr_write_b32 a116, 0
v_accvgpr_write_b32 a117, 0
v_accvgpr_write_b32 a118, 0
v_accvgpr_write_b32 a119, 0
v_accvgpr_write_b32 a120, 0
v_accvgpr_write_b32 a121, 0
v_accvgpr_write_b32 a122, 0
v_accvgpr_write_b32 a123, 0
v_accvgpr_write_b32 a124, 0
v_accvgpr_write_b32 a125, 0
v_accvgpr_write_b32 a126, 0
v_accvgpr_write_b32 a127, 0
v_accvgpr_write_b32 a128, 0
v_accvgpr_write_b32 a129, 0
v_accvgpr_write_b32 a130, 0
v_accvgpr_write_b32 a131, 0
v_accvgpr_write_b32 a132, 0
v_accvgpr_write_b32 a133, 0
v_accvgpr_write_b32 a134, 0
v_accvgpr_write_b32 a135, 0
v_accvgpr_write_b32 a136, 0
v_accvgpr_write_b32 a137, 0
v_accvgpr_write_b32 a138, 0
v_accvgpr_write_b32 a139, 0
v_accvgpr_write_b32 a140, 0
v_accvgpr_write_b32 a141, 0
v_accvgpr_write_b32 a142, 0
v_accvgpr_write_b32 a143, 0
v_accvgpr_write_b32 a144, 0
v_accvgpr_write_b32 a145, 0
v_accvgpr_write_b32 a146, 0
v_accvgpr_write_b32 a147, 0
v_accvgpr_write_b32 a148, 0
v_accvgpr_write_b32 a149, 0
v_accvgpr_write_b32 a150, 0
v_accvgpr_write_b32 a151, 0
v_accvgpr_write_b32 a152, 0
v_accvgpr_write_b32 a153, 0
v_accvgpr_write_b32 a154, 0
v_accvgpr_write_b32 a155, 0
v_accvgpr_write_b32 a156, 0
v_accvgpr_write_b32 a157, 0
v_accvgpr_write_b32 a158, 0
v_accvgpr_write_b32 a159, 0
v_accvgpr_write_b32 a160, 0
v_accvgpr_write_b32 a161, 0
v_accvgpr_write_b32 a162, 0
v_accvgpr_write_b32 a163, 0
v_accvgpr_write_b32 a164, 0
v_accvgpr_write_b32 a165, 0
v_accvgpr_write_b32 a166, 0
v_accvgpr_write_b32 a167, 0
v_accvgpr_write_b32 a168, 0
v_accvgpr_write_b32 a169, 0
v_accvgpr_write_b32 a170, 0
v_accvgpr_write_b32 a171, 0
v_accvgpr_write_b32 a172, 0
v_accvgpr_write_b32 a173, 0
v_accvgpr_write_b32 a174, 0
v_accvgpr_write_b32 a175, 0
v_accvgpr_write_b32 a176, 0
v_accvgpr_write_b32 a177, 0
v_accvgpr_write_b32 a178, 0
v_accvgpr_write_b32 a179, 0
v_accvgpr_write_b32 a180, 0
v_accvgpr_write_b32 a181, 0
v_accvgpr_write_b32 a182, 0
v_accvgpr_write_b32 a183, 0
v_accvgpr_write_b32 a184, 0
v_accvgpr_write_b32 a185, 0
v_accvgpr_write_b32 a186, 0
v_accvgpr_write_b32 a187, 0
v_accvgpr_write_b32 a188, 0
v_accvgpr_write_b32 a189, 0
v_accvgpr_write_b32 a190, 0
v_accvgpr_write_b32 a191, 0
v_mov_b32 v232, 0
v_mov_b32 v233, 0
v_mov_b32 v234, 0
v_mov_b32 v235, 0
v_mov_b32 v236, 0
v_mov_b32 v237, 0
v_mov_b32 v238, 0
v_mov_b32 v239, 0
v_mov_b32 v240, 0
v_mov_b32 v241, 0
v_mov_b32 v242, 0
v_mov_b32 v243, 0
v_mov_b32 v244, 0
v_mov_b32 v245, 0
v_mov_b32 v246, 0
v_mov_b32 v247, 0
v_mov_b32 v248, 0
v_mov_b32 v249, 0
v_mov_b32 v250, 0
v_mov_b32 v251, 0
v_mov_b32 v252, 0
v_mov_b32 v253, 0
v_mov_b32 v254, 0
v_mov_b32 v255, 0
s_mov_b32 s60, 0
L_fb_loop:
s_add_u32 m0, s52, 0
s_add_u32 s55, s60, 0
buffer_load_dwordx4 v40, s[4:7], s55 offen lds
s_add_u32 m0, s52, 1024
s_add_u32 s55, s60, 1024
buffer_load_dwordx4 v41, s[4:7], s55 offen lds
s_add_u32 m0, s52, 2048
s_add_u32 s55, s60, 2048
buffer_load_dwordx4 v42, s[4:7], s55 offen lds
s_add_u32 m0, s52, 3072
s_add_u32 s55, s60, 3072
buffer_load_dwordx4 v43, s[4:7], s55 offen lds
s_add_u32 m0, s52, 4096
s_add_u32 s55, s60, 4096
buffer_load_dwordx4 v40, s[4:7], s55 offen lds
s_add_u32 m0, s52, 5120
s_add_u32 s55, s60, 5120
buffer_load_dwordx4 v41, s[4:7], s55 offen lds
s_add_u32 m0, s52, 6144
s_add_u32 s55, s60, 6144
buffer_load_dwordx4 v42, s[4:7], s55 offen lds
s_add_u32 m0, s52, 7168
s_add_u32 s55, s60, 7168
buffer_load_dwordx4 v43, s[4:7], s55 offen lds
s_waitcnt vmcnt(0)
ds_read_b128 a[192:195], v20 offset:0
ds_read_b128 a[196:199], v21 offset:0
ds_read_b128 a[200:203], v22 offset:0
ds_read_b128 a[204:207], v23 offset:0
ds_read_b128 a[208:211], v20 offset:4096
ds_read_b128 a[212:215], v21 offset:4096
ds_read_b128 a[216:219], v22 offset:4096
ds_read_b128 a[220:223], v23 offset:4096
s_waitcnt lgkmcnt(0)
s_add_u32 m0, s52, 0
s_add_u32 s55, s60, 0
buffer_load_dwordx4 v44, s[8:11], s55 offen lds
s_add_u32 m0, s52, 1024
s_add_u32 s55, s60, 1024
buffer_load_dwordx4 v45, s[8:11], s55 offen lds
s_add_u32 m0, s52, 2048
s_add_u32 s55, s60, 2048
buffer_load_dwordx4 v44, s[8:11], s55 offen lds
s_add_u32 m0, s52, 3072
s_add_u32 s55, s60, 3072
buffer_load_dwordx4 v45, s[8:11], s55 offen lds
s_add_u32 m0, s52, 4096
s_add_u32 s55, s60, 4096
buffer_load_dwordx4 v44, s[8:11], s55 offen lds
s_add_u32 m0, s52, 5120
s_add_u32 s55, s60, 5120
buffer_load_dwordx4 v45, s[8:11], s55 offen lds
s_add_u32 m0, s52, 6144
s_add_u32 s55, s60, 6144
buffer_load_dwordx4 v44, s[8:11], s55 offen lds
s_add_u32 m0, s52, 7168
s_add_u32 s55, s60, 7168
buffer_load_dwordx4 v45, s[8:11], s55 offen lds
s_waitcnt vmcnt(0)
ds_read_b64_tr_b16 a[224:225], v24 offset:0
ds_read_b64_tr_b16 a[226:227], v24 offset:4096
ds_read_b64_tr_b16 a[228:229], v25 offset:0
ds_read_b64_tr_b16 a[230:231], v25 offset:4096
ds_read_b64_tr_b16 a[232:233], v26 offset:0
ds_read_b64_tr_b16 a[234:235], v26 offset:4096
ds_read_b64_tr_b16 a[236:237], v27 offset:0
ds_read_b64_tr_b16 a[238:239], v27 offset:4096
ds_read_b64_tr_b16 a[240:241], v28 offset:0
ds_read_b64_tr_b16 a[242:243], v28 offset:4096
ds_read_b64_tr_b16 a[244:245], v29 offset:0
ds_read_b64_tr_b16 a[246:247], v29 offset:4096
ds_read_b64_tr_b16 a[248:249], v30 offset:0
ds_read_b64_tr_b16 a[250:251], v30 offset:4096
ds_read_b64_tr_b16 a[252:253], v31 offset:0
ds_read_b64_tr_b16 a[254:255], v31 offset:4096
s_waitcnt lgkmcnt(0)
v_mfma_f32_16x16x32_bf16 v[160:163], a[192:195], v[64:67], v[208:211]
v_mfma_f32_16x16x32_bf16 v[160:163], a[196:199], v[68:71], v[160:163]
v_mfma_f32_16x16x32_bf16 v[160:163], a[200:203], v[72:75], v[160:163]
v_mfma_f32_16x16x32_bf16 v[160:163], a[204:207], v[76:79], v[160:163]
v_mfma_f32_16x16x32_bf16 v[164:167], a[208:211], v[64:67], v[208:211]
v_mfma_f32_16x16x32_bf16 v[164:167], a[212:215], v[68:71], v[164:167]
v_mfma_f32_16x16x32_bf16 v[164:167], a[216:219], v[72:75], v[164:167]
v_mfma_f32_16x16x32_bf16 v[164:167], a[220:223], v[76:79], v[164:167]
v_mfma_f32_16x16x32_bf16 v[168:171], a[192:195], v[80:83], v[212:215]
v_mfma_f32_16x16x32_bf16 v[168:171], a[196:199], v[84:87], v[168:171]
v_mfma_f32_16x16x32_bf16 v[168:171], a[200:203], v[88:91], v[168:171]
v_mfma_f32_16x16x32_bf16 v[168:171], a[204:207], v[92:95], v[168:171]
v_mfma_f32_16x16x32_bf16 v[172:175], a[208:211], v[80:83], v[212:215]
v_mfma_f32_16x16x32_bf16 v[172:175], a[212:215], v[84:87], v[172:175]
v_mfma_f32_16x16x32_bf16 v[172:175], a[216:219], v[88:91], v[172:175]
v_mfma_f32_16x16x32_bf16 v[172:175], a[220:223], v[92:95], v[172:175]
s_nop 7
v_max3_f32 v52, v160, v161, v162
v_max3_f32 v52, v52, v163, v164
v_max3_f32 v52, v52, v165, v166
v_max3_f32 v52, v52, v167, 0
v_mov_b32 v53, v52
s_nop 1
v_permlane16_swap_b32 v52, v53
v_max_f32 v52, v52, v53
v_mov_b32 v53, v52
s_nop 1
v_permlane32_swap_b32 v52, v53
v_max_f32 v52, v52, v53
v_exp_f32 v53, -v52
v_sub_f32 v160, v160, v52
v_sub_f32 v161, v161, v52
v_sub_f32 v162, v162, v52
v_sub_f32 v163, v163, v52
v_sub_f32 v164, v164, v52
v_sub_f32 v165, v165, v52
v_sub_f32 v166, v166, v52
v_sub_f32 v167, v167, v52
v_sub_f32 v208, v208, v52
v_sub_f32 v209, v209, v52
v_sub_f32 v210, v210, v52
v_sub_f32 v211, v211, v52
v_mul_f32 v232, v232, v53
v_mul_f32 v233, v233, v53
v_mul_f32 v234, v234, v53
v_mul_f32 v235, v235, v53
v_accvgpr_read_b32 v54, a0
v_accvgpr_read_b32 v55, a1
v_accvgpr_read_b32 v56, a2
v_accvgpr_read_b32 v57, a3
v_mul_f32 v54, v54, v53
v_mul_f32 v55, v55, v53
v_mul_f32 v56, v56, v53
v_mul_f32 v57, v57, v53
v_accvgpr_write_b32 a0, v54
v_accvgpr_write_b32 a1, v55
v_accvgpr_write_b32 a2, v56
v_accvgpr_write_b32 a3, v57
v_accvgpr_read_b32 v54, a4
v_accvgpr_read_b32 v55, a5
v_accvgpr_read_b32 v56, a6
v_accvgpr_read_b32 v57, a7
v_mul_f32 v54, v54, v53
v_mul_f32 v55, v55, v53
v_mul_f32 v56, v56, v53
v_mul_f32 v57, v57, v53
v_accvgpr_write_b32 a4, v54
v_accvgpr_write_b32 a5, v55
v_accvgpr_write_b32 a6, v56
v_accvgpr_write_b32 a7, v57
v_accvgpr_read_b32 v54, a8
v_accvgpr_read_b32 v55, a9
v_accvgpr_read_b32 v56, a10
v_accvgpr_read_b32 v57, a11
v_mul_f32 v54, v54, v53
v_mul_f32 v55, v55, v53
v_mul_f32 v56, v56, v53
v_mul_f32 v57, v57, v53
v_accvgpr_write_b32 a8, v54
v_accvgpr_write_b32 a9, v55
v_accvgpr_write_b32 a10, v56
v_accvgpr_write_b32 a11, v57
v_accvgpr_read_b32 v54, a12
v_accvgpr_read_b32 v55, a13
v_accvgpr_read_b32 v56, a14
v_accvgpr_read_b32 v57, a15
v_mul_f32 v54, v54, v53
v_mul_f32 v55, v55, v53
v_mul_f32 v56, v56, v53
v_mul_f32 v57, v57, v53
v_accvgpr_write_b32 a12, v54
v_accvgpr_write_b32 a13, v55
v_accvgpr_write_b32 a14, v56
v_accvgpr_write_b32 a15, v57
v_accvgpr_read_b32 v54, a16
v_accvgpr_read_b32 v55, a17
v_accvgpr_read_b32 v56, a18
v_accvgpr_read_b32 v57, a19
v_mul_f32 v54, v54, v53
v_mul_f32 v55, v55, v53
v_mul_f32 v56, v56, v53
v_mul_f32 v57, v57, v53
v_accvgpr_write_b32 a16, v54
v_accvgpr_write_b32 a17, v55
v_accvgpr_write_b32 a18, v56
v_accvgpr_write_b32 a19, v57
v_accvgpr_read_b32 v54, a20
v_accvgpr_read_b32 v55, a21
v_accvgpr_read_b32 v56, a22
v_accvgpr_read_b32 v57, a23
v_mul_f32 v54, v54, v53
v_mul_f32 v55, v55, v53
v_mul_f32 v56, v56, v53
v_mul_f32 v57, v57, v53
v_accvgpr_write_b32 a20, v54
v_accvgpr_write_b32 a21, v55
v_accvgpr_write_b32 a22, v56
v_accvgpr_write_b32 a23, v57
v_accvgpr_read_b32 v54, a24
v_accvgpr_read_b32 v55, a25
v_accvgpr_read_b32 v56, a26
v_accvgpr_read_b32 v57, a27
v_mul_f32 v54, v54, v53
v_mul_f32 v55, v55, v53
v_mul_f32 v56, v56, v53
v_mul_f32 v57, v57, v53
v_accvgpr_write_b32 a24, v54
v_accvgpr_write_b32 a25, v55
v_accvgpr_write_b32 a26, v56
v_accvgpr_write_b32 a27, v57
v_accvgpr_read_b32 v54, a28
v_accvgpr_read_b32 v55, a29
v_accvgpr_read_b32 v56, a30
v_accvgpr_read_b32 v57, a31
v_mul_f32 v54, v54, v53
v_mul_f32 v55, v55, v53
v_mul_f32 v56, v56, v53
v_mul_f32 v57, v57, v53
v_accvgpr_write_b32 a28, v54
v_accvgpr_write_b32 a29, v55
v_accvgpr_write_b32 a30, v56
v_accvgpr_write_b32 a31, v57
v_max3_f32 v52, v168, v169, v170
v_max3_f32 v52, v52, v171, v172
v_max3_f32 v52, v52, v173, v174
v_max3_f32 v52, v52, v175, 0
v_mov_b32 v53, v52
s_nop 1
v_permlane16_swap_b32 v52, v53
v_max_f32 v52, v52, v53
v_mov_b32 v53, v52
s_nop 1
v_permlane32_swap_b32 v52, v53
v_max_f32 v52, v52, v53
v_exp_f32 v53, -v52
v_sub_f32 v168, v168, v52
v_sub_f32 v169, v169, v52
v_sub_f32 v170, v170, v52
v_sub_f32 v171, v171, v52
v_sub_f32 v172, v172, v52
v_sub_f32 v173, v173, v52
v_sub_f32 v174, v174, v52
v_sub_f32 v175, v175, v52
v_sub_f32 v212, v212, v52
v_sub_f32 v213, v213, v52
v_sub_f32 v214, v214, v52
v_sub_f32 v215, v215, v52
v_mul_f32 v236, v236, v53
v_mul_f32 v237, v237, v53
v_mul_f32 v238, v238, v53
v_mul_f32 v239, v239, v53
v_accvgpr_read_b32 v54, a32
v_accvgpr_read_b32 v55, a33
v_accvgpr_read_b32 v56, a34
v_accvgpr_read_b32 v57, a35
v_mul_f32 v54, v54, v53
v_mul_f32 v55, v55, v53
v_mul_f32 v56, v56, v53
v_mul_f32 v57, v57, v53
v_accvgpr_write_b32 a32, v54
v_accvgpr_write_b32 a33, v55
v_accvgpr_write_b32 a34, v56
v_accvgpr_write_b32 a35, v57
v_accvgpr_read_b32 v54, a36
v_accvgpr_read_b32 v55, a37
v_accvgpr_read_b32 v56, a38
v_accvgpr_read_b32 v57, a39
v_mul_f32 v54, v54, v53
v_mul_f32 v55, v55, v53
v_mul_f32 v56, v56, v53
v_mul_f32 v57, v57, v53
v_accvgpr_write_b32 a36, v54
v_accvgpr_write_b32 a37, v55
v_accvgpr_write_b32 a38, v56
v_accvgpr_write_b32 a39, v57
v_accvgpr_read_b32 v54, a40
v_accvgpr_read_b32 v55, a41
v_accvgpr_read_b32 v56, a42
v_accvgpr_read_b32 v57, a43
v_mul_f32 v54, v54, v53
v_mul_f32 v55, v55, v53
v_mul_f32 v56, v56, v53
v_mul_f32 v57, v57, v53
v_accvgpr_write_b32 a40, v54
v_accvgpr_write_b32 a41, v55
v_accvgpr_write_b32 a42, v56
v_accvgpr_write_b32 a43, v57
v_accvgpr_read_b32 v54, a44
v_accvgpr_read_b32 v55, a45
v_accvgpr_read_b32 v56, a46
v_accvgpr_read_b32 v57, a47
v_mul_f32 v54, v54, v53
v_mul_f32 v55, v55, v53
v_mul_f32 v56, v56, v53
v_mul_f32 v57, v57, v53
v_accvgpr_write_b32 a44, v54
v_accvgpr_write_b32 a45, v55
v_accvgpr_write_b32 a46, v56
v_accvgpr_write_b32 a47, v57
v_accvgpr_read_b32 v54, a48
v_accvgpr_read_b32 v55, a49
v_accvgpr_read_b32 v56, a50
v_accvgpr_read_b32 v57, a51
v_mul_f32 v54, v54, v53
v_mul_f32 v55, v55, v53
v_mul_f32 v56, v56, v53
v_mul_f32 v57, v57, v53
v_accvgpr_write_b32 a48, v54
v_accvgpr_write_b32 a49, v55
v_accvgpr_write_b32 a50, v56
v_accvgpr_write_b32 a51, v57
v_accvgpr_read_b32 v54, a52
v_accvgpr_read_b32 v55, a53
v_accvgpr_read_b32 v56, a54
v_accvgpr_read_b32 v57, a55
v_mul_f32 v54, v54, v53
v_mul_f32 v55, v55, v53
v_mul_f32 v56, v56, v53
v_mul_f32 v57, v57, v53
v_accvgpr_write_b32 a52, v54
v_accvgpr_write_b32 a53, v55
v_accvgpr_write_b32 a54, v56
v_accvgpr_write_b32 a55, v57
v_accvgpr_read_b32 v54, a56
v_accvgpr_read_b32 v55, a57
v_accvgpr_read_b32 v56, a58
v_accvgpr_read_b32 v57, a59
v_mul_f32 v54, v54, v53
v_mul_f32 v55, v55, v53
v_mul_f32 v56, v56, v53
v_mul_f32 v57, v57, v53
v_accvgpr_write_b32 a56, v54
v_accvgpr_write_b32 a57, v55
v_accvgpr_write_b32 a58, v56
v_accvgpr_write_b32 a59, v57
v_accvgpr_read_b32 v54, a60
v_accvgpr_read_b32 v55, a61
v_accvgpr_read_b32 v56, a62
v_accvgpr_read_b32 v57, a63
v_mul_f32 v54, v54, v53
v_mul_f32 v55, v55, v53
v_mul_f32 v56, v56, v53
v_mul_f32 v57, v57, v53
v_accvgpr_write_b32 a60, v54
v_accvgpr_write_b32 a61, v55
v_accvgpr_write_b32 a62, v56
v_accvgpr_write_b32 a63, v57
v_exp_f32 v160, v160
v_exp_f32 v161, v161
v_exp_f32 v162, v162
v_exp_f32 v163, v163
v_exp_f32 v164, v164
v_exp_f32 v165, v165
v_exp_f32 v166, v166
v_exp_f32 v167, v167
v_exp_f32 v168, v168
v_exp_f32 v169, v169
v_exp_f32 v170, v170
v_exp_f32 v171, v171
v_exp_f32 v172, v172
v_exp_f32 v173, v173
v_exp_f32 v174, v174
v_exp_f32 v175, v175
s_nop 0
v_cvt_pk_bf16_f32 v192, v160, v161
v_cvt_pk_bf16_f32 v193, v162, v163
v_cvt_pk_bf16_f32 v194, v164, v165
v_cvt_pk_bf16_f32 v195, v166, v167
v_cvt_pk_bf16_f32 v196, v168, v169
v_cvt_pk_bf16_f32 v197, v170, v171
v_cvt_pk_bf16_f32 v198, v172, v173
v_cvt_pk_bf16_f32 v199, v174, v175
s_nop 1
v_mfma_f32_16x16x32_bf16 a[0:3], a[224:227], v[192:195], a[0:3]
v_mfma_f32_16x16x32_bf16 a[32:35], a[224:227], v[196:199], a[32:35]
v_mfma_f32_16x16x32_bf16 a[4:7], a[228:231], v[192:195], a[4:7]
v_mfma_f32_16x16x32_bf16 a[36:39], a[228:231], v[196:199], a[36:39]
v_mfma_f32_16x16x32_bf16 a[8:11], a[232:235], v[192:195], a[8:11]
v_mfma_f32_16x16x32_bf16 a[40:43], a[232:235], v[196:199], a[40:43]
v_mfma_f32_16x16x32_bf16 a[12:15], a[236:239], v[192:195], a[12:15]
v_mfma_f32_16x16x32_bf16 a[44:47], a[236:239], v[196:199], a[44:47]
v_mfma_f32_16x16x32_bf16 a[16:19], a[240:243], v[192:195], a[16:19]
v_mfma_f32_16x16x32_bf16 a[48:51], a[240:243], v[196:199], a[48:51]
v_mfma_f32_16x16x32_bf16 a[20:23], a[244:247], v[192:195], a[20:23]
v_mfma_f32_16x16x32_bf16 a[52:55], a[244:247], v[196:199], a[52:55]
v_mfma_f32_16x16x32_bf16 a[24:27], a[248:251], v[192:195], a[24:27]
v_mfma_f32_16x16x32_bf16 a[56:59], a[248:251], v[196:199], a[56:59]
v_mfma_f32_16x16x32_bf16 a[28:31], a[252:255], v[192:195], a[28:31]
v_mfma_f32_16x16x32_bf16 a[60:63], a[252:255], v[196:199], a[60:63]
v_mfma_f32_16x16x32_bf16 v[232:235], v[48:51], v[192:195], v[232:235]
v_mfma_f32_16x16x32_bf16 v[236:239], v[48:51], v[196:199], v[236:239]
v_mfma_f32_16x16x32_bf16 v[160:163], a[192:195], v[96:99], v[216:219]
v_mfma_f32_16x16x32_bf16 v[160:163], a[196:199], v[100:103], v[160:163]
v_mfma_f32_16x16x32_bf16 v[160:163], a[200:203], v[104:107], v[160:163]
v_mfma_f32_16x16x32_bf16 v[160:163], a[204:207], v[108:111], v[160:163]
v_mfma_f32_16x16x32_bf16 v[164:167], a[208:211], v[96:99], v[216:219]
v_mfma_f32_16x16x32_bf16 v[164:167], a[212:215], v[100:103], v[164:167]
v_mfma_f32_16x16x32_bf16 v[164:167], a[216:219], v[104:107], v[164:167]
v_mfma_f32_16x16x32_bf16 v[164:167], a[220:223], v[108:111], v[164:167]
v_mfma_f32_16x16x32_bf16 v[168:171], a[192:195], v[112:115], v[220:223]
v_mfma_f32_16x16x32_bf16 v[168:171], a[196:199], v[116:119], v[168:171]
v_mfma_f32_16x16x32_bf16 v[168:171], a[200:203], v[120:123], v[168:171]
v_mfma_f32_16x16x32_bf16 v[168:171], a[204:207], v[124:127], v[168:171]
v_mfma_f32_16x16x32_bf16 v[172:175], a[208:211], v[112:115], v[220:223]
v_mfma_f32_16x16x32_bf16 v[172:175], a[212:215], v[116:119], v[172:175]
v_mfma_f32_16x16x32_bf16 v[172:175], a[216:219], v[120:123], v[172:175]
v_mfma_f32_16x16x32_bf16 v[172:175], a[220:223], v[124:127], v[172:175]
s_nop 7
v_max3_f32 v52, v160, v161, v162
v_max3_f32 v52, v52, v163, v164
v_max3_f32 v52, v52, v165, v166
v_max3_f32 v52, v52, v167, 0
v_mov_b32 v53, v52
s_nop 1
v_permlane16_swap_b32 v52, v53
v_max_f32 v52, v52, v53
v_mov_b32 v53, v52
s_nop 1
v_permlane32_swap_b32 v52, v53
v_max_f32 v52, v52, v53
v_exp_f32 v53, -v52
v_sub_f32 v160, v160, v52
v_sub_f32 v161, v161, v52
v_sub_f32 v162, v162, v52
v_sub_f32 v163, v163, v52
v_sub_f32 v164, v164, v52
v_sub_f32 v165, v165, v52
v_sub_f32 v166, v166, v52
v_sub_f32 v167, v167, v52
v_sub_f32 v216, v216, v52
v_sub_f32 v217, v217, v52
v_sub_f32 v218, v218, v52
v_sub_f32 v219, v219, v52
v_mul_f32 v240, v240, v53
v_mul_f32 v241, v241, v53
v_mul_f32 v242, v242, v53
v_mul_f32 v243, v243, v53
v_accvgpr_read_b32 v54, a64
v_accvgpr_read_b32 v55, a65
v_accvgpr_read_b32 v56, a66
v_accvgpr_read_b32 v57, a67
v_mul_f32 v54, v54, v53
v_mul_f32 v55, v55, v53
v_mul_f32 v56, v56, v53
v_mul_f32 v57, v57, v53
v_accvgpr_write_b32 a64, v54
v_accvgpr_write_b32 a65, v55
v_accvgpr_write_b32 a66, v56
v_accvgpr_write_b32 a67, v57
v_accvgpr_read_b32 v54, a68
v_accvgpr_read_b32 v55, a69
v_accvgpr_read_b32 v56, a70
v_accvgpr_read_b32 v57, a71
v_mul_f32 v54, v54, v53
v_mul_f32 v55, v55, v53
v_mul_f32 v56, v56, v53
v_mul_f32 v57, v57, v53
v_accvgpr_write_b32 a68, v54
v_accvgpr_write_b32 a69, v55
v_accvgpr_write_b32 a70, v56
v_accvgpr_write_b32 a71, v57
v_accvgpr_read_b32 v54, a72
v_accvgpr_read_b32 v55, a73
v_accvgpr_read_b32 v56, a74
v_accvgpr_read_b32 v57, a75
v_mul_f32 v54, v54, v53
v_mul_f32 v55, v55, v53
v_mul_f32 v56, v56, v53
v_mul_f32 v57, v57, v53
v_accvgpr_write_b32 a72, v54
v_accvgpr_write_b32 a73, v55
v_accvgpr_write_b32 a74, v56
v_accvgpr_write_b32 a75, v57
v_accvgpr_read_b32 v54, a76
v_accvgpr_read_b32 v55, a77
v_accvgpr_read_b32 v56, a78
v_accvgpr_read_b32 v57, a79
v_mul_f32 v54, v54, v53
v_mul_f32 v55, v55, v53
v_mul_f32 v56, v56, v53
v_mul_f32 v57, v57, v53
v_accvgpr_write_b32 a76, v54
v_accvgpr_write_b32 a77, v55
v_accvgpr_write_b32 a78, v56
v_accvgpr_write_b32 a79, v57
v_accvgpr_read_b32 v54, a80
v_accvgpr_read_b32 v55, a81
v_accvgpr_read_b32 v56, a82
v_accvgpr_read_b32 v57, a83
v_mul_f32 v54, v54, v53
v_mul_f32 v55, v55, v53
v_mul_f32 v56, v56, v53
v_mul_f32 v57, v57, v53
v_accvgpr_write_b32 a80, v54
v_accvgpr_write_b32 a81, v55
v_accvgpr_write_b32 a82, v56
v_accvgpr_write_b32 a83, v57
v_accvgpr_read_b32 v54, a84
v_accvgpr_read_b32 v55, a85
v_accvgpr_read_b32 v56, a86
v_accvgpr_read_b32 v57, a87
v_mul_f32 v54, v54, v53
v_mul_f32 v55, v55, v53
v_mul_f32 v56, v56, v53
v_mul_f32 v57, v57, v53
v_accvgpr_write_b32 a84, v54
v_accvgpr_write_b32 a85, v55
v_accvgpr_write_b32 a86, v56
v_accvgpr_write_b32 a87, v57
v_accvgpr_read_b32 v54, a88
v_accvgpr_read_b32 v55, a89
v_accvgpr_read_b32 v56, a90
v_accvgpr_read_b32 v57, a91
v_mul_f32 v54, v54, v53
v_mul_f32 v55, v55, v53
v_mul_f32 v56, v56, v53
v_mul_f32 v57, v57, v53
v_accvgpr_write_b32 a88, v54
v_accvgpr_write_b32 a89, v55
v_accvgpr_write_b32 a90, v56
v_accvgpr_write_b32 a91, v57
v_accvgpr_read_b32 v54, a92
v_accvgpr_read_b32 v55, a93
v_accvgpr_read_b32 v56, a94
v_accvgpr_read_b32 v57, a95
v_mul_f32 v54, v54, v53
v_mul_f32 v55, v55, v53
v_mul_f32 v56, v56, v53
v_mul_f32 v57, v57, v53
v_accvgpr_write_b32 a92, v54
v_accvgpr_write_b32 a93, v55
v_accvgpr_write_b32 a94, v56
v_accvgpr_write_b32 a95, v57
v_max3_f32 v52, v168, v169, v170
v_max3_f32 v52, v52, v171, v172
v_max3_f32 v52, v52, v173, v174
v_max3_f32 v52, v52, v175, 0
v_mov_b32 v53, v52
s_nop 1
v_permlane16_swap_b32 v52, v53
v_max_f32 v52, v52, v53
v_mov_b32 v53, v52
s_nop 1
v_permlane32_swap_b32 v52, v53
v_max_f32 v52, v52, v53
v_exp_f32 v53, -v52
v_sub_f32 v168, v168, v52
v_sub_f32 v169, v169, v52
v_sub_f32 v170, v170, v52
v_sub_f32 v171, v171, v52
v_sub_f32 v172, v172, v52
v_sub_f32 v173, v173, v52
v_sub_f32 v174, v174, v52
v_sub_f32 v175, v175, v52
v_sub_f32 v220, v220, v52
v_sub_f32 v221, v221, v52
v_sub_f32 v222, v222, v52
v_sub_f32 v223, v223, v52
v_mul_f32 v244, v244, v53
v_mul_f32 v245, v245, v53
v_mul_f32 v246, v246, v53
v_mul_f32 v247, v247, v53
v_accvgpr_read_b32 v54, a96
v_accvgpr_read_b32 v55, a97
v_accvgpr_read_b32 v56, a98
v_accvgpr_read_b32 v57, a99
v_mul_f32 v54, v54, v53
v_mul_f32 v55, v55, v53
v_mul_f32 v56, v56, v53
v_mul_f32 v57, v57, v53
v_accvgpr_write_b32 a96, v54
v_accvgpr_write_b32 a97, v55
v_accvgpr_write_b32 a98, v56
v_accvgpr_write_b32 a99, v57
v_accvgpr_read_b32 v54, a100
v_accvgpr_read_b32 v55, a101
v_accvgpr_read_b32 v56, a102
v_accvgpr_read_b32 v57, a103
v_mul_f32 v54, v54, v53
v_mul_f32 v55, v55, v53
v_mul_f32 v56, v56, v53
v_mul_f32 v57, v57, v53
v_accvgpr_write_b32 a100, v54
v_accvgpr_write_b32 a101, v55
v_accvgpr_write_b32 a102, v56
v_accvgpr_write_b32 a103, v57
v_accvgpr_read_b32 v54, a104
v_accvgpr_read_b32 v55, a105
v_accvgpr_read_b32 v56, a106
v_accvgpr_read_b32 v57, a107
v_mul_f32 v54, v54, v53
v_mul_f32 v55, v55, v53
v_mul_f32 v56, v56, v53
v_mul_f32 v57, v57, v53
v_accvgpr_write_b32 a104, v54
v_accvgpr_write_b32 a105, v55
v_accvgpr_write_b32 a106, v56
v_accvgpr_write_b32 a107, v57
v_accvgpr_read_b32 v54, a108
v_accvgpr_read_b32 v55, a109
v_accvgpr_read_b32 v56, a110
v_accvgpr_read_b32 v57, a111
v_mul_f32 v54, v54, v53
v_mul_f32 v55, v55, v53
v_mul_f32 v56, v56, v53
v_mul_f32 v57, v57, v53
v_accvgpr_write_b32 a108, v54
v_accvgpr_write_b32 a109, v55
v_accvgpr_write_b32 a110, v56
v_accvgpr_write_b32 a111, v57
v_accvgpr_read_b32 v54, a112
v_accvgpr_read_b32 v55, a113
v_accvgpr_read_b32 v56, a114
v_accvgpr_read_b32 v57, a115
v_mul_f32 v54, v54, v53
v_mul_f32 v55, v55, v53
v_mul_f32 v56, v56, v53
v_mul_f32 v57, v57, v53
v_accvgpr_write_b32 a112, v54
v_accvgpr_write_b32 a113, v55
v_accvgpr_write_b32 a114, v56
v_accvgpr_write_b32 a115, v57
v_accvgpr_read_b32 v54, a116
v_accvgpr_read_b32 v55, a117
v_accvgpr_read_b32 v56, a118
v_accvgpr_read_b32 v57, a119
v_mul_f32 v54, v54, v53
v_mul_f32 v55, v55, v53
v_mul_f32 v56, v56, v53
v_mul_f32 v57, v57, v53
v_accvgpr_write_b32 a116, v54
v_accvgpr_write_b32 a117, v55
v_accvgpr_write_b32 a118, v56
v_accvgpr_write_b32 a119, v57
v_accvgpr_read_b32 v54, a120
v_accvgpr_read_b32 v55, a121
v_accvgpr_read_b32 v56, a122
v_accvgpr_read_b32 v57, a123
v_mul_f32 v54, v54, v53
v_mul_f32 v55, v55, v53
v_mul_f32 v56, v56, v53
v_mul_f32 v57, v57, v53
v_accvgpr_write_b32 a120, v54
v_accvgpr_write_b32 a121, v55
v_accvgpr_write_b32 a122, v56
v_accvgpr_write_b32 a123, v57
v_accvgpr_read_b32 v54, a124
v_accvgpr_read_b32 v55, a125
v_accvgpr_read_b32 v56, a126
v_accvgpr_read_b32 v57, a127
v_mul_f32 v54, v54, v53
v_mul_f32 v55, v55, v53
v_mul_f32 v56, v56, v53
v_mul_f32 v57, v57, v53
v_accvgpr_write_b32 a124, v54
v_accvgpr_write_b32 a125, v55
v_accvgpr_write_b32 a126, v56
v_accvgpr_write_b32 a127, v57
v_exp_f32 v160, v160
v_exp_f32 v161, v161
v_exp_f32 v162, v162
v_exp_f32 v163, v163
v_exp_f32 v164, v164
v_exp_f32 v165, v165
v_exp_f32 v166, v166
v_exp_f32 v167, v167
v_exp_f32 v168, v168
v_exp_f32 v169, v169
v_exp_f32 v170, v170
v_exp_f32 v171, v171
v_exp_f32 v172, v172
v_exp_f32 v173, v173
v_exp_f32 v174, v174
v_exp_f32 v175, v175
s_nop 0
v_cvt_pk_bf16_f32 v192, v160, v161
v_cvt_pk_bf16_f32 v193, v162, v163
v_cvt_pk_bf16_f32 v194, v164, v165
v_cvt_pk_bf16_f32 v195, v166, v167
v_cvt_pk_bf16_f32 v196, v168, v169
v_cvt_pk_bf16_f32 v197, v170, v171
v_cvt_pk_bf16_f32 v198, v172, v173
v_cvt_pk_bf16_f32 v199, v174, v175
s_nop 1
v_mfma_f32_16x16x32_bf16 a[64:67], a[224:227], v[192:195], a[64:67]
v_mfma_f32_16x16x32_bf16 a[96:99], a[224:227], v[196:199], a[96:99]
v_mfma_f32_16x16x32_bf16 a[68:71], a[228:231], v[192:195], a[68:71]
v_mfma_f32_16x16x32_bf16 a[100:103], a[228:231], v[196:199], a[100:103]
v_mfma_f32_16x16x32_bf16 a[72:75], a[232:235], v[192:195], a[72:75]
v_mfma_f32_16x16x32_bf16 a[104:107], a[232:235], v[196:199], a[104:107]
v_mfma_f32_16x16x32_bf16 a[76:79], a[236:239], v[192:195], a[76:79]
v_mfma_f32_16x16x32_bf16 a[108:111], a[236:239], v[196:199], a[108:111]
v_mfma_f32_16x16x32_bf16 a[80:83], a[240:243], v[192:195], a[80:83]
v_mfma_f32_16x16x32_bf16 a[112:115], a[240:243], v[196:199], a[112:115]
v_mfma_f32_16x16x32_bf16 a[84:87], a[244:247], v[192:195], a[84:87]
v_mfma_f32_16x16x32_bf16 a[116:119], a[244:247], v[196:199], a[116:119]
v_mfma_f32_16x16x32_bf16 a[88:91], a[248:251], v[192:195], a[88:91]
v_mfma_f32_16x16x32_bf16 a[120:123], a[248:251], v[196:199], a[120:123]
v_mfma_f32_16x16x32_bf16 a[92:95], a[252:255], v[192:195], a[92:95]
v_mfma_f32_16x16x32_bf16 a[124:127], a[252:255], v[196:199], a[124:127]
v_mfma_f32_16x16x32_bf16 v[240:243], v[48:51], v[192:195], v[240:243]
v_mfma_f32_16x16x32_bf16 v[244:247], v[48:51], v[196:199], v[244:247]
v_mfma_f32_16x16x32_bf16 v[160:163], a[192:195], v[128:131], v[224:227]
v_mfma_f32_16x16x32_bf16 v[160:163], a[196:199], v[132:135], v[160:163]
v_mfma_f32_16x16x32_bf16 v[160:163], a[200:203], v[136:139], v[160:163]
v_mfma_f32_16x16x32_bf16 v[160:163], a[204:207], v[140:143], v[160:163]
v_mfma_f32_16x16x32_bf16 v[164:167], a[208:211], v[128:131], v[224:227]
v_mfma_f32_16x16x32_bf16 v[164:167], a[212:215], v[132:135], v[164:167]
v_mfma_f32_16x16x32_bf16 v[164:167], a[216:219], v[136:139], v[164:167]
v_mfma_f32_16x16x32_bf16 v[164:167], a[220:223], v[140:143], v[164:167]
v_mfma_f32_16x16x32_bf16 v[168:171], a[192:195], v[144:147], v[228:231]
v_mfma_f32_16x16x32_bf16 v[168:171], a[196:199], v[148:151], v[168:171]
v_mfma_f32_16x16x32_bf16 v[168:171], a[200:203], v[152:155], v[168:171]
v_mfma_f32_16x16x32_bf16 v[168:171], a[204:207], v[156:159], v[168:171]
v_mfma_f32_16x16x32_bf16 v[172:175], a[208:211], v[144:147], v[228:231]
v_mfma_f32_16x16x32_bf16 v[172:175], a[212:215], v[148:151], v[172:175]
v_mfma_f32_16x16x32_bf16 v[172:175], a[216:219], v[152:155], v[172:175]
v_mfma_f32_16x16x32_bf16 v[172:175], a[220:223], v[156:159], v[172:175]
s_nop 7
v_max3_f32 v52, v160, v161, v162
v_max3_f32 v52, v52, v163, v164
v_max3_f32 v52, v52, v165, v166
v_max3_f32 v52, v52, v167, 0
v_mov_b32 v53, v52
s_nop 1
v_permlane16_swap_b32 v52, v53
v_max_f32 v52, v52, v53
v_mov_b32 v53, v52
s_nop 1
v_permlane32_swap_b32 v52, v53
v_max_f32 v52, v52, v53
v_exp_f32 v53, -v52
v_sub_f32 v160, v160, v52
v_sub_f32 v161, v161, v52
v_sub_f32 v162, v162, v52
v_sub_f32 v163, v163, v52
v_sub_f32 v164, v164, v52
v_sub_f32 v165, v165, v52
v_sub_f32 v166, v166, v52
v_sub_f32 v167, v167, v52
v_sub_f32 v224, v224, v52
v_sub_f32 v225, v225, v52
v_sub_f32 v226, v226, v52
v_sub_f32 v227, v227, v52
v_mul_f32 v248, v248, v53
v_mul_f32 v249, v249, v53
v_mul_f32 v250, v250, v53
v_mul_f32 v251, v251, v53
v_accvgpr_read_b32 v54, a128
v_accvgpr_read_b32 v55, a129
v_accvgpr_read_b32 v56, a130
v_accvgpr_read_b32 v57, a131
v_mul_f32 v54, v54, v53
v_mul_f32 v55, v55, v53
v_mul_f32 v56, v56, v53
v_mul_f32 v57, v57, v53
v_accvgpr_write_b32 a128, v54
v_accvgpr_write_b32 a129, v55
v_accvgpr_write_b32 a130, v56
v_accvgpr_write_b32 a131, v57
v_accvgpr_read_b32 v54, a132
v_accvgpr_read_b32 v55, a133
v_accvgpr_read_b32 v56, a134
v_accvgpr_read_b32 v57, a135
v_mul_f32 v54, v54, v53
v_mul_f32 v55, v55, v53
v_mul_f32 v56, v56, v53
v_mul_f32 v57, v57, v53
v_accvgpr_write_b32 a132, v54
v_accvgpr_write_b32 a133, v55
v_accvgpr_write_b32 a134, v56
v_accvgpr_write_b32 a135, v57
v_accvgpr_read_b32 v54, a136
v_accvgpr_read_b32 v55, a137
v_accvgpr_read_b32 v56, a138
v_accvgpr_read_b32 v57, a139
v_mul_f32 v54, v54, v53
v_mul_f32 v55, v55, v53
v_mul_f32 v56, v56, v53
v_mul_f32 v57, v57, v53
v_accvgpr_write_b32 a136, v54
v_accvgpr_write_b32 a137, v55
v_accvgpr_write_b32 a138, v56
v_accvgpr_write_b32 a139, v57
v_accvgpr_read_b32 v54, a140
v_accvgpr_read_b32 v55, a141
v_accvgpr_read_b32 v56, a142
v_accvgpr_read_b32 v57, a143
v_mul_f32 v54, v54, v53
v_mul_f32 v55, v55, v53
v_mul_f32 v56, v56, v53
v_mul_f32 v57, v57, v53
v_accvgpr_write_b32 a140, v54
v_accvgpr_write_b32 a141, v55
v_accvgpr_write_b32 a142, v56
v_accvgpr_write_b32 a143, v57
v_accvgpr_read_b32 v54, a144
v_accvgpr_read_b32 v55, a145
v_accvgpr_read_b32 v56, a146
v_accvgpr_read_b32 v57, a147
v_mul_f32 v54, v54, v53
v_mul_f32 v55, v55, v53
v_mul_f32 v56, v56, v53
v_mul_f32 v57, v57, v53
v_accvgpr_write_b32 a144, v54
v_accvgpr_write_b32 a145, v55
v_accvgpr_write_b32 a146, v56
v_accvgpr_write_b32 a147, v57
v_accvgpr_read_b32 v54, a148
v_accvgpr_read_b32 v55, a149
v_accvgpr_read_b32 v56, a150
v_accvgpr_read_b32 v57, a151
v_mul_f32 v54, v54, v53
v_mul_f32 v55, v55, v53
v_mul_f32 v56, v56, v53
v_mul_f32 v57, v57, v53
v_accvgpr_write_b32 a148, v54
v_accvgpr_write_b32 a149, v55
v_accvgpr_write_b32 a150, v56
v_accvgpr_write_b32 a151, v57
v_accvgpr_read_b32 v54, a152
v_accvgpr_read_b32 v55, a153
v_accvgpr_read_b32 v56, a154
v_accvgpr_read_b32 v57, a155
v_mul_f32 v54, v54, v53
v_mul_f32 v55, v55, v53
v_mul_f32 v56, v56, v53
v_mul_f32 v57, v57, v53
v_accvgpr_write_b32 a152, v54
v_accvgpr_write_b32 a153, v55
v_accvgpr_write_b32 a154, v56
v_accvgpr_write_b32 a155, v57
v_accvgpr_read_b32 v54, a156
v_accvgpr_read_b32 v55, a157
v_accvgpr_read_b32 v56, a158
v_accvgpr_read_b32 v57, a159
v_mul_f32 v54, v54, v53
v_mul_f32 v55, v55, v53
v_mul_f32 v56, v56, v53
v_mul_f32 v57, v57, v53
v_accvgpr_write_b32 a156, v54
v_accvgpr_write_b32 a157, v55
v_accvgpr_write_b32 a158, v56
v_accvgpr_write_b32 a159, v57
v_max3_f32 v52, v168, v169, v170
v_max3_f32 v52, v52, v171, v172
v_max3_f32 v52, v52, v173, v174
v_max3_f32 v52, v52, v175, 0
v_mov_b32 v53, v52
s_nop 1
v_permlane16_swap_b32 v52, v53
v_max_f32 v52, v52, v53
v_mov_b32 v53, v52
s_nop 1
v_permlane32_swap_b32 v52, v53
v_max_f32 v52, v52, v53
v_exp_f32 v53, -v52
v_sub_f32 v168, v168, v52
v_sub_f32 v169, v169, v52
v_sub_f32 v170, v170, v52
v_sub_f32 v171, v171, v52
v_sub_f32 v172, v172, v52
v_sub_f32 v173, v173, v52
v_sub_f32 v174, v174, v52
v_sub_f32 v175, v175, v52
v_sub_f32 v228, v228, v52
v_sub_f32 v229, v229, v52
v_sub_f32 v230, v230, v52
v_sub_f32 v231, v231, v52
v_mul_f32 v252, v252, v53
v_mul_f32 v253, v253, v53
v_mul_f32 v254, v254, v53
v_mul_f32 v255, v255, v53
v_accvgpr_read_b32 v54, a160
v_accvgpr_read_b32 v55, a161
v_accvgpr_read_b32 v56, a162
v_accvgpr_read_b32 v57, a163
v_mul_f32 v54, v54, v53
v_mul_f32 v55, v55, v53
v_mul_f32 v56, v56, v53
v_mul_f32 v57, v57, v53
v_accvgpr_write_b32 a160, v54
v_accvgpr_write_b32 a161, v55
v_accvgpr_write_b32 a162, v56
v_accvgpr_write_b32 a163, v57
v_accvgpr_read_b32 v54, a164
v_accvgpr_read_b32 v55, a165
v_accvgpr_read_b32 v56, a166
v_accvgpr_read_b32 v57, a167
v_mul_f32 v54, v54, v53
v_mul_f32 v55, v55, v53
v_mul_f32 v56, v56, v53
v_mul_f32 v57, v57, v53
v_accvgpr_write_b32 a164, v54
v_accvgpr_write_b32 a165, v55
v_accvgpr_write_b32 a166, v56
v_accvgpr_write_b32 a167, v57
v_accvgpr_read_b32 v54, a168
v_accvgpr_read_b32 v55, a169
v_accvgpr_read_b32 v56, a170
v_accvgpr_read_b32 v57, a171
v_mul_f32 v54, v54, v53
v_mul_f32 v55, v55, v53
v_mul_f32 v56, v56, v53
v_mul_f32 v57, v57, v53
v_accvgpr_write_b32 a168, v54
v_accvgpr_write_b32 a169, v55
v_accvgpr_write_b32 a170, v56
v_accvgpr_write_b32 a171, v57
v_accvgpr_read_b32 v54, a172
v_accvgpr_read_b32 v55, a173
v_accvgpr_read_b32 v56, a174
v_accvgpr_read_b32 v57, a175
v_mul_f32 v54, v54, v53
v_mul_f32 v55, v55, v53
v_mul_f32 v56, v56, v53
v_mul_f32 v57, v57, v53
v_accvgpr_write_b32 a172, v54
v_accvgpr_write_b32 a173, v55
v_accvgpr_write_b32 a174, v56
v_accvgpr_write_b32 a175, v57
v_accvgpr_read_b32 v54, a176
v_accvgpr_read_b32 v55, a177
v_accvgpr_read_b32 v56, a178
v_accvgpr_read_b32 v57, a179
v_mul_f32 v54, v54, v53
v_mul_f32 v55, v55, v53
v_mul_f32 v56, v56, v53
v_mul_f32 v57, v57, v53
v_accvgpr_write_b32 a176, v54
v_accvgpr_write_b32 a177, v55
v_accvgpr_write_b32 a178, v56
v_accvgpr_write_b32 a179, v57
v_accvgpr_read_b32 v54, a180
v_accvgpr_read_b32 v55, a181
v_accvgpr_read_b32 v56, a182
v_accvgpr_read_b32 v57, a183
v_mul_f32 v54, v54, v53
v_mul_f32 v55, v55, v53
v_mul_f32 v56, v56, v53
v_mul_f32 v57, v57, v53
v_accvgpr_write_b32 a180, v54
v_accvgpr_write_b32 a181, v55
v_accvgpr_write_b32 a182, v56
v_accvgpr_write_b32 a183, v57
v_accvgpr_read_b32 v54, a184
v_accvgpr_read_b32 v55, a185
v_accvgpr_read_b32 v56, a186
v_accvgpr_read_b32 v57, a187
v_mul_f32 v54, v54, v53
v_mul_f32 v55, v55, v53
v_mul_f32 v56, v56, v53
v_mul_f32 v57, v57, v53
v_accvgpr_write_b32 a184, v54
v_accvgpr_write_b32 a185, v55
v_accvgpr_write_b32 a186, v56
v_accvgpr_write_b32 a187, v57
v_accvgpr_read_b32 v54, a188
v_accvgpr_read_b32 v55, a189
v_accvgpr_read_b32 v56, a190
v_accvgpr_read_b32 v57, a191
v_mul_f32 v54, v54, v53
v_mul_f32 v55, v55, v53
v_mul_f32 v56, v56, v53
v_mul_f32 v57, v57, v53
v_accvgpr_write_b32 a188, v54
v_accvgpr_write_b32 a189, v55
v_accvgpr_write_b32 a190, v56
v_accvgpr_write_b32 a191, v57
v_exp_f32 v160, v160
v_exp_f32 v161, v161
v_exp_f32 v162, v162
v_exp_f32 v163, v163
v_exp_f32 v164, v164
v_exp_f32 v165, v165
v_exp_f32 v166, v166
v_exp_f32 v167, v167
v_exp_f32 v168, v168
v_exp_f32 v169, v169
v_exp_f32 v170, v170
v_exp_f32 v171, v171
v_exp_f32 v172, v172
v_exp_f32 v173, v173
v_exp_f32 v174, v174
v_exp_f32 v175, v175
s_nop 0
v_cvt_pk_bf16_f32 v192, v160, v161
v_cvt_pk_bf16_f32 v193, v162, v163
v_cvt_pk_bf16_f32 v194, v164, v165
v_cvt_pk_bf16_f32 v195, v166, v167
v_cvt_pk_bf16_f32 v196, v168, v169
v_cvt_pk_bf16_f32 v197, v170, v171
v_cvt_pk_bf16_f32 v198, v172, v173
v_cvt_pk_bf16_f32 v199, v174, v175
s_nop 1
v_mfma_f32_16x16x32_bf16 a[128:131], a[224:227], v[192:195], a[128:131]
v_mfma_f32_16x16x32_bf16 a[160:163], a[224:227], v[196:199], a[160:163]
v_mfma_f32_16x16x32_bf16 a[132:135], a[228:231], v[192:195], a[132:135]
v_mfma_f32_16x16x32_bf16 a[164:167], a[228:231], v[196:199], a[164:167]
v_mfma_f32_16x16x32_bf16 a[136:139], a[232:235], v[192:195], a[136:139]
v_mfma_f32_16x16x32_bf16 a[168:171], a[232:235], v[196:199], a[168:171]
v_mfma_f32_16x16x32_bf16 a[140:143], a[236:239], v[192:195], a[140:143]
v_mfma_f32_16x16x32_bf16 a[172:175], a[236:239], v[196:199], a[172:175]
v_mfma_f32_16x16x32_bf16 a[144:147], a[240:243], v[192:195], a[144:147]
v_mfma_f32_16x16x32_bf16 a[176:179], a[240:243], v[196:199], a[176:179]
v_mfma_f32_16x16x32_bf16 a[148:151], a[244:247], v[192:195], a[148:151]
v_mfma_f32_16x16x32_bf16 a[180:183], a[244:247], v[196:199], a[180:183]
v_mfma_f32_16x16x32_bf16 a[152:155], a[248:251], v[192:195], a[152:155]
v_mfma_f32_16x16x32_bf16 a[184:187], a[248:251], v[196:199], a[184:187]
v_mfma_f32_16x16x32_bf16 a[156:159], a[252:255], v[192:195], a[156:159]
v_mfma_f32_16x16x32_bf16 a[188:191], a[252:255], v[196:199], a[188:191]
v_mfma_f32_16x16x32_bf16 v[248:251], v[48:51], v[192:195], v[248:251]
v_mfma_f32_16x16x32_bf16 v[252:255], v[48:51], v[196:199], v[252:255]
s_add_u32 s60, s60, 8192
s_cmp_lt_u32 s60, 0x40000
s_cbranch_scc1 L_fb_loop
s_nop 7
s_branch L_epi
.section .rodata,"a"
.p2align 6
.amdhsa_kernel concat_heads__mha_block_cached__gqa_block_cached__near_ridge_kernel
  .amdhsa_next_free_vgpr 512
  .amdhsa_next_free_sgpr 102
  .amdhsa_accum_offset 256
  .amdhsa_group_segment_fixed_size 0
  .amdhsa_kernarg_size 104
  .amdhsa_user_sgpr_count 2
  .amdhsa_user_sgpr_kernarg_segment_ptr 1
  .amdhsa_system_sgpr_workgroup_id_x 1
.end_amdhsa_kernel
```
